```python
import torch

def _softmax(x, axis=-1):
    return torch.softmax(x, dim=axis)
def _gelu(x):
    return torch.nn.functional.gelu(x, approximate="tanh")
def _silu(x):
    return torch.nn.functional.silu(x)
def _sigmoid(x):
    return torch.sigmoid(x)
def _layernorm(x, axis=-1, eps=1e-5):
    m = x.mean(dim=axis, keepdim=True)
    v = x.var(dim=axis, keepdim=True, unbiased=False)
    return (x - m) / torch.sqrt(v + eps)
def _scatter_add(tgt, idx, src, axis=0):
    return tgt.clone().index_add_(axis, idx, src)
def _segment_sum(src, seg, n):
    out = torch.zeros((n,) + src.shape[1:], dtype=src.dtype)
    return out.index_add_(0, seg, src)
def _pad(x, pw):
    flat = tuple(v for pair in reversed(pw) for v in pair)
    return torch.nn.functional.pad(x, flat)

kernel_name = 'interleave_layers__softmax_full_mha__mixer_channel_mlp__prompt'

def setup_inputs():

    _w = (lambda a: (lambda t: t.to(torch.bfloat16) if t.is_floating_point() else t)(torch.as_tensor(a)))
    def _A_setup():
        B, S, D = 1, 2048, 640
        return {
            "x": _w((lambda *s: torch.randn(*s, dtype=torch.bfloat16) * 0.05)(B, S, D)),
            "wqkv": _w((lambda *s: torch.randn(*s, dtype=torch.bfloat16) * 0.05)(D, 3 * D)),
            "wo": _w((lambda *s: torch.randn(*s, dtype=torch.bfloat16) * 0.05)(D, D)),
        }
    _A_in = _A_setup()

    def _B_setup():
        B, S, D, F = 1, 2048, 640, 1536
        return {
            "x": _w((lambda *s: torch.randn(*s, dtype=torch.bfloat16) * 0.05)(B, S, D)),
            "w1": _w((lambda *s: torch.randn(*s, dtype=torch.bfloat16) * 3.2)(D, F) * (D ** -0.5)),
            "b1": _w((lambda *s: torch.randn(*s, dtype=torch.bfloat16) * 0.8)(F)),
            "w2": _w((lambda *s: torch.randn(*s, dtype=torch.bfloat16) * 0.4)(F, D) * (F ** -0.5)),
            "b2": _w((lambda *s: torch.randn(*s, dtype=torch.bfloat16) * 0.4)(D)),
        }
    _B_in = _B_setup()

    return {
        "A_x": _A_in["x"],
        "A_wqkv": _A_in["wqkv"],
        "A_wo": _A_in["wo"],
        "B_x": _B_in["x"],
        "B_w1": _B_in["w1"],
        "B_b1": _B_in["b1"],
        "B_w2": _B_in["w2"],
        "B_b2": _B_in["b2"],
    }

def reference(A_x, A_wqkv, A_wo, B_x, B_w1, B_b1, B_w2, B_b2):
    def _A_ref(x, wqkv, wo):
        B, S, D = x.shape
        H = 32; Dh = D // H
        qkv = (lambda x, *d: x.permute(*d))((x @ wqkv).reshape(B, S, 3, H, Dh), 2, 0, 3, 1, 4)
        q, k, v = qkv[0], qkv[1], qkv[2]
        scale = Dh ** -0.5
        scores = torch.einsum("bhqd,bhkd->bhqk", q, k) * scale
        p = _softmax(scores, axis=-1)
        o = torch.einsum("bhqk,bhkd->bhqd", p, v)
        return (lambda x, *d: x.permute(*d))(o, 0, 2, 1, 3).reshape(B, S, D) @ wo

    def _B_ref(x, w1, b1, w2, b2):
        y = _layernorm(x, axis=-1)
        h = _gelu(torch.einsum("bsd,df->bsf", y, w1) + b1)
        return torch.einsum("bsf,fd->bsd", h, w2) + b2

    x = A_x
    x = x + _A_ref(_layernorm(x, axis=-1), A_wqkv, A_wo)
    x = x + _B_ref(_layernorm(x, axis=-1), B_w1, B_b1, B_w2, B_b2)
    x = x + _A_ref(_layernorm(x, axis=-1), A_wqkv, A_wo)
    x = x + _B_ref(_layernorm(x, axis=-1), B_w1, B_b1, B_w2, B_b2)
    return x
```

```asm
; @launch grid=(256,1,1) block=(512,1,1) lds=163840
.amdgcn_target "amdgcn-amd-amdhsa--gfx950"
.text
.globl interleave_layers__softmax_full_mha__mixer_channel_mlp__prompt_kernel
.p2align 8
.type interleave_layers__softmax_full_mha__mixer_channel_mlp__prompt_kernel,@function
interleave_layers__softmax_full_mha__mixer_channel_mlp__prompt_kernel:
    s_cmp_ge_u32 s2, 256
    s_cbranch_scc1 L_end
    s_load_dwordx4 s[84:87], s[0:1], 0
    s_load_dwordx2 s[96:97], s[0:1], 80
    s_load_dwordx2 s[30:31], s[0:1], 72
    s_mov_b32 s98, 1
    s_mov_b32 s19, 0
    v_lshrrev_b32 v12, 6, v0
    v_and_b32 v1, 63, v0
    s_and_b32 s17, s2, 7
    v_readfirstlane_b32 s16, v12
    s_lshr_b32 s18, s2, 3
    s_lshr_b32 s52, s17, 1
    s_and_b32 s53, s17, 1
    s_lshr_b32 s54, s18, 3
    s_and_b32 s55, s18, 7
    s_xor_b32 s16, s16, 0
    s_cmp_lt_u32 s16, 4
    s_cbranch_scc1 L_front_np
    s_setprio 3
L_front_np:
    s_lshl2_add_u32 s37, s52, s54
    s_lshl3_add_u32 s36, s53, s55
    s_mul_i32 s32, s54, 3
    s_add_u32 s32, s32, s55
    s_mul_i32 s53, s53, 5
    s_add_u32 s32, s32, s53
    s_add_u32 s32, s32, s52
    s_mul_i32 s52, s32, 26
    s_lshr_b32 s52, s52, 8
    s_mul_i32 s52, s52, 10
    s_sub_u32 s32, s32, s52
    s_and_b32 s38, s16, 3
    s_lshl2_add_u32 s40, s37, s38
    s_cmp_lt_u32 s16, 4
    s_cbranch_scc1 L_front_compute
L_front_loader:
    v_lshrrev_b32 v12, 3, v1
    v_mul_u32_u24 v12, 1280, v12
    v_lshrrev_b32 v13, 4, v1
    v_and_b32 v14, 7, v1
    v_xor_b32 v14, v14, v13
    v_lshl_add_u32 v16, v14, 4, v12
    v_xor_b32 v14, 4, v14
    v_lshl_add_u32 v17, v14, 4, v12
    v_and_b32 v12, 3, v1
    v_lshl_add_u32 v12, v13, 2, v12
    v_lshlrev_b32 v12, 2, v12
    v_mov_b32 v14, 0x86572310
    v_mov_b32 v15, 0x40e9bacd
    v_lshrrev_b64 v[14:15], v12, v[14:15]
    v_and_b32 v14, 15, v14
    v_bfe_u32 v12, v1, 2, 2
    v_mul_u32_u24 v12, 3840, v12
    v_lshl_add_u32 v18, v14, 4, v12
    s_mul_i32 s33, s40, 40960
    s_mul_i32 s34, s38, 61440
    s_mul_i32 s50, s36, 240
    s_add_u32 s34, s34, s50
    s_lshl_b32 s35, s38, 12
    v_add_u32 v48, 0, v18
    v_add_u32 v49, 14336, v18
    v_add_u32 v50, 28672, v18
    v_add_u32 v51, 43008, v18
    v_add_u32 v52, 0, v16
    v_add_u32 v53, 9216, v17
    v_add_u32 v54, 18432, v16
    v_add_u32 v55, 27648, v17
    s_mov_b32 s22, -1
    s_mov_b32 s23, 0xbbbbffff
    s_waitcnt lgkmcnt(0)
    s_mov_b32 s8, s84
    s_and_b32 s9, s85, 0xffff
    s_mov_b32 s10, 2621440
    s_mov_b32 s11, 0x20000
    s_mov_b32 s12, s86
    s_and_b32 s13, s87, 0xffff
    s_mov_b32 s14, 2457600
    s_mov_b32 s15, 0x20000
    s_mov_b64 exec, s[22:23]
    s_add_u32 m0, s35, 16384
    s_mul_i32 s51, s32, 245760
    s_add_u32 s51, s51, s34
    buffer_load_dwordx4 v48, s[12:15], s51 offen offset:0 lds
    buffer_load_dwordx4 v49, s[12:15], s51 offen offset:1024 lds
    buffer_load_dwordx4 v50, s[12:15], s51 offen offset:2048 lds
    buffer_load_dwordx4 v51, s[12:15], s51 offen offset:3072 lds
    s_mov_b64 exec, -1
    s_add_u32 m0, s35, 0
    s_lshl_b32 s50, s32, 7
    s_add_u32 s50, s50, s33
    buffer_load_dwordx4 v52, s[8:11], s50 offen offset:0 lds
    buffer_load_dwordx4 v53, s[8:11], s50 offen offset:1024 lds
    buffer_load_dwordx4 v54, s[8:11], s50 offen offset:2048 lds
    buffer_load_dwordx4 v55, s[8:11], s50 offen offset:3072 lds
    s_add_u32 s32, s32, 1
    s_cmp_eq_u32 s32, 10
    s_cselect_b32 s32, 0, s32
    v_lshrrev_b32 v5, 5, v1
    v_lshlrev_b32 v2, 4, v1
    v_bfe_u32 v6, v1, 4, 1
    v_bfe_u32 v7, v1, 2, 2
    v_and_b32 v8, 1, v1
    v_lshlrev_b32 v8, 1, v8
    v_bfe_u32 v9, v1, 1, 1
    v_or_b32 v8, v8, v9
    v_and_b32 v9, 31, v1
    v_lshl_add_u32 v10, v5, 3, v7
    v_mov_b32 v11, 0x3f803f80
    s_cmp_lg_u32 s38, 0
    s_cbranch_scc1 L_wa_1
    v_mul_u32_u24 v12, 5, v6
    v_add_u32 v12, v12, v8
    v_and_b32 v13, 14, v12
    v_mov_b32 v14, 0x3b4
    v_bfe_u32 v14, v14, v13, 2
    v_add_u32 v14, 0, v14
    v_and_b32 v14, 3, v14
    v_lshrrev_b32 v13, 3, v12
    v_mul_u32_u24 v13, 3, v13
    v_add_u32 v13, 0, v13
    v_and_b32 v12, 1, v12
    v_lshl_add_u32 v14, v7, 2, v14
    v_lshlrev_b32 v14, 4, v14
    v_lshl_add_u32 v14, v13, 8, v14
    v_lshl_add_u32 v14, v12, 3, v14
    v_lshl_add_u32 v14, v5, 11, v14
    v_add_u32 v20, 16384, v14
L_wa_1:
    s_cmp_lg_u32 s38, 1
    s_cbranch_scc1 L_wa_2
    v_mul_u32_u24 v12, 5, v6
    v_add_u32 v12, v12, v8
    v_and_b32 v13, 14, v12
    v_mov_b32 v14, 0x3b4
    v_bfe_u32 v14, v14, v13, 2
    v_add_u32 v14, 1, v14
    v_and_b32 v14, 3, v14
    v_lshrrev_b32 v13, 3, v12
    v_mul_u32_u24 v13, 2, v13
    v_add_u32 v13, 1, v13
    v_and_b32 v12, 1, v12
    v_lshl_add_u32 v14, v7, 2, v14
    v_lshlrev_b32 v14, 4, v14
    v_lshl_add_u32 v14, v13, 8, v14
    v_lshl_add_u32 v14, v12, 3, v14
    v_lshl_add_u32 v14, v5, 11, v14
    v_add_u32 v20, 16384, v14
L_wa_2:
    s_cmp_lg_u32 s38, 2
    s_cbranch_scc1 L_wa_3
    v_mul_u32_u24 v12, 5, v6
    v_add_u32 v12, v12, v8
    v_and_b32 v13, 14, v12
    v_mov_b32 v14, 0x3b4
    v_bfe_u32 v14, v14, v13, 2
    v_add_u32 v14, 2, v14
    v_and_b32 v14, 3, v14
    v_lshrrev_b32 v13, 3, v12
    v_mul_u32_u24 v13, 1, v13
    v_add_u32 v13, 2, v13
    v_and_b32 v12, 1, v12
    v_lshl_add_u32 v14, v7, 2, v14
    v_lshlrev_b32 v14, 4, v14
    v_lshl_add_u32 v14, v13, 8, v14
    v_lshl_add_u32 v14, v12, 3, v14
    v_lshl_add_u32 v14, v5, 11, v14
    v_add_u32 v20, 16384, v14
L_wa_3:
    s_cmp_lg_u32 s38, 3
    s_cbranch_scc1 L_wa_4
    v_and_b32 v12, 1, v1
    v_bfe_u32 v15, v1, 1, 1
    v_lshl_add_u32 v15, v6, 1, v15
    v_add_u32 v14, 3, v15
    v_and_b32 v14, 3, v14
    v_mul_u32_u24 v13, 3, v12
    v_max_u32 v13, v13, v15
    v_lshl_add_u32 v14, v7, 2, v14
    v_lshlrev_b32 v14, 4, v14
    v_lshl_add_u32 v14, v13, 8, v14
    v_lshl_add_u32 v14, v12, 3, v14
    v_lshl_add_u32 v14, v5, 11, v14
    v_add_u32 v20, 16384, v14
L_wa_4:
    v_add_u32 v21, 65536, v20
    v_mov_b32 v112, 0
    v_mov_b32 v113, 0
    v_mov_b32 v114, 0
    v_mov_b32 v115, 0
    v_mov_b32 v116, 0
    v_mov_b32 v117, 0
    v_mov_b32 v118, 0
    v_mov_b32 v119, 0
    v_mov_b32 v120, 0
    v_mov_b32 v121, 0
    v_mov_b32 v122, 0
    v_mov_b32 v123, 0
    v_mov_b32 v124, 0
    v_mov_b32 v125, 0
    v_mov_b32 v126, 0
    v_mov_b32 v127, 0
    v_mov_b32 v56, v11
    v_mov_b32 v57, v11
    v_mov_b32 v58, v11
    v_mov_b32 v59, v11
    s_mov_b64 exec, s[22:23]
    s_add_u32 m0, s35, 49152
    s_mul_i32 s51, s32, 245760
    s_add_u32 s51, s51, s34
    buffer_load_dwordx4 v48, s[12:15], s51 offen offset:0 lds
    buffer_load_dwordx4 v49, s[12:15], s51 offen offset:1024 lds
    buffer_load_dwordx4 v50, s[12:15], s51 offen offset:2048 lds
    buffer_load_dwordx4 v51, s[12:15], s51 offen offset:3072 lds
    s_mov_b64 exec, -1
    s_add_u32 m0, s35, 32768
    s_lshl_b32 s50, s32, 7
    s_add_u32 s50, s50, s33
    buffer_load_dwordx4 v52, s[8:11], s50 offen offset:0 lds
    buffer_load_dwordx4 v53, s[8:11], s50 offen offset:1024 lds
    buffer_load_dwordx4 v54, s[8:11], s50 offen offset:2048 lds
    buffer_load_dwordx4 v55, s[8:11], s50 offen offset:3072 lds
    s_add_u32 s32, s32, 1
    s_cmp_eq_u32 s32, 10
    s_cselect_b32 s32, 0, s32
    s_waitcnt vmcnt(8)
    s_barrier
    s_setprio 0
    ds_read_b64_tr_b16 v[32:33], v20 offset:0
    ds_read_b64_tr_b16 v[34:35], v20 offset:1024
    ds_read_b64_tr_b16 v[36:37], v20 offset:4096
    ds_read_b64_tr_b16 v[38:39], v20 offset:5120
    ds_read_b64_tr_b16 v[40:41], v20 offset:8192
    ds_read_b64_tr_b16 v[42:43], v20 offset:9216
    ds_read_b64_tr_b16 v[44:45], v20 offset:12288
    ds_read_b64_tr_b16 v[46:47], v20 offset:13312
    s_mov_b64 exec, s[22:23]
    s_add_u32 m0, s35, 81920
    s_mul_i32 s51, s32, 245760
    s_add_u32 s51, s51, s34
    buffer_load_dwordx4 v48, s[12:15], s51 offen offset:0 lds
    buffer_load_dwordx4 v49, s[12:15], s51 offen offset:1024 lds
    buffer_load_dwordx4 v50, s[12:15], s51 offen offset:2048 lds
    buffer_load_dwordx4 v51, s[12:15], s51 offen offset:3072 lds
    s_mov_b64 exec, -1
    s_add_u32 m0, s35, 65536
    s_lshl_b32 s50, s32, 7
    s_add_u32 s50, s50, s33
    s_waitcnt lgkmcnt(0)
    buffer_load_dwordx4 v52, s[8:11], s50 offen offset:0 lds
    buffer_load_dwordx4 v53, s[8:11], s50 offen offset:1024 lds
    buffer_load_dwordx4 v54, s[8:11], s50 offen offset:2048 lds
    buffer_load_dwordx4 v55, s[8:11], s50 offen offset:3072 lds
    s_setprio 3
    v_mfma_f32_4x4x4_16b_bf16 v[112:115], v[56:57], v[32:33], v[112:115]
    v_mfma_f32_4x4x4_16b_bf16 v[116:119], v[56:57], v[34:35], v[116:119]
    v_mfma_f32_4x4x4_16b_bf16 v[120:123], v[56:57], v[36:37], v[120:123]
    v_mfma_f32_4x4x4_16b_bf16 v[124:127], v[56:57], v[38:39], v[124:127]
    v_mfma_f32_4x4x4_16b_bf16 v[112:115], v[56:57], v[40:41], v[112:115]
    v_mfma_f32_4x4x4_16b_bf16 v[116:119], v[56:57], v[42:43], v[116:119]
    v_mfma_f32_4x4x4_16b_bf16 v[120:123], v[56:57], v[44:45], v[120:123]
    v_mfma_f32_4x4x4_16b_bf16 v[124:127], v[56:57], v[46:47], v[124:127]
    s_setprio 0
    s_add_u32 s32, s32, 1
    s_cmp_eq_u32 s32, 10
    s_cselect_b32 s32, 0, s32
    s_waitcnt vmcnt(8)
    s_barrier
    ds_read_b64_tr_b16 v[32:33], v20 offset:32768
    ds_read_b64_tr_b16 v[34:35], v20 offset:33792
    ds_read_b64_tr_b16 v[36:37], v20 offset:36864
    ds_read_b64_tr_b16 v[38:39], v20 offset:37888
    ds_read_b64_tr_b16 v[40:41], v20 offset:40960
    ds_read_b64_tr_b16 v[42:43], v20 offset:41984
    ds_read_b64_tr_b16 v[44:45], v20 offset:45056
    ds_read_b64_tr_b16 v[46:47], v20 offset:46080
    s_mov_b64 exec, s[22:23]
    s_add_u32 m0, s35, 114688
    s_mul_i32 s51, s32, 245760
    s_add_u32 s51, s51, s34
    buffer_load_dwordx4 v48, s[12:15], s51 offen offset:0 lds
    buffer_load_dwordx4 v49, s[12:15], s51 offen offset:1024 lds
    buffer_load_dwordx4 v50, s[12:15], s51 offen offset:2048 lds
    buffer_load_dwordx4 v51, s[12:15], s51 offen offset:3072 lds
    s_mov_b64 exec, -1
    s_add_u32 m0, s35, 98304
    s_lshl_b32 s50, s32, 7
    s_add_u32 s50, s50, s33
    s_waitcnt lgkmcnt(0)
    buffer_load_dwordx4 v52, s[8:11], s50 offen offset:0 lds
    buffer_load_dwordx4 v53, s[8:11], s50 offen offset:1024 lds
    buffer_load_dwordx4 v54, s[8:11], s50 offen offset:2048 lds
    buffer_load_dwordx4 v55, s[8:11], s50 offen offset:3072 lds
    s_setprio 3
    v_mfma_f32_4x4x4_16b_bf16 v[112:115], v[56:57], v[32:33], v[112:115]
    v_mfma_f32_4x4x4_16b_bf16 v[116:119], v[56:57], v[34:35], v[116:119]
    v_mfma_f32_4x4x4_16b_bf16 v[120:123], v[56:57], v[36:37], v[120:123]
    v_mfma_f32_4x4x4_16b_bf16 v[124:127], v[56:57], v[38:39], v[124:127]
    v_mfma_f32_4x4x4_16b_bf16 v[112:115], v[56:57], v[40:41], v[112:115]
    v_mfma_f32_4x4x4_16b_bf16 v[116:119], v[56:57], v[42:43], v[116:119]
    v_mfma_f32_4x4x4_16b_bf16 v[120:123], v[56:57], v[44:45], v[120:123]
    v_mfma_f32_4x4x4_16b_bf16 v[124:127], v[56:57], v[46:47], v[124:127]
    s_setprio 0
    s_add_u32 s32, s32, 1
    s_cmp_eq_u32 s32, 10
    s_cselect_b32 s32, 0, s32
    s_mov_b32 s4, s96
    s_and_b32 s5, s97, 0xffff
    s_mov_b32 s6, 268435456
    s_mov_b32 s7, 0x20000
    s_mov_b32 s24, s30
    s_and_b32 s25, s31, 0xffff
    s_mov_b32 s26, 256
    s_mov_b32 s27, 0x20000
    s_getreg_b32 s29, hwreg(HW_REG_XCC_ID)
    s_and_b32 s29, s29, 15
    s_or_b32 s29, s29, 0x80
    v_and_b32 v4, 3, v1
    v_bfe_u32 v12, v1, 3, 1
    v_lshl_or_b32 v4, v12, 2, v4
    v_bfe_u32 v12, v1, 2, 1
    v_lshl_or_b32 v4, v12, 3, v4
    v_and_b32 v12, 16, v1
    v_or_b32 v4, v4, v12
    v_xor_b32 v4, 264, v4
    v_lshlrev_b32 v4, 3, v4
    v_lshlrev_b32 v12, 7, v5
    v_xor_b32 v3, v12, v2
    s_waitcnt vmcnt(8)
    s_barrier
    ds_read_b64_tr_b16 v[32:33], v21 offset:0
    ds_read_b64_tr_b16 v[34:35], v21 offset:1024
    ds_read_b64_tr_b16 v[36:37], v21 offset:4096
    ds_read_b64_tr_b16 v[38:39], v21 offset:5120
    ds_read_b64_tr_b16 v[40:41], v21 offset:8192
    ds_read_b64_tr_b16 v[42:43], v21 offset:9216
    ds_read_b64_tr_b16 v[44:45], v21 offset:12288
    ds_read_b64_tr_b16 v[46:47], v21 offset:13312
    s_mov_b64 exec, s[22:23]
    s_add_u32 m0, s35, 16384
    s_mul_i32 s51, s32, 245760
    s_add_u32 s51, s51, s34
    buffer_load_dwordx4 v48, s[12:15], s51 offen offset:0 lds
    buffer_load_dwordx4 v49, s[12:15], s51 offen offset:1024 lds
    buffer_load_dwordx4 v50, s[12:15], s51 offen offset:2048 lds
    buffer_load_dwordx4 v51, s[12:15], s51 offen offset:3072 lds
    s_mov_b64 exec, -1
    s_add_u32 m0, s35, 0
    s_lshl_b32 s50, s32, 7
    s_add_u32 s50, s50, s33
    s_waitcnt lgkmcnt(0)
    buffer_load_dwordx4 v52, s[8:11], s50 offen offset:0 lds
    buffer_load_dwordx4 v53, s[8:11], s50 offen offset:1024 lds
    buffer_load_dwordx4 v54, s[8:11], s50 offen offset:2048 lds
    buffer_load_dwordx4 v55, s[8:11], s50 offen offset:3072 lds
    s_setprio 3
    v_mfma_f32_4x4x4_16b_bf16 v[112:115], v[56:57], v[32:33], v[112:115]
    v_mfma_f32_4x4x4_16b_bf16 v[116:119], v[56:57], v[34:35], v[116:119]
    v_mfma_f32_4x4x4_16b_bf16 v[120:123], v[56:57], v[36:37], v[120:123]
    v_mfma_f32_4x4x4_16b_bf16 v[124:127], v[56:57], v[38:39], v[124:127]
    v_mfma_f32_4x4x4_16b_bf16 v[112:115], v[56:57], v[40:41], v[112:115]
    v_mfma_f32_4x4x4_16b_bf16 v[116:119], v[56:57], v[42:43], v[116:119]
    v_mfma_f32_4x4x4_16b_bf16 v[120:123], v[56:57], v[44:45], v[120:123]
    v_mfma_f32_4x4x4_16b_bf16 v[124:127], v[56:57], v[46:47], v[124:127]
    s_setprio 0
    s_add_u32 s32, s32, 1
    s_cmp_eq_u32 s32, 10
    s_cselect_b32 s32, 0, s32
    v_mul_u32_u24 v12, 384, v5
    v_lshl_add_u32 v12, v9, 4, v12
    v_mov_b32 v13, 1073741824
    v_cmp_gt_u32 vcc, 24, v9
    s_mul_i32 s54, s36, 163840
    s_add_u32 s54, s54, 2097152
    v_cndmask_b32 v12, v13, v12, vcc
    s_movk_i32 s55, 3072
    s_lshl_b32 s56, s38, 10
    s_cmp_eq_u32 s38, 3
    s_cselect_b64 vcc, -1, 0
    s_cselect_b32 s55, 768, s55
    s_cselect_b32 s56, 15360, s56
    s_add_u32 s54, s54, s56
    v_cndmask_b32 v31, v2, v12, vcc
    s_lshr_b32 s56, 0x77f, s37
    s_and_b32 s56, s56, 1
    s_cselect_b32 s54, s54, 1073741824
    s_add_u32 s56, s32, 2
    s_sub_u32 s57, s32, 8
    s_cselect_b32 s57, s56, s57
    s_lshl_b32 s50, s57, 2
    s_add_u32 s50, s50, 0
    s_mul_i32 s51, s50, 0x3334
    s_lshr_b32 s51, s51, 16
    s_mul_i32 s52, s51, 5
    s_sub_u32 s50, s50, s52
    s_mul_i32 s50, s50, s55
    s_mul_i32 s51, s51, 20480
    s_add_u32 s50, s50, s51
    s_add_u32 s44, s50, s54
    s_lshl_b32 s50, s57, 2
    s_add_u32 s50, s50, 1
    s_mul_i32 s51, s50, 0x3334
    s_lshr_b32 s51, s51, 16
    s_mul_i32 s52, s51, 5
    s_sub_u32 s50, s50, s52
    s_mul_i32 s50, s50, s55
    s_mul_i32 s51, s51, 20480
    s_add_u32 s50, s50, s51
    s_add_u32 s45, s50, s54
    s_lshl_b32 s50, s57, 2
    s_add_u32 s50, s50, 2
    s_mul_i32 s51, s50, 0x3334
    s_lshr_b32 s51, s51, 16
    s_mul_i32 s52, s51, 5
    s_sub_u32 s50, s50, s52
    s_mul_i32 s50, s50, s55
    s_mul_i32 s51, s51, 20480
    s_add_u32 s50, s50, s51
    s_add_u32 s46, s50, s54
    s_lshl_b32 s50, s57, 2
    s_add_u32 s50, s50, 3
    s_mul_i32 s51, s50, 0x3334
    s_lshr_b32 s51, s51, 16
    s_mul_i32 s52, s51, 5
    s_sub_u32 s50, s50, s52
    s_mul_i32 s50, s50, s55
    s_mul_i32 s51, s51, 20480
    s_add_u32 s50, s50, s51
    s_add_u32 s47, s50, s54
    v_and_b32 v26, 7, v1
    v_lshlrev_b32 v26, 2, v26
    s_waitcnt vmcnt(8)
    s_barrier
    ds_read_b64_tr_b16 v[32:33], v21 offset:32768
    ds_read_b64_tr_b16 v[34:35], v21 offset:33792
    ds_read_b64_tr_b16 v[36:37], v21 offset:36864
    ds_read_b64_tr_b16 v[38:39], v21 offset:37888
    ds_read_b64_tr_b16 v[40:41], v21 offset:40960
    ds_read_b64_tr_b16 v[42:43], v21 offset:41984
    ds_read_b64_tr_b16 v[44:45], v21 offset:45056
    ds_read_b64_tr_b16 v[46:47], v21 offset:46080
    s_mov_b64 exec, s[22:23]
    s_add_u32 m0, s35, 49152
    s_mul_i32 s51, s32, 245760
    s_add_u32 s51, s51, s34
    buffer_load_dwordx4 v48, s[12:15], s51 offen offset:0 lds
    buffer_load_dwordx4 v49, s[12:15], s51 offen offset:1024 lds
    buffer_load_dwordx4 v50, s[12:15], s51 offen offset:2048 lds
    buffer_load_dwordx4 v51, s[12:15], s51 offen offset:3072 lds
    s_mov_b64 exec, -1
    s_add_u32 m0, s35, 32768
    s_lshl_b32 s50, s32, 7
    s_add_u32 s50, s50, s33
    s_waitcnt lgkmcnt(0)
    buffer_load_dwordx4 v52, s[8:11], s50 offen offset:0 lds
    buffer_load_dwordx4 v53, s[8:11], s50 offen offset:1024 lds
    buffer_load_dwordx4 v54, s[8:11], s50 offen offset:2048 lds
    buffer_load_dwordx4 v55, s[8:11], s50 offen offset:3072 lds
    s_setprio 3
    v_mfma_f32_4x4x4_16b_bf16 v[112:115], v[56:57], v[32:33], v[112:115]
    v_mfma_f32_4x4x4_16b_bf16 v[116:119], v[56:57], v[34:35], v[116:119]
    v_mfma_f32_4x4x4_16b_bf16 v[120:123], v[56:57], v[36:37], v[120:123]
    v_mfma_f32_4x4x4_16b_bf16 v[124:127], v[56:57], v[38:39], v[124:127]
    v_mfma_f32_4x4x4_16b_bf16 v[112:115], v[56:57], v[40:41], v[112:115]
    v_mfma_f32_4x4x4_16b_bf16 v[116:119], v[56:57], v[42:43], v[116:119]
    v_mfma_f32_4x4x4_16b_bf16 v[120:123], v[56:57], v[44:45], v[120:123]
    v_mfma_f32_4x4x4_16b_bf16 v[124:127], v[56:57], v[46:47], v[124:127]
    s_setprio 0
    s_add_u32 s32, s32, 1
    s_cmp_eq_u32 s32, 10
    s_cselect_b32 s32, 0, s32
    s_waitcnt vmcnt(8)
    s_barrier
    ds_read_b64_tr_b16 v[32:33], v20 offset:0
    ds_read_b64_tr_b16 v[34:35], v20 offset:1024
    ds_read_b64_tr_b16 v[36:37], v20 offset:4096
    ds_read_b64_tr_b16 v[38:39], v20 offset:5120
    ds_read_b64_tr_b16 v[40:41], v20 offset:8192
    ds_read_b64_tr_b16 v[42:43], v20 offset:9216
    ds_read_b64_tr_b16 v[44:45], v20 offset:12288
    ds_read_b64_tr_b16 v[46:47], v20 offset:13312
    s_mov_b64 exec, s[22:23]
    s_add_u32 m0, s35, 81920
    s_mul_i32 s51, s32, 245760
    s_add_u32 s51, s51, s34
    buffer_load_dwordx4 v48, s[12:15], s51 offen offset:0 lds
    buffer_load_dwordx4 v49, s[12:15], s51 offen offset:1024 lds
    buffer_load_dwordx4 v50, s[12:15], s51 offen offset:2048 lds
    buffer_load_dwordx4 v51, s[12:15], s51 offen offset:3072 lds
    s_mov_b64 exec, -1
    s_add_u32 m0, s35, 65536
    s_lshl_b32 s50, s32, 7
    s_add_u32 s50, s50, s33
    s_waitcnt lgkmcnt(0)
    buffer_load_dwordx4 v52, s[8:11], s50 offen offset:0 lds
    buffer_load_dwordx4 v53, s[8:11], s50 offen offset:1024 lds
    buffer_load_dwordx4 v54, s[8:11], s50 offen offset:2048 lds
    buffer_load_dwordx4 v55, s[8:11], s50 offen offset:3072 lds
    s_setprio 3
    v_mfma_f32_4x4x4_16b_bf16 v[112:115], v[56:57], v[32:33], v[112:115]
    v_mfma_f32_4x4x4_16b_bf16 v[116:119], v[56:57], v[34:35], v[116:119]
    v_mfma_f32_4x4x4_16b_bf16 v[120:123], v[56:57], v[36:37], v[120:123]
    v_mfma_f32_4x4x4_16b_bf16 v[124:127], v[56:57], v[38:39], v[124:127]
    v_mfma_f32_4x4x4_16b_bf16 v[112:115], v[56:57], v[40:41], v[112:115]
    v_mfma_f32_4x4x4_16b_bf16 v[116:119], v[56:57], v[42:43], v[116:119]
    v_mfma_f32_4x4x4_16b_bf16 v[120:123], v[56:57], v[44:45], v[120:123]
    v_mfma_f32_4x4x4_16b_bf16 v[124:127], v[56:57], v[46:47], v[124:127]
    s_setprio 0
    s_add_u32 s32, s32, 1
    s_cmp_eq_u32 s32, 10
    s_cselect_b32 s32, 0, s32
    s_waitcnt vmcnt(8)
    s_barrier
    ds_read_b64_tr_b16 v[32:33], v20 offset:32768
    ds_read_b64_tr_b16 v[34:35], v20 offset:33792
    ds_read_b64_tr_b16 v[36:37], v20 offset:36864
    ds_read_b64_tr_b16 v[38:39], v20 offset:37888
    ds_read_b64_tr_b16 v[40:41], v20 offset:40960
    ds_read_b64_tr_b16 v[42:43], v20 offset:41984
    ds_read_b64_tr_b16 v[44:45], v20 offset:45056
    ds_read_b64_tr_b16 v[46:47], v20 offset:46080
    s_mov_b64 exec, s[22:23]
    s_add_u32 m0, s35, 114688
    s_mul_i32 s51, s32, 245760
    s_add_u32 s51, s51, s34
    buffer_load_dwordx4 v48, s[12:15], s51 offen offset:0 lds
    buffer_load_dwordx4 v49, s[12:15], s51 offen offset:1024 lds
    buffer_load_dwordx4 v50, s[12:15], s51 offen offset:2048 lds
    buffer_load_dwordx4 v51, s[12:15], s51 offen offset:3072 lds
    s_mov_b64 exec, -1
    s_add_u32 m0, s35, 98304
    s_lshl_b32 s50, s32, 7
    s_add_u32 s50, s50, s33
    s_waitcnt lgkmcnt(0)
    buffer_load_dwordx4 v52, s[8:11], s50 offen offset:0 lds
    buffer_load_dwordx4 v53, s[8:11], s50 offen offset:1024 lds
    buffer_load_dwordx4 v54, s[8:11], s50 offen offset:2048 lds
    buffer_load_dwordx4 v55, s[8:11], s50 offen offset:3072 lds
    s_setprio 3
    v_mfma_f32_4x4x4_16b_bf16 v[112:115], v[56:57], v[32:33], v[112:115]
    v_mfma_f32_4x4x4_16b_bf16 v[116:119], v[56:57], v[34:35], v[116:119]
    v_mfma_f32_4x4x4_16b_bf16 v[120:123], v[56:57], v[36:37], v[120:123]
    v_mfma_f32_4x4x4_16b_bf16 v[124:127], v[56:57], v[38:39], v[124:127]
    v_mfma_f32_4x4x4_16b_bf16 v[112:115], v[56:57], v[40:41], v[112:115]
    v_mfma_f32_4x4x4_16b_bf16 v[116:119], v[56:57], v[42:43], v[116:119]
    v_mfma_f32_4x4x4_16b_bf16 v[120:123], v[56:57], v[44:45], v[120:123]
    v_mfma_f32_4x4x4_16b_bf16 v[124:127], v[56:57], v[46:47], v[124:127]
    s_setprio 0
    s_add_u32 s32, s32, 1
    s_cmp_eq_u32 s32, 10
    s_cselect_b32 s32, 0, s32
    s_waitcnt vmcnt(8)
    s_barrier
    ds_read_b64_tr_b16 v[32:33], v21 offset:0
    ds_read_b64_tr_b16 v[34:35], v21 offset:1024
    ds_read_b64_tr_b16 v[36:37], v21 offset:4096
    ds_read_b64_tr_b16 v[38:39], v21 offset:5120
    ds_read_b64_tr_b16 v[40:41], v21 offset:8192
    ds_read_b64_tr_b16 v[42:43], v21 offset:9216
    ds_read_b64_tr_b16 v[44:45], v21 offset:12288
    ds_read_b64_tr_b16 v[46:47], v21 offset:13312
    s_mov_b64 exec, s[22:23]
    s_add_u32 m0, s35, 16384
    s_mul_i32 s51, s32, 245760
    s_add_u32 s51, s51, s34
    buffer_load_dwordx4 v48, s[12:15], s51 offen offset:0 lds
    buffer_load_dwordx4 v49, s[12:15], s51 offen offset:1024 lds
    buffer_load_dwordx4 v50, s[12:15], s51 offen offset:2048 lds
    buffer_load_dwordx4 v51, s[12:15], s51 offen offset:3072 lds
    s_mov_b64 exec, -1
    s_add_u32 m0, s35, 0
    s_lshl_b32 s50, s32, 7
    s_add_u32 s50, s50, s33
    s_waitcnt lgkmcnt(0)
    buffer_load_dwordx4 v52, s[8:11], s50 offen offset:0 lds
    buffer_load_dwordx4 v53, s[8:11], s50 offen offset:1024 lds
    buffer_load_dwordx4 v54, s[8:11], s50 offen offset:2048 lds
    buffer_load_dwordx4 v55, s[8:11], s50 offen offset:3072 lds
    s_setprio 3
    v_mfma_f32_4x4x4_16b_bf16 v[112:115], v[56:57], v[32:33], v[112:115]
    v_mfma_f32_4x4x4_16b_bf16 v[116:119], v[56:57], v[34:35], v[116:119]
    v_mfma_f32_4x4x4_16b_bf16 v[120:123], v[56:57], v[36:37], v[120:123]
    v_mfma_f32_4x4x4_16b_bf16 v[124:127], v[56:57], v[38:39], v[124:127]
    v_mfma_f32_4x4x4_16b_bf16 v[112:115], v[56:57], v[40:41], v[112:115]
    v_mfma_f32_4x4x4_16b_bf16 v[116:119], v[56:57], v[42:43], v[116:119]
    v_mfma_f32_4x4x4_16b_bf16 v[120:123], v[56:57], v[44:45], v[120:123]
    v_mfma_f32_4x4x4_16b_bf16 v[124:127], v[56:57], v[46:47], v[124:127]
    s_setprio 0
    s_add_u32 s32, s32, 1
    s_cmp_eq_u32 s32, 10
    s_cselect_b32 s32, 0, s32
    s_waitcnt vmcnt(8)
    s_barrier
    ds_read_b64_tr_b16 v[32:33], v21 offset:32768
    ds_read_b64_tr_b16 v[34:35], v21 offset:33792
    ds_read_b64_tr_b16 v[36:37], v21 offset:36864
    ds_read_b64_tr_b16 v[38:39], v21 offset:37888
    ds_read_b64_tr_b16 v[40:41], v21 offset:40960
    ds_read_b64_tr_b16 v[42:43], v21 offset:41984
    ds_read_b64_tr_b16 v[44:45], v21 offset:45056
    ds_read_b64_tr_b16 v[46:47], v21 offset:46080
    s_mov_b64 exec, s[22:23]
    s_add_u32 m0, s35, 49152
    s_mul_i32 s51, s32, 245760
    s_add_u32 s51, s51, s34
    buffer_load_dwordx4 v48, s[12:15], s51 offen offset:0 lds
    buffer_load_dwordx4 v49, s[12:15], s51 offen offset:1024 lds
    buffer_load_dwordx4 v50, s[12:15], s51 offen offset:2048 lds
    buffer_load_dwordx4 v51, s[12:15], s51 offen offset:3072 lds
    s_mov_b64 exec, -1
    s_add_u32 m0, s35, 32768
    s_lshl_b32 s50, s32, 7
    s_add_u32 s50, s50, s33
    s_waitcnt lgkmcnt(0)
    buffer_load_dwordx4 v52, s[8:11], s50 offen offset:0 lds
    buffer_load_dwordx4 v53, s[8:11], s50 offen offset:1024 lds
    buffer_load_dwordx4 v54, s[8:11], s50 offen offset:2048 lds
    buffer_load_dwordx4 v55, s[8:11], s50 offen offset:3072 lds
    s_setprio 3
    v_mfma_f32_4x4x4_16b_bf16 v[112:115], v[56:57], v[32:33], v[112:115]
    v_mfma_f32_4x4x4_16b_bf16 v[116:119], v[56:57], v[34:35], v[116:119]
    v_mfma_f32_4x4x4_16b_bf16 v[120:123], v[56:57], v[36:37], v[120:123]
    v_mfma_f32_4x4x4_16b_bf16 v[124:127], v[56:57], v[38:39], v[124:127]
    v_mfma_f32_4x4x4_16b_bf16 v[112:115], v[56:57], v[40:41], v[112:115]
    v_mfma_f32_4x4x4_16b_bf16 v[116:119], v[56:57], v[42:43], v[116:119]
    v_mfma_f32_4x4x4_16b_bf16 v[120:123], v[56:57], v[44:45], v[120:123]
    v_mfma_f32_4x4x4_16b_bf16 v[124:127], v[56:57], v[46:47], v[124:127]
    s_setprio 0
    buffer_load_dword v27, v26, s[24:27], 0 offen sc0 sc1
    buffer_store_dwordx4 v[32:35], v31, s[4:7], s44 offen sc0 sc1
    buffer_store_dwordx4 v[36:39], v31, s[4:7], s45 offen sc0 sc1
    buffer_store_dwordx4 v[40:43], v31, s[4:7], s46 offen sc0 sc1
    buffer_store_dwordx4 v[44:47], v31, s[4:7], s47 offen sc0 sc1
    s_waitcnt vmcnt(13)
    s_barrier
    ds_read_b64_tr_b16 v[32:33], v20 offset:0
    ds_read_b64_tr_b16 v[34:35], v20 offset:1024
    ds_read_b64_tr_b16 v[36:37], v20 offset:4096
    ds_read_b64_tr_b16 v[38:39], v20 offset:5120
    ds_read_b64_tr_b16 v[40:41], v20 offset:8192
    ds_read_b64_tr_b16 v[42:43], v20 offset:9216
    ds_read_b64_tr_b16 v[44:45], v20 offset:12288
    ds_read_b64_tr_b16 v[46:47], v20 offset:13312
    s_waitcnt lgkmcnt(0)
    s_setprio 3
    v_mfma_f32_4x4x4_16b_bf16 v[112:115], v[56:57], v[32:33], v[112:115]
    v_mfma_f32_4x4x4_16b_bf16 v[116:119], v[56:57], v[34:35], v[116:119]
    v_mfma_f32_4x4x4_16b_bf16 v[120:123], v[56:57], v[36:37], v[120:123]
    v_mfma_f32_4x4x4_16b_bf16 v[124:127], v[56:57], v[38:39], v[124:127]
    v_mfma_f32_4x4x4_16b_bf16 v[112:115], v[56:57], v[40:41], v[112:115]
    v_mfma_f32_4x4x4_16b_bf16 v[116:119], v[56:57], v[42:43], v[116:119]
    v_mfma_f32_4x4x4_16b_bf16 v[120:123], v[56:57], v[44:45], v[120:123]
    v_mfma_f32_4x4x4_16b_bf16 v[124:127], v[56:57], v[46:47], v[124:127]
    s_waitcnt vmcnt(4)
    s_barrier
    ds_read_b64_tr_b16 v[32:33], v20 offset:32768
    ds_read_b64_tr_b16 v[34:35], v20 offset:33792
    ds_read_b64_tr_b16 v[36:37], v20 offset:36864
    ds_read_b64_tr_b16 v[38:39], v20 offset:37888
    ds_read_b64_tr_b16 v[40:41], v20 offset:40960
    ds_read_b64_tr_b16 v[42:43], v20 offset:41984
    ds_read_b64_tr_b16 v[44:45], v20 offset:45056
    ds_read_b64_tr_b16 v[46:47], v20 offset:46080
    s_waitcnt lgkmcnt(0)
    s_setprio 3
    v_mfma_f32_4x4x4_16b_bf16 v[112:115], v[56:57], v[32:33], v[112:115]
    v_mfma_f32_4x4x4_16b_bf16 v[116:119], v[56:57], v[34:35], v[116:119]
    v_mfma_f32_4x4x4_16b_bf16 v[120:123], v[56:57], v[36:37], v[120:123]
    v_mfma_f32_4x4x4_16b_bf16 v[124:127], v[56:57], v[38:39], v[124:127]
    v_mfma_f32_4x4x4_16b_bf16 v[112:115], v[56:57], v[40:41], v[112:115]
    v_mfma_f32_4x4x4_16b_bf16 v[116:119], v[56:57], v[42:43], v[116:119]
    v_mfma_f32_4x4x4_16b_bf16 v[120:123], v[56:57], v[44:45], v[120:123]
    v_mfma_f32_4x4x4_16b_bf16 v[124:127], v[56:57], v[46:47], v[124:127]
    s_nop 7
    v_add_f32 v112, v112, v116
    v_add_f32 v120, v120, v124
    v_add_f32 v112, v112, v120
    v_mov_b32 v113, v112
    s_nop 1
    v_permlane32_swap_b32 v112, v113
    s_nop 1
    v_add_f32 v112, v112, v113
    v_and_b32 v13, 0xffff0000, v112
    v_sub_f32 v15, v112, v13
    v_lshrrev_b32 v14, 16, v13
    v_cmp_gt_u32 vcc, 32, v1
    v_or_b32 v14, v14, v13
    v_lshrrev_b32 v15, 16, v15
    v_cndmask_b32 v14, 0, v14, vcc
    v_cndmask_b32 v15, 0, v15, vcc
    s_lshl_b32 s56, s38, 9
    v_lshlrev_b32 v13, 3, v1
    v_add_u32 v13, s56, v13
    v_add_u32 v25, 131072, v13
    ds_write_b64 v25, v[14:15]
    s_mov_b32 s57, 0x100000
L_dbg_poll:
    v_cmp_eq_u32 vcc, 0, v27
    s_cbranch_vccz L_dbg_done
    s_sub_u32 s57, s57, 1
    s_cbranch_scc1 L_dbg_done
    buffer_load_dword v27, v26, s[24:27], 0 offen sc0 sc1
    s_waitcnt vmcnt(0)
    s_branch L_dbg_poll
L_dbg_done:
    s_waitcnt lgkmcnt(0)
    s_barrier
    s_cmp_lg_u32 s16, 7
    s_cbranch_scc1 L_noxcc
    s_lshl_b32 s57, s17, 5
    s_add_u32 s57, s57, s18
    s_lshl_b32 s57, s57, 2
    s_add_u32 s57, s57, 1024
    v_mov_b32 v30, s29
    s_mov_b64 exec, 1
    buffer_store_dword v30, v2, s[4:7], s57 offen sc0 sc1
    s_mov_b64 exec, -1
L_noxcc:
    s_cmp_lg_u32 s37, 0
    s_cbranch_scc1 L_noaux_5
    s_lshl_b32 s56, s36, 11
    s_add_u32 s56, s56, 262144
    buffer_store_dwordx2 v[14:15], v13, s[4:7], s56 offen sc0 sc1
L_noaux_5:
    s_setprio 0
    s_mov_b32 s25, 0
    s_mov_b32 s28, 0
    s_branch L_layer
L_front_compute:
    v_lshrrev_b32 v5, 5, v1
    v_lshlrev_b32 v2, 4, v1
    v_bfe_u32 v6, v1, 4, 1
    v_bfe_u32 v7, v1, 2, 2
    v_and_b32 v8, 1, v1
    v_lshlrev_b32 v8, 1, v8
    v_bfe_u32 v9, v1, 1, 1
    v_or_b32 v8, v8, v9
    v_and_b32 v9, 31, v1
    v_lshl_add_u32 v10, v5, 3, v7
    v_mov_b32 v11, 0x3f803f80
    v_lshrrev_b32 v12, 2, v1
    v_lshlrev_b32 v12, 10, v12
    v_and_b32 v13, 3, v1
    v_lshl_add_u32 v12, v13, 6, v12
    s_lshl_b32 s50, s38, 15
    s_add_u32 s50, s50, 17184
    v_add_u32 v12, s50, v12
    v_mov_b32 v16, v11
    v_mov_b32 v17, v11
    ds_write_b64 v12, v[16:17]
    ds_write_b64 v12, v[16:17] offset:8
    s_waitcnt lgkmcnt(0)
    s_mov_b32 s4, s96
    s_and_b32 s5, s97, 0xffff
    s_mov_b32 s6, 268435456
    s_mov_b32 s7, 0x20000
    s_mov_b32 s24, s30
    s_and_b32 s25, s31, 0xffff
    s_mov_b32 s26, 256
    s_mov_b32 s27, 0x20000
    s_getreg_b32 s29, hwreg(HW_REG_XCC_ID)
    s_and_b32 s29, s29, 15
    s_or_b32 s29, s29, 0x80
    v_and_b32 v4, 3, v1
    v_bfe_u32 v12, v1, 3, 1
    v_lshl_or_b32 v4, v12, 2, v4
    v_bfe_u32 v12, v1, 2, 1
    v_lshl_or_b32 v4, v12, 3, v4
    v_and_b32 v12, 16, v1
    v_or_b32 v4, v4, v12
    v_xor_b32 v4, 264, v4
    v_lshlrev_b32 v4, 3, v4
    v_lshlrev_b32 v12, 7, v5
    v_xor_b32 v3, v12, v2
    s_cmp_lg_u32 s16, 1
    s_cbranch_scc1 L_nocw
    s_getpc_b64 s[88:89]
L_cw_pc:
    s_sub_u32 s88, s88, L_cw_pc-interleave_layers__softmax_full_mha__mixer_channel_mlp__prompt_kernel
    s_subb_u32 s89, s89, 0
    s_and_b32 s89, s89, 0xffff
    s_mov_b32 s90, L_code_end-interleave_layers__softmax_full_mha__mixer_channel_mlp__prompt_kernel
    s_mov_b32 s91, 0x20000
    s_lshl_b32 s50, s18, 7
    v_lshlrev_b32 v12, 12, v1
    s_mov_b64 exec, 0xffff
    buffer_load_dword v18, v12, s[88:91], s50 offen
    s_mov_b64 exec, -1
L_nocw:
    s_cmp_lg_u32 s16, 3
    s_cbranch_scc1 L_nozero
    s_cmp_lg_u32 s18, 0
    s_cbranch_scc1 L_nozero
    v_mov_b32 v16, 0
    v_mov_b32 v17, 0
    v_mov_b32 v18, 0
    v_mov_b32 v19, 0
    s_mul_i32 s50, s17, 1179648
    s_add_u32 s50, s50, 11304960
    s_add_u32 s51, s50, 4096
    s_lshl_b32 s52, s17, 13
    s_add_u32 s52, s52, 65536
    s_lshl_b32 s53, s17, 8
    v_lshlrev_b32 v12, 7, v1
    v_lshlrev_b32 v13, 2, v1
    buffer_store_dwordx4 v[16:19], v2, s[4:7], s50 offen offset:0 sc0 sc1
    buffer_store_dwordx4 v[16:19], v2, s[4:7], s50 offen offset:1024 sc0 sc1
    buffer_store_dwordx4 v[16:19], v2, s[4:7], s50 offen offset:2048 sc0 sc1
    buffer_store_dwordx4 v[16:19], v2, s[4:7], s50 offen offset:3072 sc0 sc1
    buffer_store_dwordx4 v[16:19], v2, s[4:7], s51 offen offset:0 sc0 sc1
    buffer_store_dwordx4 v[16:19], v2, s[4:7], s51 offen offset:1024 sc0 sc1
    buffer_store_dwordx4 v[16:19], v2, s[4:7], s51 offen offset:2048 sc0 sc1
    buffer_store_dwordx4 v[16:19], v2, s[4:7], s51 offen offset:3072 sc0 sc1
    s_add_u32 s54, s52, 4096
    buffer_store_dwordx4 v[16:19], v2, s[4:7], s52 offen offset:0 sc0 sc1
    buffer_store_dwordx4 v[16:19], v2, s[4:7], s52 offen offset:1024 sc0 sc1
    buffer_store_dwordx4 v[16:19], v2, s[4:7], s52 offen offset:2048 sc0 sc1
    buffer_store_dwordx4 v[16:19], v2, s[4:7], s52 offen offset:3072 sc0 sc1
    buffer_store_dwordx4 v[16:19], v2, s[4:7], s54 offen offset:0 sc0 sc1
    buffer_store_dwordx4 v[16:19], v2, s[4:7], s54 offen offset:1024 sc0 sc1
    buffer_store_dwordx4 v[16:19], v2, s[4:7], s54 offen offset:2048 sc0 sc1
    buffer_store_dwordx4 v[16:19], v2, s[4:7], s54 offen offset:3072 sc0 sc1
    buffer_store_dword v16, v13, s[4:7], s53 offen sc0 sc1
L_nozero:
    s_mov_b32 s8, s84
    s_and_b32 s9, s85, 0xffff
    s_mov_b32 s10, 2621440
    s_mov_b32 s11, 0x20000
    s_mov_b32 s12, s86
    s_and_b32 s13, s87, 0xffff
    s_mov_b32 s14, 2457600
    s_mov_b32 s15, 0x20000
    s_mov_b32 s21, 19922944
    s_lshl_b32 s50, s38, 12
    v_lshlrev_b32 v14, 7, v9
    v_add_u32 v14, s50, v14
    v_bfe_u32 v13, v9, 1, 3
    v_xor_b32 v13, v13, v5
    v_xor_b32 v12, 0, v13
    v_lshl_add_u32 v128, v12, 4, v14
    v_add_u32 v132, 65536, v128
    v_xor_b32 v12, 2, v13
    v_lshl_add_u32 v129, v12, 4, v14
    v_add_u32 v133, 65536, v129
    v_xor_b32 v12, 4, v13
    v_lshl_add_u32 v130, v12, 4, v14
    v_add_u32 v134, 65536, v130
    v_xor_b32 v12, 6, v13
    v_lshl_add_u32 v131, v12, 4, v14
    v_add_u32 v135, 65536, v131
    v_mul_u32_u24 v12, 5, v6
    v_add_u32 v12, v12, v8
    v_and_b32 v13, 14, v12
    v_mov_b32 v14, 0x3b4
    v_bfe_u32 v14, v14, v13, 2
    v_add_u32 v14, 0, v14
    v_and_b32 v14, 3, v14
    v_lshrrev_b32 v13, 3, v12
    v_mul_u32_u24 v13, 3, v13
    v_add_u32 v13, 0, v13
    v_and_b32 v12, 1, v12
    v_lshl_add_u32 v14, v7, 2, v14
    v_lshlrev_b32 v14, 4, v14
    v_lshl_add_u32 v14, v13, 8, v14
    v_lshl_add_u32 v14, v12, 3, v14
    v_lshl_add_u32 v14, v5, 11, v14
    v_add_u32 v136, 16384, v14
    v_add_u32 v140, 65536, v136
    v_mul_u32_u24 v12, 5, v6
    v_add_u32 v12, v12, v8
    v_and_b32 v13, 14, v12
    v_mov_b32 v14, 0x3b4
    v_bfe_u32 v14, v14, v13, 2
    v_add_u32 v14, 1, v14
    v_and_b32 v14, 3, v14
    v_lshrrev_b32 v13, 3, v12
    v_mul_u32_u24 v13, 2, v13
    v_add_u32 v13, 1, v13
    v_and_b32 v12, 1, v12
    v_lshl_add_u32 v14, v7, 2, v14
    v_lshlrev_b32 v14, 4, v14
    v_lshl_add_u32 v14, v13, 8, v14
    v_lshl_add_u32 v14, v12, 3, v14
    v_lshl_add_u32 v14, v5, 11, v14
    v_add_u32 v137, 16384, v14
    v_add_u32 v141, 65536, v137
    v_mul_u32_u24 v12, 5, v6
    v_add_u32 v12, v12, v8
    v_and_b32 v13, 14, v12
    v_mov_b32 v14, 0x3b4
    v_bfe_u32 v14, v14, v13, 2
    v_add_u32 v14, 2, v14
    v_and_b32 v14, 3, v14
    v_lshrrev_b32 v13, 3, v12
    v_mul_u32_u24 v13, 1, v13
    v_add_u32 v13, 2, v13
    v_and_b32 v12, 1, v12
    v_lshl_add_u32 v14, v7, 2, v14
    v_lshlrev_b32 v14, 4, v14
    v_lshl_add_u32 v14, v13, 8, v14
    v_lshl_add_u32 v14, v12, 3, v14
    v_lshl_add_u32 v14, v5, 11, v14
    v_add_u32 v138, 16384, v14
    v_add_u32 v142, 65536, v138
    v_and_b32 v12, 1, v1
    v_bfe_u32 v15, v1, 1, 1
    v_lshl_add_u32 v15, v6, 1, v15
    v_add_u32 v14, 3, v15
    v_and_b32 v14, 3, v14
    v_mul_u32_u24 v13, 3, v12
    v_max_u32 v13, v13, v15
    v_lshl_add_u32 v14, v7, 2, v14
    v_lshlrev_b32 v14, 4, v14
    v_lshl_add_u32 v14, v13, 8, v14
    v_lshl_add_u32 v14, v12, 3, v14
    v_lshl_add_u32 v14, v5, 11, v14
    v_add_u32 v139, 16384, v14
    v_add_u32 v143, 65536, v139
    s_mul_i32 s84, s40, 2560
    s_add_u32 s84, s84, s21
    s_mul_i32 s57, s36, 6
    s_add_u32 s57, s57, 0
    s_lshr_b32 s58, s57, 1
    s_add_u32 s58, s58, 32
    s_and_b32 s59, s57, 31
    s_cmp_lt_u32 s57, 32
    s_cselect_b32 s58, s58, s59
    s_mov_b32 s86, 163840
    s_cselect_b32 s88, 256, s86
    s_cselect_b32 s86, 1024, s86
    s_cselect_b32 s59, 0x3ea52b5c, 1.0
    v_mov_b32 v20, s59
    s_mul_i32 s58, s58, 163840
    s_add_u32 s58, s58, s84
    s_cmp_ge_u32 s57, 64
    s_cselect_b32 s85, 1024, 0
    s_cselect_b32 s87, 256, 0
    s_add_u32 s85, s85, s58
    s_add_u32 s87, s87, s58
    s_add_u32 s86, s86, s85
    v_mul_lo_u32 v26, s88, v5
    v_add_u32 v26, v26, v4
    s_mul_i32 s57, s36, 6
    s_add_u32 s57, s57, 2
    s_lshr_b32 s58, s57, 1
    s_add_u32 s58, s58, 32
    s_and_b32 s59, s57, 31
    s_cmp_lt_u32 s57, 32
    s_cselect_b32 s58, s58, s59
    s_mov_b32 s90, 163840
    s_cselect_b32 s92, 256, s90
    s_cselect_b32 s90, 1024, s90
    s_cselect_b32 s59, 0x3ea52b5c, 1.0
    v_mov_b32 v22, s59
    s_mul_i32 s58, s58, 163840
    s_add_u32 s58, s58, s84
    s_cmp_ge_u32 s57, 64
    s_cselect_b32 s89, 1024, 0
    s_cselect_b32 s91, 256, 0
    s_add_u32 s89, s89, s58
    s_add_u32 s91, s91, s58
    s_add_u32 s90, s90, s89
    v_mul_lo_u32 v27, s92, v5
    v_add_u32 v27, v27, v4
    s_mul_i32 s57, s36, 6
    s_add_u32 s57, s57, 4
    s_lshr_b32 s58, s57, 1
    s_add_u32 s58, s58, 32
    s_and_b32 s59, s57, 31
    s_cmp_lt_u32 s57, 32
    s_cselect_b32 s58, s58, s59
    s_mov_b32 s94, 163840
    s_cselect_b32 s96, 256, s94
    s_cselect_b32 s94, 1024, s94
    s_cselect_b32 s59, 0x3ea52b5c, 1.0
    v_mov_b32 v24, s59
    s_mul_i32 s58, s58, 163840
    s_add_u32 s58, s58, s84
    s_cmp_ge_u32 s57, 64
    s_cselect_b32 s93, 1024, 0
    s_cselect_b32 s95, 256, 0
    s_add_u32 s93, s93, s58
    s_add_u32 s95, s95, s58
    s_add_u32 s94, s94, s93
    v_mul_lo_u32 v28, s96, v5
    v_add_u32 v28, v28, v4
    v_lshlrev_b32 v30, 3, v1
    v_add_u32 v30, 131072, v30
    v_mov_b32 v160, 0
    v_mov_b32 v161, 0
    v_mov_b32 v144, 0
    v_mov_b32 v145, 1
    s_cmp_lg_u32 s16, 3
    s_cbranch_scc1 L_noann
    s_cmp_lg_u32 s18, 0
    s_cbranch_scc1 L_noann
    s_lshl_b32 s50, s17, 2
    s_waitcnt vmcnt(0)
    s_mov_b64 exec, 1
    buffer_store_dword v145, v144, s[24:27], s50 offen sc0 sc1
    s_mov_b64 exec, -1
L_noann:
    s_setprio 1
    s_barrier
    ds_read_b128 v[208:211], v128 offset:0
    ds_read_b64_tr_b16 v[48:49], v136 offset:0
    ds_read_b64_tr_b16 v[50:51], v136 offset:1024
    ds_read_b64_tr_b16 v[52:53], v137 offset:0
    ds_read_b64_tr_b16 v[54:55], v137 offset:1024
    ds_read_b64_tr_b16 v[56:57], v138 offset:0
    ds_read_b64_tr_b16 v[58:59], v138 offset:1024
    ds_read_b64_tr_b16 v[60:61], v139 offset:0
    ds_read_b64_tr_b16 v[62:63], v139 offset:1024
    ds_read_b128 v[212:215], v129 offset:0
    ds_read_b64_tr_b16 v[176:177], v136 offset:4096
    ds_read_b64_tr_b16 v[178:179], v136 offset:5120
    ds_read_b64_tr_b16 v[180:181], v137 offset:4096
    ds_read_b64_tr_b16 v[182:183], v137 offset:5120
    s_waitcnt lgkmcnt(11)
    v_mfma_f32_32x32x16_bf16 v[64:79], v[48:51], v[208:211], 0
    ds_read_b64_tr_b16 v[48:49], v138 offset:4096
    ds_read_b64_tr_b16 v[50:51], v138 offset:5120
    s_waitcnt lgkmcnt(11)
    v_mfma_f32_32x32x16_bf16 v[80:95], v[52:55], v[208:211], 0
    ds_read_b64_tr_b16 v[52:53], v139 offset:4096
    ds_read_b64_tr_b16 v[54:55], v139 offset:5120
    s_waitcnt lgkmcnt(11)
    v_mfma_f32_32x32x16_bf16 v[96:111], v[56:59], v[208:211], 0
    ds_read_b128 v[216:219], v130 offset:0
    ds_read_b64_tr_b16 v[56:57], v136 offset:8192
    ds_read_b64_tr_b16 v[58:59], v136 offset:9216
    s_waitcnt lgkmcnt(12)
    v_mfma_f32_32x32x16_bf16 v[112:127], v[60:63], v[208:211], 0
    ds_read_b64_tr_b16 v[60:61], v137 offset:8192
    ds_read_b64_tr_b16 v[62:63], v137 offset:9216
    s_waitcnt lgkmcnt(11)
    v_mfma_f32_32x32x16_bf16 v[64:79], v[176:179], v[212:215], v[64:79]
    ds_read_b64_tr_b16 v[176:177], v138 offset:8192
    ds_read_b64_tr_b16 v[178:179], v138 offset:9216
    s_waitcnt lgkmcnt(11)
    v_mfma_f32_32x32x16_bf16 v[80:95], v[180:183], v[212:215], v[80:95]
    ds_read_b64_tr_b16 v[180:181], v139 offset:8192
    ds_read_b64_tr_b16 v[182:183], v139 offset:9216
    s_waitcnt lgkmcnt(11)
    v_mfma_f32_32x32x16_bf16 v[96:111], v[48:51], v[212:215], v[96:111]
    ds_read_b128 v[220:223], v131 offset:0
    ds_read_b64_tr_b16 v[48:49], v136 offset:12288
    ds_read_b64_tr_b16 v[50:51], v136 offset:13312
    s_waitcnt lgkmcnt(12)
    v_mfma_f32_32x32x16_bf16 v[112:127], v[52:55], v[212:215], v[112:127]
    ds_read_b64_tr_b16 v[52:53], v137 offset:12288
    ds_read_b64_tr_b16 v[54:55], v137 offset:13312
    s_waitcnt lgkmcnt(11)
    v_mfma_f32_32x32x16_bf16 v[64:79], v[56:59], v[216:219], v[64:79]
    ds_read_b64_tr_b16 v[56:57], v138 offset:12288
    ds_read_b64_tr_b16 v[58:59], v138 offset:13312
    s_waitcnt lgkmcnt(11)
    v_mfma_f32_32x32x16_bf16 v[80:95], v[60:63], v[216:219], v[80:95]
    ds_read_b64_tr_b16 v[60:61], v139 offset:12288
    ds_read_b64_tr_b16 v[62:63], v139 offset:13312
    s_waitcnt lgkmcnt(11)
    v_mfma_f32_32x32x16_bf16 v[96:111], v[176:179], v[216:219], v[96:111]
    s_barrier
    ds_read_b128 v[224:227], v128 offset:32768
    ds_read_b64_tr_b16 v[176:177], v136 offset:32768
    ds_read_b64_tr_b16 v[178:179], v136 offset:33792
    s_waitcnt lgkmcnt(12)
    v_mfma_f32_32x32x16_bf16 v[112:127], v[180:183], v[216:219], v[112:127]
    ds_read_b64_tr_b16 v[180:181], v137 offset:32768
    ds_read_b64_tr_b16 v[182:183], v137 offset:33792
    s_waitcnt lgkmcnt(11)
    v_mfma_f32_32x32x16_bf16 v[64:79], v[48:51], v[220:223], v[64:79]
    ds_read_b64_tr_b16 v[48:49], v138 offset:32768
    ds_read_b64_tr_b16 v[50:51], v138 offset:33792
    s_waitcnt lgkmcnt(11)
    v_mfma_f32_32x32x16_bf16 v[80:95], v[52:55], v[220:223], v[80:95]
    ds_read_b64_tr_b16 v[52:53], v139 offset:32768
    ds_read_b64_tr_b16 v[54:55], v139 offset:33792
    v_mfma_f32_4x4x4_16b_bf16 v[160:163], v[208:209], v[208:209], 0
    v_mfma_f32_4x4x4_16b_bf16 v[164:167], v[210:211], v[210:211], 0
    v_mfma_f32_4x4x4_16b_bf16 v[168:171], v[212:213], v[212:213], 0
    v_mfma_f32_4x4x4_16b_bf16 v[172:175], v[214:215], v[214:215], 0
    v_mfma_f32_4x4x4_16b_bf16 v[160:163], v[216:217], v[216:217], v[160:163]
    v_mfma_f32_4x4x4_16b_bf16 v[164:167], v[218:219], v[218:219], v[164:167]
    v_mfma_f32_4x4x4_16b_bf16 v[168:171], v[220:221], v[220:221], v[168:171]
    v_mfma_f32_4x4x4_16b_bf16 v[172:175], v[222:223], v[222:223], v[172:175]
    s_waitcnt lgkmcnt(11)
    v_mfma_f32_32x32x16_bf16 v[96:111], v[56:59], v[220:223], v[96:111]
    ds_read_b128 v[228:231], v129 offset:32768
    ds_read_b64_tr_b16 v[56:57], v136 offset:36864
    ds_read_b64_tr_b16 v[58:59], v136 offset:37888
    s_waitcnt lgkmcnt(12)
    v_mfma_f32_32x32x16_bf16 v[112:127], v[60:63], v[220:223], v[112:127]
    ds_read_b64_tr_b16 v[60:61], v137 offset:36864
    ds_read_b64_tr_b16 v[62:63], v137 offset:37888
    s_waitcnt lgkmcnt(11)
    v_mfma_f32_32x32x16_bf16 v[64:79], v[176:179], v[224:227], v[64:79]
    ds_read_b64_tr_b16 v[176:177], v138 offset:36864
    ds_read_b64_tr_b16 v[178:179], v138 offset:37888
    s_waitcnt lgkmcnt(11)
    v_mfma_f32_32x32x16_bf16 v[80:95], v[180:183], v[224:227], v[80:95]
    ds_read_b64_tr_b16 v[180:181], v139 offset:36864
    ds_read_b64_tr_b16 v[182:183], v139 offset:37888
    s_waitcnt lgkmcnt(11)
    v_mfma_f32_32x32x16_bf16 v[96:111], v[48:51], v[224:227], v[96:111]
    ds_read_b128 v[208:211], v130 offset:32768
    ds_read_b64_tr_b16 v[48:49], v136 offset:40960
    ds_read_b64_tr_b16 v[50:51], v136 offset:41984
    s_waitcnt lgkmcnt(12)
    v_mfma_f32_32x32x16_bf16 v[112:127], v[52:55], v[224:227], v[112:127]
    ds_read_b64_tr_b16 v[52:53], v137 offset:40960
    ds_read_b64_tr_b16 v[54:55], v137 offset:41984
    s_waitcnt lgkmcnt(11)
    v_mfma_f32_32x32x16_bf16 v[64:79], v[56:59], v[228:231], v[64:79]
    ds_read_b64_tr_b16 v[56:57], v138 offset:40960
    ds_read_b64_tr_b16 v[58:59], v138 offset:41984
    s_waitcnt lgkmcnt(11)
    v_mfma_f32_32x32x16_bf16 v[80:95], v[60:63], v[228:231], v[80:95]
    ds_read_b64_tr_b16 v[60:61], v139 offset:40960
    ds_read_b64_tr_b16 v[62:63], v139 offset:41984
    s_waitcnt lgkmcnt(11)
    v_mfma_f32_32x32x16_bf16 v[96:111], v[176:179], v[228:231], v[96:111]
    ds_read_b128 v[212:215], v131 offset:32768
    ds_read_b64_tr_b16 v[176:177], v136 offset:45056
    ds_read_b64_tr_b16 v[178:179], v136 offset:46080
    s_waitcnt lgkmcnt(12)
    v_mfma_f32_32x32x16_bf16 v[112:127], v[180:183], v[228:231], v[112:127]
    ds_read_b64_tr_b16 v[180:181], v137 offset:45056
    ds_read_b64_tr_b16 v[182:183], v137 offset:46080
    s_waitcnt lgkmcnt(11)
    v_mfma_f32_32x32x16_bf16 v[64:79], v[48:51], v[208:211], v[64:79]
    ds_read_b64_tr_b16 v[48:49], v138 offset:45056
    ds_read_b64_tr_b16 v[50:51], v138 offset:46080
    s_waitcnt lgkmcnt(11)
    v_mfma_f32_32x32x16_bf16 v[80:95], v[52:55], v[208:211], v[80:95]
    ds_read_b64_tr_b16 v[52:53], v139 offset:45056
    ds_read_b64_tr_b16 v[54:55], v139 offset:46080
    s_waitcnt lgkmcnt(11)
    v_mfma_f32_32x32x16_bf16 v[96:111], v[56:59], v[208:211], v[96:111]
    s_barrier
    ds_read_b128 v[216:219], v132 offset:0
    ds_read_b64_tr_b16 v[56:57], v140 offset:0
    ds_read_b64_tr_b16 v[58:59], v140 offset:1024
    s_waitcnt lgkmcnt(12)
    v_mfma_f32_32x32x16_bf16 v[112:127], v[60:63], v[208:211], v[112:127]
    ds_read_b64_tr_b16 v[60:61], v141 offset:0
    ds_read_b64_tr_b16 v[62:63], v141 offset:1024
    s_waitcnt lgkmcnt(11)
    v_mfma_f32_32x32x16_bf16 v[64:79], v[176:179], v[212:215], v[64:79]
    ds_read_b64_tr_b16 v[176:177], v142 offset:0
    ds_read_b64_tr_b16 v[178:179], v142 offset:1024
    s_waitcnt lgkmcnt(11)
    v_mfma_f32_32x32x16_bf16 v[80:95], v[180:183], v[212:215], v[80:95]
    ds_read_b64_tr_b16 v[180:181], v143 offset:0
    ds_read_b64_tr_b16 v[182:183], v143 offset:1024
    v_mfma_f32_4x4x4_16b_bf16 v[160:163], v[224:225], v[224:225], v[160:163]
    v_mfma_f32_4x4x4_16b_bf16 v[164:167], v[226:227], v[226:227], v[164:167]
    v_mfma_f32_4x4x4_16b_bf16 v[168:171], v[228:229], v[228:229], v[168:171]
    v_mfma_f32_4x4x4_16b_bf16 v[172:175], v[230:231], v[230:231], v[172:175]
    v_mfma_f32_4x4x4_16b_bf16 v[160:163], v[208:209], v[208:209], v[160:163]
    v_mfma_f32_4x4x4_16b_bf16 v[164:167], v[210:211], v[210:211], v[164:167]
    v_mfma_f32_4x4x4_16b_bf16 v[168:171], v[212:213], v[212:213], v[168:171]
    v_mfma_f32_4x4x4_16b_bf16 v[172:175], v[214:215], v[214:215], v[172:175]
    s_waitcnt lgkmcnt(11)
    v_mfma_f32_32x32x16_bf16 v[96:111], v[48:51], v[212:215], v[96:111]
    ds_read_b128 v[220:223], v133 offset:0
    ds_read_b64_tr_b16 v[48:49], v140 offset:4096
    ds_read_b64_tr_b16 v[50:51], v140 offset:5120
    s_waitcnt lgkmcnt(12)
    v_mfma_f32_32x32x16_bf16 v[112:127], v[52:55], v[212:215], v[112:127]
    ds_read_b64_tr_b16 v[52:53], v141 offset:4096
    ds_read_b64_tr_b16 v[54:55], v141 offset:5120
    s_waitcnt lgkmcnt(11)
    v_mfma_f32_32x32x16_bf16 v[64:79], v[56:59], v[216:219], v[64:79]
    ds_read_b64_tr_b16 v[56:57], v142 offset:4096
    ds_read_b64_tr_b16 v[58:59], v142 offset:5120
    s_waitcnt lgkmcnt(11)
    v_mfma_f32_32x32x16_bf16 v[80:95], v[60:63], v[216:219], v[80:95]
    ds_read_b64_tr_b16 v[60:61], v143 offset:4096
    ds_read_b64_tr_b16 v[62:63], v143 offset:5120
    s_waitcnt lgkmcnt(11)
    v_mfma_f32_32x32x16_bf16 v[96:111], v[176:179], v[216:219], v[96:111]
    ds_read_b128 v[224:227], v134 offset:0
    ds_read_b64_tr_b16 v[176:177], v140 offset:8192
    ds_read_b64_tr_b16 v[178:179], v140 offset:9216
    s_waitcnt lgkmcnt(12)
    v_mfma_f32_32x32x16_bf16 v[112:127], v[180:183], v[216:219], v[112:127]
    ds_read_b64_tr_b16 v[180:181], v141 offset:8192
    ds_read_b64_tr_b16 v[182:183], v141 offset:9216
    s_waitcnt lgkmcnt(11)
    v_mfma_f32_32x32x16_bf16 v[64:79], v[48:51], v[220:223], v[64:79]
    ds_read_b64_tr_b16 v[48:49], v142 offset:8192
    ds_read_b64_tr_b16 v[50:51], v142 offset:9216
    s_waitcnt lgkmcnt(11)
    v_mfma_f32_32x32x16_bf16 v[80:95], v[52:55], v[220:223], v[80:95]
    ds_read_b64_tr_b16 v[52:53], v143 offset:8192
    ds_read_b64_tr_b16 v[54:55], v143 offset:9216
    s_waitcnt lgkmcnt(11)
    v_mfma_f32_32x32x16_bf16 v[96:111], v[56:59], v[220:223], v[96:111]
    ds_read_b128 v[228:231], v135 offset:0
    ds_read_b64_tr_b16 v[56:57], v140 offset:12288
    ds_read_b64_tr_b16 v[58:59], v140 offset:13312
    s_waitcnt lgkmcnt(12)
    v_mfma_f32_32x32x16_bf16 v[112:127], v[60:63], v[220:223], v[112:127]
    ds_read_b64_tr_b16 v[60:61], v141 offset:12288
    ds_read_b64_tr_b16 v[62:63], v141 offset:13312
    s_waitcnt lgkmcnt(11)
    v_mfma_f32_32x32x16_bf16 v[64:79], v[176:179], v[224:227], v[64:79]
    ds_read_b64_tr_b16 v[176:177], v142 offset:12288
    ds_read_b64_tr_b16 v[178:179], v142 offset:13312
    s_waitcnt lgkmcnt(11)
    v_mfma_f32_32x32x16_bf16 v[80:95], v[180:183], v[224:227], v[80:95]
    ds_read_b64_tr_b16 v[180:181], v143 offset:12288
    ds_read_b64_tr_b16 v[182:183], v143 offset:13312
    s_waitcnt lgkmcnt(11)
    v_mfma_f32_32x32x16_bf16 v[96:111], v[48:51], v[224:227], v[96:111]
    s_barrier
    ds_read_b128 v[208:211], v132 offset:32768
    ds_read_b64_tr_b16 v[48:49], v140 offset:32768
    ds_read_b64_tr_b16 v[50:51], v140 offset:33792
    s_waitcnt lgkmcnt(12)
    v_mfma_f32_32x32x16_bf16 v[112:127], v[52:55], v[224:227], v[112:127]
    ds_read_b64_tr_b16 v[52:53], v141 offset:32768
    ds_read_b64_tr_b16 v[54:55], v141 offset:33792
    s_waitcnt lgkmcnt(11)
    v_mfma_f32_32x32x16_bf16 v[64:79], v[56:59], v[228:231], v[64:79]
    ds_read_b64_tr_b16 v[56:57], v142 offset:32768
    ds_read_b64_tr_b16 v[58:59], v142 offset:33792
    s_waitcnt lgkmcnt(11)
    v_mfma_f32_32x32x16_bf16 v[80:95], v[60:63], v[228:231], v[80:95]
    ds_read_b64_tr_b16 v[60:61], v143 offset:32768
    ds_read_b64_tr_b16 v[62:63], v143 offset:33792
    v_mfma_f32_4x4x4_16b_bf16 v[160:163], v[216:217], v[216:217], v[160:163]
    v_mfma_f32_4x4x4_16b_bf16 v[164:167], v[218:219], v[218:219], v[164:167]
    v_mfma_f32_4x4x4_16b_bf16 v[168:171], v[220:221], v[220:221], v[168:171]
    v_mfma_f32_4x4x4_16b_bf16 v[172:175], v[222:223], v[222:223], v[172:175]
    v_mfma_f32_4x4x4_16b_bf16 v[160:163], v[224:225], v[224:225], v[160:163]
    v_mfma_f32_4x4x4_16b_bf16 v[164:167], v[226:227], v[226:227], v[164:167]
    v_mfma_f32_4x4x4_16b_bf16 v[168:171], v[228:229], v[228:229], v[168:171]
    v_mfma_f32_4x4x4_16b_bf16 v[172:175], v[230:231], v[230:231], v[172:175]
    s_waitcnt lgkmcnt(11)
    v_mfma_f32_32x32x16_bf16 v[96:111], v[176:179], v[228:231], v[96:111]
    ds_read_b128 v[212:215], v133 offset:32768
    ds_read_b64_tr_b16 v[176:177], v140 offset:36864
    ds_read_b64_tr_b16 v[178:179], v140 offset:37888
    s_waitcnt lgkmcnt(12)
    v_mfma_f32_32x32x16_bf16 v[112:127], v[180:183], v[228:231], v[112:127]
    ds_read_b64_tr_b16 v[180:181], v141 offset:36864
    ds_read_b64_tr_b16 v[182:183], v141 offset:37888
    s_waitcnt lgkmcnt(11)
    v_mfma_f32_32x32x16_bf16 v[64:79], v[48:51], v[208:211], v[64:79]
    ds_read_b64_tr_b16 v[48:49], v142 offset:36864
    ds_read_b64_tr_b16 v[50:51], v142 offset:37888
    s_waitcnt lgkmcnt(11)
    v_mfma_f32_32x32x16_bf16 v[80:95], v[52:55], v[208:211], v[80:95]
    ds_read_b64_tr_b16 v[52:53], v143 offset:36864
    ds_read_b64_tr_b16 v[54:55], v143 offset:37888
    s_waitcnt lgkmcnt(11)
    v_mfma_f32_32x32x16_bf16 v[96:111], v[56:59], v[208:211], v[96:111]
    ds_read_b128 v[216:219], v134 offset:32768
    ds_read_b64_tr_b16 v[56:57], v140 offset:40960
    ds_read_b64_tr_b16 v[58:59], v140 offset:41984
    s_waitcnt lgkmcnt(12)
    v_mfma_f32_32x32x16_bf16 v[112:127], v[60:63], v[208:211], v[112:127]
    ds_read_b64_tr_b16 v[60:61], v141 offset:40960
    ds_read_b64_tr_b16 v[62:63], v141 offset:41984
    s_waitcnt lgkmcnt(11)
    v_mfma_f32_32x32x16_bf16 v[64:79], v[176:179], v[212:215], v[64:79]
    ds_read_b64_tr_b16 v[176:177], v142 offset:40960
    ds_read_b64_tr_b16 v[178:179], v142 offset:41984
    s_waitcnt lgkmcnt(11)
    v_mfma_f32_32x32x16_bf16 v[80:95], v[180:183], v[212:215], v[80:95]
    ds_read_b64_tr_b16 v[180:181], v143 offset:40960
    ds_read_b64_tr_b16 v[182:183], v143 offset:41984
    s_waitcnt lgkmcnt(11)
    v_mfma_f32_32x32x16_bf16 v[96:111], v[48:51], v[212:215], v[96:111]
    ds_read_b128 v[220:223], v135 offset:32768
    ds_read_b64_tr_b16 v[48:49], v140 offset:45056
    ds_read_b64_tr_b16 v[50:51], v140 offset:46080
    s_waitcnt lgkmcnt(12)
    v_mfma_f32_32x32x16_bf16 v[112:127], v[52:55], v[212:215], v[112:127]
    ds_read_b64_tr_b16 v[52:53], v141 offset:45056
    ds_read_b64_tr_b16 v[54:55], v141 offset:46080
    s_waitcnt lgkmcnt(11)
    v_mfma_f32_32x32x16_bf16 v[64:79], v[56:59], v[216:219], v[64:79]
    ds_read_b64_tr_b16 v[56:57], v142 offset:45056
    ds_read_b64_tr_b16 v[58:59], v142 offset:46080
    s_waitcnt lgkmcnt(11)
    v_mfma_f32_32x32x16_bf16 v[80:95], v[60:63], v[216:219], v[80:95]
    ds_read_b64_tr_b16 v[60:61], v143 offset:45056
    ds_read_b64_tr_b16 v[62:63], v143 offset:46080
    s_waitcnt lgkmcnt(11)
    v_mfma_f32_32x32x16_bf16 v[96:111], v[176:179], v[216:219], v[96:111]
    s_barrier
    ds_read_b128 v[224:227], v128 offset:0
    ds_read_b64_tr_b16 v[176:177], v136 offset:0
    ds_read_b64_tr_b16 v[178:179], v136 offset:1024
    s_waitcnt lgkmcnt(12)
    v_mfma_f32_32x32x16_bf16 v[112:127], v[180:183], v[216:219], v[112:127]
    ds_read_b64_tr_b16 v[180:181], v137 offset:0
    ds_read_b64_tr_b16 v[182:183], v137 offset:1024
    s_waitcnt lgkmcnt(11)
    v_mfma_f32_32x32x16_bf16 v[64:79], v[48:51], v[220:223], v[64:79]
    ds_read_b64_tr_b16 v[48:49], v138 offset:0
    ds_read_b64_tr_b16 v[50:51], v138 offset:1024
    s_waitcnt lgkmcnt(11)
    v_mfma_f32_32x32x16_bf16 v[80:95], v[52:55], v[220:223], v[80:95]
    ds_read_b64_tr_b16 v[52:53], v139 offset:0
    ds_read_b64_tr_b16 v[54:55], v139 offset:1024
    v_mfma_f32_4x4x4_16b_bf16 v[160:163], v[208:209], v[208:209], v[160:163]
    v_mfma_f32_4x4x4_16b_bf16 v[164:167], v[210:211], v[210:211], v[164:167]
    v_mfma_f32_4x4x4_16b_bf16 v[168:171], v[212:213], v[212:213], v[168:171]
    v_mfma_f32_4x4x4_16b_bf16 v[172:175], v[214:215], v[214:215], v[172:175]
    v_mfma_f32_4x4x4_16b_bf16 v[160:163], v[216:217], v[216:217], v[160:163]
    v_mfma_f32_4x4x4_16b_bf16 v[164:167], v[218:219], v[218:219], v[164:167]
    v_mfma_f32_4x4x4_16b_bf16 v[168:171], v[220:221], v[220:221], v[168:171]
    v_mfma_f32_4x4x4_16b_bf16 v[172:175], v[222:223], v[222:223], v[172:175]
    s_waitcnt lgkmcnt(11)
    v_mfma_f32_32x32x16_bf16 v[96:111], v[56:59], v[220:223], v[96:111]
    ds_read_b128 v[228:231], v129 offset:0
    ds_read_b64_tr_b16 v[56:57], v136 offset:4096
    ds_read_b64_tr_b16 v[58:59], v136 offset:5120
    s_waitcnt lgkmcnt(12)
    v_mfma_f32_32x32x16_bf16 v[112:127], v[60:63], v[220:223], v[112:127]
    ds_read_b64_tr_b16 v[60:61], v137 offset:4096
    ds_read_b64_tr_b16 v[62:63], v137 offset:5120
    s_waitcnt lgkmcnt(11)
    v_mfma_f32_32x32x16_bf16 v[64:79], v[176:179], v[224:227], v[64:79]
    ds_read_b64_tr_b16 v[176:177], v138 offset:4096
    ds_read_b64_tr_b16 v[178:179], v138 offset:5120
    s_waitcnt lgkmcnt(11)
    v_mfma_f32_32x32x16_bf16 v[80:95], v[180:183], v[224:227], v[80:95]
    ds_read_b64_tr_b16 v[180:181], v139 offset:4096
    ds_read_b64_tr_b16 v[182:183], v139 offset:5120
    s_waitcnt lgkmcnt(11)
    v_mfma_f32_32x32x16_bf16 v[96:111], v[48:51], v[224:227], v[96:111]
    ds_read_b128 v[208:211], v130 offset:0
    ds_read_b64_tr_b16 v[48:49], v136 offset:8192
    ds_read_b64_tr_b16 v[50:51], v136 offset:9216
    s_waitcnt lgkmcnt(12)
    v_mfma_f32_32x32x16_bf16 v[112:127], v[52:55], v[224:227], v[112:127]
    ds_read_b64_tr_b16 v[52:53], v137 offset:8192
    ds_read_b64_tr_b16 v[54:55], v137 offset:9216
    s_waitcnt lgkmcnt(11)
    v_mfma_f32_32x32x16_bf16 v[64:79], v[56:59], v[228:231], v[64:79]
    ds_read_b64_tr_b16 v[56:57], v138 offset:8192
    ds_read_b64_tr_b16 v[58:59], v138 offset:9216
    s_waitcnt lgkmcnt(11)
    v_mfma_f32_32x32x16_bf16 v[80:95], v[60:63], v[228:231], v[80:95]
    ds_read_b64_tr_b16 v[60:61], v139 offset:8192
    ds_read_b64_tr_b16 v[62:63], v139 offset:9216
    s_waitcnt lgkmcnt(11)
    v_mfma_f32_32x32x16_bf16 v[96:111], v[176:179], v[228:231], v[96:111]
    ds_read_b128 v[212:215], v131 offset:0
    ds_read_b64_tr_b16 v[176:177], v136 offset:12288
    ds_read_b64_tr_b16 v[178:179], v136 offset:13312
    s_waitcnt lgkmcnt(12)
    v_mfma_f32_32x32x16_bf16 v[112:127], v[180:183], v[228:231], v[112:127]
    ds_read_b64_tr_b16 v[180:181], v137 offset:12288
    ds_read_b64_tr_b16 v[182:183], v137 offset:13312
    s_waitcnt lgkmcnt(11)
    v_mfma_f32_32x32x16_bf16 v[64:79], v[48:51], v[208:211], v[64:79]
    ds_read_b64_tr_b16 v[48:49], v138 offset:12288
    ds_read_b64_tr_b16 v[50:51], v138 offset:13312
    s_waitcnt lgkmcnt(11)
    v_mfma_f32_32x32x16_bf16 v[80:95], v[52:55], v[208:211], v[80:95]
    ds_read_b64_tr_b16 v[52:53], v139 offset:12288
    ds_read_b64_tr_b16 v[54:55], v139 offset:13312
    s_waitcnt lgkmcnt(11)
    v_mfma_f32_32x32x16_bf16 v[96:111], v[56:59], v[208:211], v[96:111]
    s_barrier
    ds_read_b128 v[216:219], v128 offset:32768
    ds_read_b64_tr_b16 v[56:57], v136 offset:32768
    ds_read_b64_tr_b16 v[58:59], v136 offset:33792
    s_waitcnt lgkmcnt(12)
    v_mfma_f32_32x32x16_bf16 v[112:127], v[60:63], v[208:211], v[112:127]
    ds_read_b64_tr_b16 v[60:61], v137 offset:32768
    ds_read_b64_tr_b16 v[62:63], v137 offset:33792
    s_waitcnt lgkmcnt(11)
    v_mfma_f32_32x32x16_bf16 v[64:79], v[176:179], v[212:215], v[64:79]
    ds_read_b64_tr_b16 v[176:177], v138 offset:32768
    ds_read_b64_tr_b16 v[178:179], v138 offset:33792
    s_waitcnt lgkmcnt(11)
    v_mfma_f32_32x32x16_bf16 v[80:95], v[180:183], v[212:215], v[80:95]
    ds_read_b64_tr_b16 v[180:181], v139 offset:32768
    ds_read_b64_tr_b16 v[182:183], v139 offset:33792
    v_mfma_f32_4x4x4_16b_bf16 v[160:163], v[224:225], v[224:225], v[160:163]
    v_mfma_f32_4x4x4_16b_bf16 v[164:167], v[226:227], v[226:227], v[164:167]
    v_mfma_f32_4x4x4_16b_bf16 v[168:171], v[228:229], v[228:229], v[168:171]
    v_mfma_f32_4x4x4_16b_bf16 v[172:175], v[230:231], v[230:231], v[172:175]
    v_mfma_f32_4x4x4_16b_bf16 v[160:163], v[208:209], v[208:209], v[160:163]
    v_mfma_f32_4x4x4_16b_bf16 v[164:167], v[210:211], v[210:211], v[164:167]
    v_mfma_f32_4x4x4_16b_bf16 v[168:171], v[212:213], v[212:213], v[168:171]
    v_mfma_f32_4x4x4_16b_bf16 v[172:175], v[214:215], v[214:215], v[172:175]
    s_waitcnt lgkmcnt(11)
    v_mfma_f32_32x32x16_bf16 v[96:111], v[48:51], v[212:215], v[96:111]
    ds_read_b128 v[220:223], v129 offset:32768
    ds_read_b64_tr_b16 v[48:49], v136 offset:36864
    ds_read_b64_tr_b16 v[50:51], v136 offset:37888
    s_waitcnt lgkmcnt(12)
    v_mfma_f32_32x32x16_bf16 v[112:127], v[52:55], v[212:215], v[112:127]
    ds_read_b64_tr_b16 v[52:53], v137 offset:36864
    ds_read_b64_tr_b16 v[54:55], v137 offset:37888
    s_waitcnt lgkmcnt(11)
    v_mfma_f32_32x32x16_bf16 v[64:79], v[56:59], v[216:219], v[64:79]
    ds_read_b64_tr_b16 v[56:57], v138 offset:36864
    ds_read_b64_tr_b16 v[58:59], v138 offset:37888
    s_waitcnt lgkmcnt(11)
    v_mfma_f32_32x32x16_bf16 v[80:95], v[60:63], v[216:219], v[80:95]
    ds_read_b64_tr_b16 v[60:61], v139 offset:36864
    ds_read_b64_tr_b16 v[62:63], v139 offset:37888
    s_waitcnt lgkmcnt(11)
    v_mfma_f32_32x32x16_bf16 v[96:111], v[176:179], v[216:219], v[96:111]
    ds_read_b128 v[224:227], v130 offset:32768
    ds_read_b64_tr_b16 v[176:177], v136 offset:40960
    ds_read_b64_tr_b16 v[178:179], v136 offset:41984
    s_waitcnt lgkmcnt(12)
    v_mfma_f32_32x32x16_bf16 v[112:127], v[180:183], v[216:219], v[112:127]
    ds_read_b64_tr_b16 v[180:181], v137 offset:40960
    ds_read_b64_tr_b16 v[182:183], v137 offset:41984
    s_waitcnt lgkmcnt(11)
    v_mfma_f32_32x32x16_bf16 v[64:79], v[48:51], v[220:223], v[64:79]
    ds_read_b64_tr_b16 v[48:49], v138 offset:40960
    ds_read_b64_tr_b16 v[50:51], v138 offset:41984
    s_waitcnt lgkmcnt(11)
    v_mfma_f32_32x32x16_bf16 v[80:95], v[52:55], v[220:223], v[80:95]
    ds_read_b64_tr_b16 v[52:53], v139 offset:40960
    ds_read_b64_tr_b16 v[54:55], v139 offset:41984
    s_waitcnt lgkmcnt(11)
    v_mfma_f32_32x32x16_bf16 v[96:111], v[56:59], v[220:223], v[96:111]
    ds_read_b128 v[228:231], v131 offset:32768
    ds_read_b64_tr_b16 v[56:57], v136 offset:45056
    ds_read_b64_tr_b16 v[58:59], v136 offset:46080
    s_waitcnt lgkmcnt(12)
    v_mfma_f32_32x32x16_bf16 v[112:127], v[60:63], v[220:223], v[112:127]
    ds_read_b64_tr_b16 v[60:61], v137 offset:45056
    ds_read_b64_tr_b16 v[62:63], v137 offset:46080
    s_waitcnt lgkmcnt(11)
    v_mfma_f32_32x32x16_bf16 v[64:79], v[176:179], v[224:227], v[64:79]
    ds_read_b64_tr_b16 v[176:177], v138 offset:45056
    ds_read_b64_tr_b16 v[178:179], v138 offset:46080
    s_waitcnt lgkmcnt(11)
    v_mfma_f32_32x32x16_bf16 v[80:95], v[180:183], v[224:227], v[80:95]
    ds_read_b64_tr_b16 v[180:181], v139 offset:45056
    ds_read_b64_tr_b16 v[182:183], v139 offset:46080
    s_waitcnt lgkmcnt(11)
    v_mfma_f32_32x32x16_bf16 v[96:111], v[48:51], v[224:227], v[96:111]
    s_barrier
    ds_read_b128 v[208:211], v132 offset:0
    ds_read_b64_tr_b16 v[48:49], v140 offset:0
    ds_read_b64_tr_b16 v[50:51], v140 offset:1024
    s_waitcnt lgkmcnt(12)
    v_mfma_f32_32x32x16_bf16 v[112:127], v[52:55], v[224:227], v[112:127]
    ds_read_b64_tr_b16 v[52:53], v141 offset:0
    ds_read_b64_tr_b16 v[54:55], v141 offset:1024
    s_waitcnt lgkmcnt(11)
    v_mfma_f32_32x32x16_bf16 v[64:79], v[56:59], v[228:231], v[64:79]
    ds_read_b64_tr_b16 v[56:57], v142 offset:0
    ds_read_b64_tr_b16 v[58:59], v142 offset:1024
    s_waitcnt lgkmcnt(11)
    v_mfma_f32_32x32x16_bf16 v[80:95], v[60:63], v[228:231], v[80:95]
    ds_read_b64_tr_b16 v[60:61], v143 offset:0
    ds_read_b64_tr_b16 v[62:63], v143 offset:1024
    v_mfma_f32_4x4x4_16b_bf16 v[160:163], v[216:217], v[216:217], v[160:163]
    v_mfma_f32_4x4x4_16b_bf16 v[164:167], v[218:219], v[218:219], v[164:167]
    v_mfma_f32_4x4x4_16b_bf16 v[168:171], v[220:221], v[220:221], v[168:171]
    v_mfma_f32_4x4x4_16b_bf16 v[172:175], v[222:223], v[222:223], v[172:175]
    v_mfma_f32_4x4x4_16b_bf16 v[160:163], v[224:225], v[224:225], v[160:163]
    v_mfma_f32_4x4x4_16b_bf16 v[164:167], v[226:227], v[226:227], v[164:167]
    v_mfma_f32_4x4x4_16b_bf16 v[168:171], v[228:229], v[228:229], v[168:171]
    v_mfma_f32_4x4x4_16b_bf16 v[172:175], v[230:231], v[230:231], v[172:175]
    s_waitcnt lgkmcnt(11)
    v_mfma_f32_32x32x16_bf16 v[96:111], v[176:179], v[228:231], v[96:111]
    ds_read_b128 v[212:215], v133 offset:0
    ds_read_b64_tr_b16 v[176:177], v140 offset:4096
    ds_read_b64_tr_b16 v[178:179], v140 offset:5120
    s_waitcnt lgkmcnt(12)
    v_mfma_f32_32x32x16_bf16 v[112:127], v[180:183], v[228:231], v[112:127]
    ds_read_b64_tr_b16 v[180:181], v141 offset:4096
    ds_read_b64_tr_b16 v[182:183], v141 offset:5120
    s_waitcnt lgkmcnt(11)
    v_mfma_f32_32x32x16_bf16 v[64:79], v[48:51], v[208:211], v[64:79]
    ds_read_b64_tr_b16 v[48:49], v142 offset:4096
    ds_read_b64_tr_b16 v[50:51], v142 offset:5120
    s_waitcnt lgkmcnt(11)
    v_mfma_f32_32x32x16_bf16 v[80:95], v[52:55], v[208:211], v[80:95]
    ds_read_b64_tr_b16 v[52:53], v143 offset:4096
    ds_read_b64_tr_b16 v[54:55], v143 offset:5120
    s_waitcnt lgkmcnt(11)
    v_mfma_f32_32x32x16_bf16 v[96:111], v[56:59], v[208:211], v[96:111]
    ds_read_b128 v[216:219], v134 offset:0
    ds_read_b64_tr_b16 v[56:57], v140 offset:8192
    ds_read_b64_tr_b16 v[58:59], v140 offset:9216
    s_waitcnt lgkmcnt(12)
    v_mfma_f32_32x32x16_bf16 v[112:127], v[60:63], v[208:211], v[112:127]
    ds_read_b64_tr_b16 v[60:61], v141 offset:8192
    ds_read_b64_tr_b16 v[62:63], v141 offset:9216
    s_waitcnt lgkmcnt(11)
    v_mfma_f32_32x32x16_bf16 v[64:79], v[176:179], v[212:215], v[64:79]
    ds_read_b64_tr_b16 v[176:177], v142 offset:8192
    ds_read_b64_tr_b16 v[178:179], v142 offset:9216
    s_waitcnt lgkmcnt(11)
    v_mfma_f32_32x32x16_bf16 v[80:95], v[180:183], v[212:215], v[80:95]
    ds_read_b64_tr_b16 v[180:181], v143 offset:8192
    ds_read_b64_tr_b16 v[182:183], v143 offset:9216
    s_waitcnt lgkmcnt(11)
    v_mfma_f32_32x32x16_bf16 v[96:111], v[48:51], v[212:215], v[96:111]
    ds_read_b128 v[220:223], v135 offset:0
    ds_read_b64_tr_b16 v[48:49], v140 offset:12288
    ds_read_b64_tr_b16 v[50:51], v140 offset:13312
    s_waitcnt lgkmcnt(12)
    v_mfma_f32_32x32x16_bf16 v[112:127], v[52:55], v[212:215], v[112:127]
    ds_read_b64_tr_b16 v[52:53], v141 offset:12288
    ds_read_b64_tr_b16 v[54:55], v141 offset:13312
    s_waitcnt lgkmcnt(11)
    v_mfma_f32_32x32x16_bf16 v[64:79], v[56:59], v[216:219], v[64:79]
    ds_read_b64_tr_b16 v[56:57], v142 offset:12288
    ds_read_b64_tr_b16 v[58:59], v142 offset:13312
    s_waitcnt lgkmcnt(11)
    v_mfma_f32_32x32x16_bf16 v[80:95], v[60:63], v[216:219], v[80:95]
    ds_read_b64_tr_b16 v[60:61], v143 offset:12288
    ds_read_b64_tr_b16 v[62:63], v143 offset:13312
    s_waitcnt lgkmcnt(11)
    v_mfma_f32_32x32x16_bf16 v[96:111], v[176:179], v[216:219], v[96:111]
    s_barrier
    ds_read_b128 v[224:227], v132 offset:32768
    ds_read_b64_tr_b16 v[176:177], v140 offset:32768
    ds_read_b64_tr_b16 v[178:179], v140 offset:33792
    s_waitcnt lgkmcnt(12)
    v_mfma_f32_32x32x16_bf16 v[112:127], v[180:183], v[216:219], v[112:127]
    ds_read_b64_tr_b16 v[180:181], v141 offset:32768
    ds_read_b64_tr_b16 v[182:183], v141 offset:33792
    s_waitcnt lgkmcnt(11)
    v_mfma_f32_32x32x16_bf16 v[64:79], v[48:51], v[220:223], v[64:79]
    ds_read_b64_tr_b16 v[48:49], v142 offset:32768
    ds_read_b64_tr_b16 v[50:51], v142 offset:33792
    s_waitcnt lgkmcnt(11)
    v_mfma_f32_32x32x16_bf16 v[80:95], v[52:55], v[220:223], v[80:95]
    ds_read_b64_tr_b16 v[52:53], v143 offset:32768
    ds_read_b64_tr_b16 v[54:55], v143 offset:33792
    v_mfma_f32_4x4x4_16b_bf16 v[160:163], v[208:209], v[208:209], v[160:163]
    v_mfma_f32_4x4x4_16b_bf16 v[164:167], v[210:211], v[210:211], v[164:167]
    v_mfma_f32_4x4x4_16b_bf16 v[168:171], v[212:213], v[212:213], v[168:171]
    v_mfma_f32_4x4x4_16b_bf16 v[172:175], v[214:215], v[214:215], v[172:175]
    v_mfma_f32_4x4x4_16b_bf16 v[160:163], v[216:217], v[216:217], v[160:163]
    v_mfma_f32_4x4x4_16b_bf16 v[164:167], v[218:219], v[218:219], v[164:167]
    v_mfma_f32_4x4x4_16b_bf16 v[168:171], v[220:221], v[220:221], v[168:171]
    v_mfma_f32_4x4x4_16b_bf16 v[172:175], v[222:223], v[222:223], v[172:175]
    s_waitcnt lgkmcnt(11)
    v_mfma_f32_32x32x16_bf16 v[96:111], v[56:59], v[220:223], v[96:111]
    ds_read_b128 v[228:231], v133 offset:32768
    ds_read_b64_tr_b16 v[56:57], v140 offset:36864
    ds_read_b64_tr_b16 v[58:59], v140 offset:37888
    s_waitcnt lgkmcnt(12)
    v_mfma_f32_32x32x16_bf16 v[112:127], v[60:63], v[220:223], v[112:127]
    ds_read_b64_tr_b16 v[60:61], v141 offset:36864
    ds_read_b64_tr_b16 v[62:63], v141 offset:37888
    s_waitcnt lgkmcnt(11)
    v_mfma_f32_32x32x16_bf16 v[64:79], v[176:179], v[224:227], v[64:79]
    ds_read_b64_tr_b16 v[176:177], v142 offset:36864
    ds_read_b64_tr_b16 v[178:179], v142 offset:37888
    s_waitcnt lgkmcnt(11)
    v_mfma_f32_32x32x16_bf16 v[80:95], v[180:183], v[224:227], v[80:95]
    ds_read_b64_tr_b16 v[180:181], v143 offset:36864
    ds_read_b64_tr_b16 v[182:183], v143 offset:37888
    s_waitcnt lgkmcnt(11)
    v_mfma_f32_32x32x16_bf16 v[96:111], v[48:51], v[224:227], v[96:111]
    ds_read_b128 v[208:211], v134 offset:32768
    ds_read_b64_tr_b16 v[48:49], v140 offset:40960
    ds_read_b64_tr_b16 v[50:51], v140 offset:41984
    s_waitcnt lgkmcnt(12)
    v_mfma_f32_32x32x16_bf16 v[112:127], v[52:55], v[224:227], v[112:127]
    ds_read_b64_tr_b16 v[52:53], v141 offset:40960
    ds_read_b64_tr_b16 v[54:55], v141 offset:41984
    s_waitcnt lgkmcnt(11)
    v_mfma_f32_32x32x16_bf16 v[64:79], v[56:59], v[228:231], v[64:79]
    ds_read_b64_tr_b16 v[56:57], v142 offset:40960
    ds_read_b64_tr_b16 v[58:59], v142 offset:41984
    s_waitcnt lgkmcnt(11)
    v_mfma_f32_32x32x16_bf16 v[80:95], v[60:63], v[228:231], v[80:95]
    ds_read_b64_tr_b16 v[60:61], v143 offset:40960
    ds_read_b64_tr_b16 v[62:63], v143 offset:41984
    s_waitcnt lgkmcnt(11)
    v_mfma_f32_32x32x16_bf16 v[96:111], v[176:179], v[228:231], v[96:111]
    ds_read_b128 v[212:215], v135 offset:32768
    ds_read_b64_tr_b16 v[176:177], v140 offset:45056
    ds_read_b64_tr_b16 v[178:179], v140 offset:46080
    s_waitcnt lgkmcnt(12)
    v_mfma_f32_32x32x16_bf16 v[112:127], v[180:183], v[228:231], v[112:127]
    ds_read_b64_tr_b16 v[180:181], v141 offset:45056
    ds_read_b64_tr_b16 v[182:183], v141 offset:46080
    s_waitcnt lgkmcnt(11)
    v_mfma_f32_32x32x16_bf16 v[64:79], v[48:51], v[208:211], v[64:79]
    ds_read_b64_tr_b16 v[48:49], v142 offset:45056
    ds_read_b64_tr_b16 v[50:51], v142 offset:46080
    s_waitcnt lgkmcnt(11)
    v_mfma_f32_32x32x16_bf16 v[80:95], v[52:55], v[208:211], v[80:95]
    ds_read_b64_tr_b16 v[52:53], v143 offset:45056
    ds_read_b64_tr_b16 v[54:55], v143 offset:46080
    s_waitcnt lgkmcnt(11)
    v_mfma_f32_32x32x16_bf16 v[96:111], v[56:59], v[208:211], v[96:111]
    s_barrier
    ds_read_b128 v[216:219], v128 offset:0
    ds_read_b64_tr_b16 v[56:57], v136 offset:0
    ds_read_b64_tr_b16 v[58:59], v136 offset:1024
    s_waitcnt lgkmcnt(12)
    v_mfma_f32_32x32x16_bf16 v[112:127], v[60:63], v[208:211], v[112:127]
    ds_read_b64_tr_b16 v[60:61], v137 offset:0
    ds_read_b64_tr_b16 v[62:63], v137 offset:1024
    s_waitcnt lgkmcnt(11)
    v_mfma_f32_32x32x16_bf16 v[64:79], v[176:179], v[212:215], v[64:79]
    ds_read_b64_tr_b16 v[176:177], v138 offset:0
    ds_read_b64_tr_b16 v[178:179], v138 offset:1024
    s_waitcnt lgkmcnt(11)
    v_mfma_f32_32x32x16_bf16 v[80:95], v[180:183], v[212:215], v[80:95]
    ds_read_b64_tr_b16 v[180:181], v139 offset:0
    ds_read_b64_tr_b16 v[182:183], v139 offset:1024
    v_mfma_f32_4x4x4_16b_bf16 v[160:163], v[224:225], v[224:225], v[160:163]
    v_mfma_f32_4x4x4_16b_bf16 v[164:167], v[226:227], v[226:227], v[164:167]
    v_mfma_f32_4x4x4_16b_bf16 v[168:171], v[228:229], v[228:229], v[168:171]
    v_mfma_f32_4x4x4_16b_bf16 v[172:175], v[230:231], v[230:231], v[172:175]
    v_mfma_f32_4x4x4_16b_bf16 v[160:163], v[208:209], v[208:209], v[160:163]
    v_mfma_f32_4x4x4_16b_bf16 v[164:167], v[210:211], v[210:211], v[164:167]
    v_mfma_f32_4x4x4_16b_bf16 v[168:171], v[212:213], v[212:213], v[168:171]
    v_mfma_f32_4x4x4_16b_bf16 v[172:175], v[214:215], v[214:215], v[172:175]
    s_waitcnt lgkmcnt(11)
    v_mfma_f32_32x32x16_bf16 v[96:111], v[48:51], v[212:215], v[96:111]
    ds_read_b128 v[220:223], v129 offset:0
    ds_read_b64_tr_b16 v[48:49], v136 offset:4096
    ds_read_b64_tr_b16 v[50:51], v136 offset:5120
    s_waitcnt lgkmcnt(12)
    v_mfma_f32_32x32x16_bf16 v[112:127], v[52:55], v[212:215], v[112:127]
    ds_read_b64_tr_b16 v[52:53], v137 offset:4096
    ds_read_b64_tr_b16 v[54:55], v137 offset:5120
    s_waitcnt lgkmcnt(11)
    v_mfma_f32_32x32x16_bf16 v[64:79], v[56:59], v[216:219], v[64:79]
    ds_read_b64_tr_b16 v[56:57], v138 offset:4096
    ds_read_b64_tr_b16 v[58:59], v138 offset:5120
    s_waitcnt lgkmcnt(11)
    v_mfma_f32_32x32x16_bf16 v[80:95], v[60:63], v[216:219], v[80:95]
    ds_read_b64_tr_b16 v[60:61], v139 offset:4096
    ds_read_b64_tr_b16 v[62:63], v139 offset:5120
    s_waitcnt lgkmcnt(11)
    v_mfma_f32_32x32x16_bf16 v[96:111], v[176:179], v[216:219], v[96:111]
    ds_read_b128 v[224:227], v130 offset:0
    ds_read_b64_tr_b16 v[176:177], v136 offset:8192
    ds_read_b64_tr_b16 v[178:179], v136 offset:9216
    s_waitcnt lgkmcnt(12)
    v_mfma_f32_32x32x16_bf16 v[112:127], v[180:183], v[216:219], v[112:127]
    ds_read_b64_tr_b16 v[180:181], v137 offset:8192
    ds_read_b64_tr_b16 v[182:183], v137 offset:9216
    s_waitcnt lgkmcnt(11)
    v_mfma_f32_32x32x16_bf16 v[64:79], v[48:51], v[220:223], v[64:79]
    ds_read_b64_tr_b16 v[48:49], v138 offset:8192
    ds_read_b64_tr_b16 v[50:51], v138 offset:9216
    s_waitcnt lgkmcnt(11)
    v_mfma_f32_32x32x16_bf16 v[80:95], v[52:55], v[220:223], v[80:95]
    ds_read_b64_tr_b16 v[52:53], v139 offset:8192
    ds_read_b64_tr_b16 v[54:55], v139 offset:9216
    s_waitcnt lgkmcnt(11)
    v_mfma_f32_32x32x16_bf16 v[96:111], v[56:59], v[220:223], v[96:111]
    ds_read_b128 v[228:231], v131 offset:0
    ds_read_b64_tr_b16 v[56:57], v136 offset:12288
    ds_read_b64_tr_b16 v[58:59], v136 offset:13312
    s_waitcnt lgkmcnt(12)
    v_mfma_f32_32x32x16_bf16 v[112:127], v[60:63], v[220:223], v[112:127]
    ds_read_b64_tr_b16 v[60:61], v137 offset:12288
    ds_read_b64_tr_b16 v[62:63], v137 offset:13312
    s_waitcnt lgkmcnt(11)
    v_mfma_f32_32x32x16_bf16 v[64:79], v[176:179], v[224:227], v[64:79]
    ds_read_b64_tr_b16 v[176:177], v138 offset:12288
    ds_read_b64_tr_b16 v[178:179], v138 offset:13312
    s_waitcnt lgkmcnt(11)
    v_mfma_f32_32x32x16_bf16 v[80:95], v[180:183], v[224:227], v[80:95]
    ds_read_b64_tr_b16 v[180:181], v139 offset:12288
    ds_read_b64_tr_b16 v[182:183], v139 offset:13312
    s_waitcnt lgkmcnt(11)
    v_mfma_f32_32x32x16_bf16 v[96:111], v[48:51], v[224:227], v[96:111]
    s_barrier
    ds_read_b128 v[208:211], v128 offset:32768
    ds_read_b64_tr_b16 v[48:49], v136 offset:32768
    ds_read_b64_tr_b16 v[50:51], v136 offset:33792
    s_waitcnt lgkmcnt(12)
    v_mfma_f32_32x32x16_bf16 v[112:127], v[52:55], v[224:227], v[112:127]
    ds_read_b64_tr_b16 v[52:53], v137 offset:32768
    ds_read_b64_tr_b16 v[54:55], v137 offset:33792
    s_waitcnt lgkmcnt(11)
    v_mfma_f32_32x32x16_bf16 v[64:79], v[56:59], v[228:231], v[64:79]
    ds_read_b64_tr_b16 v[56:57], v138 offset:32768
    ds_read_b64_tr_b16 v[58:59], v138 offset:33792
    s_waitcnt lgkmcnt(11)
    v_mfma_f32_32x32x16_bf16 v[80:95], v[60:63], v[228:231], v[80:95]
    ds_read_b64_tr_b16 v[60:61], v139 offset:32768
    ds_read_b64_tr_b16 v[62:63], v139 offset:33792
    v_mfma_f32_4x4x4_16b_bf16 v[160:163], v[216:217], v[216:217], v[160:163]
    v_mfma_f32_4x4x4_16b_bf16 v[164:167], v[218:219], v[218:219], v[164:167]
    v_mfma_f32_4x4x4_16b_bf16 v[168:171], v[220:221], v[220:221], v[168:171]
    v_mfma_f32_4x4x4_16b_bf16 v[172:175], v[222:223], v[222:223], v[172:175]
    v_mfma_f32_4x4x4_16b_bf16 v[160:163], v[224:225], v[224:225], v[160:163]
    v_mfma_f32_4x4x4_16b_bf16 v[164:167], v[226:227], v[226:227], v[164:167]
    v_mfma_f32_4x4x4_16b_bf16 v[168:171], v[228:229], v[228:229], v[168:171]
    v_mfma_f32_4x4x4_16b_bf16 v[172:175], v[230:231], v[230:231], v[172:175]
    s_waitcnt lgkmcnt(11)
    v_mfma_f32_32x32x16_bf16 v[96:111], v[176:179], v[228:231], v[96:111]
    ds_read_b128 v[212:215], v129 offset:32768
    ds_read_b64_tr_b16 v[176:177], v136 offset:36864
    ds_read_b64_tr_b16 v[178:179], v136 offset:37888
    s_waitcnt lgkmcnt(12)
    v_mfma_f32_32x32x16_bf16 v[112:127], v[180:183], v[228:231], v[112:127]
    ds_read_b64_tr_b16 v[180:181], v137 offset:36864
    ds_read_b64_tr_b16 v[182:183], v137 offset:37888
    s_waitcnt lgkmcnt(11)
    v_mfma_f32_32x32x16_bf16 v[64:79], v[48:51], v[208:211], v[64:79]
    ds_read_b64_tr_b16 v[48:49], v138 offset:36864
    ds_read_b64_tr_b16 v[50:51], v138 offset:37888
    s_waitcnt lgkmcnt(11)
    v_mfma_f32_32x32x16_bf16 v[80:95], v[52:55], v[208:211], v[80:95]
    ds_read_b64_tr_b16 v[52:53], v139 offset:36864
    ds_read_b64_tr_b16 v[54:55], v139 offset:37888
    s_waitcnt lgkmcnt(11)
    v_mfma_f32_32x32x16_bf16 v[96:111], v[56:59], v[208:211], v[96:111]
    ds_read_b128 v[216:219], v130 offset:32768
    ds_read_b64_tr_b16 v[56:57], v136 offset:40960
    ds_read_b64_tr_b16 v[58:59], v136 offset:41984
    s_waitcnt lgkmcnt(12)
    v_mfma_f32_32x32x16_bf16 v[112:127], v[60:63], v[208:211], v[112:127]
    ds_read_b64_tr_b16 v[60:61], v137 offset:40960
    ds_read_b64_tr_b16 v[62:63], v137 offset:41984
    s_waitcnt lgkmcnt(11)
    v_mfma_f32_32x32x16_bf16 v[64:79], v[176:179], v[212:215], v[64:79]
    ds_read_b64_tr_b16 v[176:177], v138 offset:40960
    ds_read_b64_tr_b16 v[178:179], v138 offset:41984
    s_waitcnt lgkmcnt(11)
    v_mfma_f32_32x32x16_bf16 v[80:95], v[180:183], v[212:215], v[80:95]
    ds_read_b64_tr_b16 v[180:181], v139 offset:40960
    ds_read_b64_tr_b16 v[182:183], v139 offset:41984
    s_waitcnt lgkmcnt(11)
    v_mfma_f32_32x32x16_bf16 v[96:111], v[48:51], v[212:215], v[96:111]
    ds_read_b128 v[220:223], v131 offset:32768
    ds_read_b64_tr_b16 v[48:49], v136 offset:45056
    ds_read_b64_tr_b16 v[50:51], v136 offset:46080
    s_waitcnt lgkmcnt(12)
    v_mfma_f32_32x32x16_bf16 v[112:127], v[52:55], v[212:215], v[112:127]
    ds_read_b64_tr_b16 v[52:53], v137 offset:45056
    ds_read_b64_tr_b16 v[54:55], v137 offset:46080
    s_waitcnt lgkmcnt(11)
    v_mfma_f32_32x32x16_bf16 v[64:79], v[56:59], v[216:219], v[64:79]
    ds_read_b64_tr_b16 v[56:57], v138 offset:45056
    ds_read_b64_tr_b16 v[58:59], v138 offset:46080
    s_waitcnt lgkmcnt(11)
    v_mfma_f32_32x32x16_bf16 v[80:95], v[60:63], v[216:219], v[80:95]
    ds_read_b64_tr_b16 v[60:61], v139 offset:45056
    ds_read_b64_tr_b16 v[62:63], v139 offset:46080
    s_waitcnt lgkmcnt(11)
    v_mfma_f32_32x32x16_bf16 v[96:111], v[176:179], v[216:219], v[96:111]
    s_waitcnt lgkmcnt(9)
    v_mfma_f32_32x32x16_bf16 v[112:127], v[180:183], v[216:219], v[112:127]
    s_waitcnt lgkmcnt(6)
    v_mfma_f32_32x32x16_bf16 v[64:79], v[48:51], v[220:223], v[64:79]
    s_waitcnt lgkmcnt(4)
    v_mfma_f32_32x32x16_bf16 v[80:95], v[52:55], v[220:223], v[80:95]
    v_mfma_f32_4x4x4_16b_bf16 v[160:163], v[208:209], v[208:209], v[160:163]
    v_mfma_f32_4x4x4_16b_bf16 v[164:167], v[210:211], v[210:211], v[164:167]
    v_mfma_f32_4x4x4_16b_bf16 v[168:171], v[212:213], v[212:213], v[168:171]
    v_mfma_f32_4x4x4_16b_bf16 v[172:175], v[214:215], v[214:215], v[172:175]
    v_mfma_f32_4x4x4_16b_bf16 v[160:163], v[216:217], v[216:217], v[160:163]
    v_mfma_f32_4x4x4_16b_bf16 v[164:167], v[218:219], v[218:219], v[164:167]
    v_mfma_f32_4x4x4_16b_bf16 v[168:171], v[220:221], v[220:221], v[168:171]
    v_mfma_f32_4x4x4_16b_bf16 v[172:175], v[222:223], v[222:223], v[172:175]
    s_waitcnt lgkmcnt(2)
    v_mfma_f32_32x32x16_bf16 v[96:111], v[56:59], v[220:223], v[96:111]
    s_waitcnt lgkmcnt(0)
    v_mfma_f32_32x32x16_bf16 v[112:127], v[60:63], v[220:223], v[112:127]
    s_barrier
    ds_read_b64 v[40:41], v30
    ds_read_b64 v[42:43], v30 offset:512
    ds_read_b64 v[44:45], v30 offset:1024
    ds_read_b64 v[46:47], v30 offset:1536
    s_mov_b32 s50, 0xaaaaaaaa
    s_mov_b32 s51, 0xaaaaaaaa
    s_mov_b32 s52, 0xcccccccc
    s_mov_b32 s53, 0xcccccccc
    v_pk_add_f32 v[160:161], v[160:161], v[164:165]
    v_pk_add_f32 v[162:163], v[162:163], v[166:167]
    v_pk_add_f32 v[168:169], v[168:169], v[172:173]
    v_pk_add_f32 v[170:171], v[170:171], v[174:175]
    v_pk_add_f32 v[160:161], v[160:161], v[168:169]
    v_pk_add_f32 v[162:163], v[162:163], v[170:171]
    v_cndmask_b32 v160, v160, v161, s[50:51]
    v_cndmask_b32 v162, v162, v163, s[50:51]
    v_cndmask_b32 v160, v160, v162, s[52:53]
    v_cmp_gt_u32 vcc, 32, v1
    v_mov_b32 v161, v160
    s_nop 1
    v_permlane32_swap_b32 v160, v161
    s_nop 1
    v_add_f32 v160, v160, v161
    v_cndmask_b32 v192, v160, v124, vcc
    v_mul_f32 v192, 0x3acccccd, v192
    v_mov_b32 v193, v192
    s_nop 1
    v_permlane32_swap_b32 v192, v193
    v_cmp_gt_u32 vcc, 32, v1
    v_fma_f32 v193, -v192, v192, v193
    v_max_f32 v193, 0, v193
    v_add_f32 v194, 0x3727c5ac, v193
    v_rsq_f32 v16, v194
    v_sub_f32 v196, 0, v192
    v_mov_b32 v18, 0xffff0000
    v_and_b32 v197, 0xffff0000, v196
    v_sub_f32 v198, v196, v197
    v_lshrrev_b32 v197, 16, v197
    v_and_or_b32 v38, v198, v18, v197
    v_mov_b32 v39, v197
    v_mul_f32 v20, v20, v16
    v_mul_f32 v22, v22, v16
    v_mul_f32 v24, v24, v16
    s_waitcnt lgkmcnt(0)
    v_mfma_f32_32x32x8_bf16 v[64:79], v[40:41], v[38:39], v[64:79]
    v_mfma_f32_32x32x8_bf16 v[80:95], v[42:43], v[38:39], v[80:95]
    v_mfma_f32_32x32x8_bf16 v[96:111], v[44:45], v[38:39], v[96:111]
    v_mfma_f32_32x32x8_bf16 v[112:127], v[46:47], v[38:39], v[112:127]
    s_lshr_b32 s24, s40, 2
    s_lshl_b32 s24, s24, 7
    s_and_b32 s50, s40, 3
    s_lshl2_add_u32 s24, s50, s24
    s_lshl_b32 s50, s36, 11
    s_add_u32 s24, s24, s50
    s_add_u32 s24, s24, 65536
    s_mov_b32 s25, 0
    s_nop 2
    v_pk_mul_f32 v[64:65], v[64:65], v[20:21] op_sel_hi:[1,0]
    v_pk_mul_f32 v[66:67], v[66:67], v[20:21] op_sel_hi:[1,0]
    v_pk_mul_f32 v[68:69], v[68:69], v[20:21] op_sel_hi:[1,0]
    v_pk_mul_f32 v[70:71], v[70:71], v[20:21] op_sel_hi:[1,0]
    v_cvt_pk_bf16_f32 v64, v64, v65
    v_cvt_pk_bf16_f32 v65, v66, v67
    v_cvt_pk_bf16_f32 v66, v68, v69
    v_cvt_pk_bf16_f32 v67, v70, v71
    buffer_store_dwordx4 v[64:67], v3, s[4:7], s85 offen sc0 sc1
    v_pk_mul_f32 v[72:73], v[72:73], v[20:21] op_sel_hi:[1,0]
    v_pk_mul_f32 v[74:75], v[74:75], v[20:21] op_sel_hi:[1,0]
    v_pk_mul_f32 v[76:77], v[76:77], v[20:21] op_sel_hi:[1,0]
    v_pk_mul_f32 v[78:79], v[78:79], v[20:21] op_sel_hi:[1,0]
    v_cvt_pk_bf16_f32 v72, v72, v73
    v_cvt_pk_bf16_f32 v73, v74, v75
    v_cvt_pk_bf16_f32 v74, v76, v77
    v_cvt_pk_bf16_f32 v75, v78, v79
    buffer_store_dwordx4 v[72:75], v3, s[4:7], s86 offen sc0 sc1
    v_pk_mul_f32 v[80:81], v[80:81], v[22:23] op_sel_hi:[1,0]
    v_pk_mul_f32 v[82:83], v[82:83], v[22:23] op_sel_hi:[1,0]
    v_pk_mul_f32 v[84:85], v[84:85], v[22:23] op_sel_hi:[1,0]
    v_pk_mul_f32 v[86:87], v[86:87], v[22:23] op_sel_hi:[1,0]
    v_cvt_pk_bf16_f32 v80, v80, v81
    v_cvt_pk_bf16_f32 v81, v82, v83
    v_cvt_pk_bf16_f32 v82, v84, v85
    v_cvt_pk_bf16_f32 v83, v86, v87
    buffer_store_dwordx4 v[80:83], v3, s[4:7], s89 offen sc0 sc1
    v_pk_mul_f32 v[88:89], v[88:89], v[22:23] op_sel_hi:[1,0]
    v_pk_mul_f32 v[90:91], v[90:91], v[22:23] op_sel_hi:[1,0]
    v_pk_mul_f32 v[92:93], v[92:93], v[22:23] op_sel_hi:[1,0]
    v_pk_mul_f32 v[94:95], v[94:95], v[22:23] op_sel_hi:[1,0]
    v_cvt_pk_bf16_f32 v88, v88, v89
    v_cvt_pk_bf16_f32 v89, v90, v91
    v_cvt_pk_bf16_f32 v90, v92, v93
    v_cvt_pk_bf16_f32 v91, v94, v95
    buffer_store_dwordx4 v[88:91], v3, s[4:7], s90 offen sc0 sc1
    v_pk_mul_f32 v[96:97], v[96:97], v[24:25] op_sel_hi:[1,0]
    v_pk_mul_f32 v[98:99], v[98:99], v[24:25] op_sel_hi:[1,0]
    v_pk_mul_f32 v[100:101], v[100:101], v[24:25] op_sel_hi:[1,0]
    v_pk_mul_f32 v[102:103], v[102:103], v[24:25] op_sel_hi:[1,0]
    v_cvt_pk_bf16_f32 v96, v96, v97
    v_cvt_pk_bf16_f32 v97, v98, v99
    v_cvt_pk_bf16_f32 v98, v100, v101
    v_cvt_pk_bf16_f32 v99, v102, v103
    buffer_store_dwordx4 v[96:99], v3, s[4:7], s93 offen sc0 sc1
    v_pk_mul_f32 v[104:105], v[104:105], v[24:25] op_sel_hi:[1,0]
    v_pk_mul_f32 v[106:107], v[106:107], v[24:25] op_sel_hi:[1,0]
    v_pk_mul_f32 v[108:109], v[108:109], v[24:25] op_sel_hi:[1,0]
    v_pk_mul_f32 v[110:111], v[110:111], v[24:25] op_sel_hi:[1,0]
    v_cvt_pk_bf16_f32 v104, v104, v105
    v_cvt_pk_bf16_f32 v105, v106, v107
    v_cvt_pk_bf16_f32 v106, v108, v109
    v_cvt_pk_bf16_f32 v107, v110, v111
    buffer_store_dwordx4 v[104:107], v3, s[4:7], s94 offen sc0 sc1
    v_pk_mul_f32 v[112:113], v[112:113], v[20:21] op_sel_hi:[1,0]
    v_pk_mul_f32 v[114:115], v[114:115], v[20:21] op_sel_hi:[1,0]
    v_cvt_pk_bf16_f32 v112, v112, v113
    v_cvt_pk_bf16_f32 v113, v114, v115
    buffer_store_dwordx2 v[112:113], v26, s[4:7], s87 offen sc0 sc1
    v_pk_mul_f32 v[116:117], v[116:117], v[22:23] op_sel_hi:[1,0]
    v_pk_mul_f32 v[118:119], v[118:119], v[22:23] op_sel_hi:[1,0]
    v_cvt_pk_bf16_f32 v116, v116, v117
    v_cvt_pk_bf16_f32 v117, v118, v119
    buffer_store_dwordx2 v[116:117], v27, s[4:7], s91 offen sc0 sc1
    v_pk_mul_f32 v[120:121], v[120:121], v[24:25] op_sel_hi:[1,0]
    v_pk_mul_f32 v[122:123], v[122:123], v[24:25] op_sel_hi:[1,0]
    v_cvt_pk_bf16_f32 v120, v120, v121
    v_cvt_pk_bf16_f32 v121, v122, v123
    buffer_store_dwordx2 v[120:121], v28, s[4:7], s95 offen sc0 sc1
    s_branch L_layer
L_layer:
    s_cmp_lg_u32 s25, 0
    s_cbranch_scc1 L_par2
    s_mov_b32 s20, 0x1300000
    s_mov_b32 s21, 0x1a80000
    s_mov_b32 s22, 0xd0000
    s_mov_b32 s23, 0xc8000
    s_mov_b32 s26, 0xc0000
    s_mov_b32 s27, 0xd0000
    s_mov_b32 s30, 0x0
    s_mov_b32 s31, 0xd0000
    s_mov_b32 s32, 0x0
    s_mov_b32 s33, 0xc0000
    s_branch L_par3
L_par2:
    s_load_dwordx2 s[50:51], s[0:1], 64
    s_mov_b32 s20, 0x1a80000
    s_mov_b32 s21, 0x0
    s_mov_b32 s22, 0xd0000
    s_mov_b32 s23, 0xc9000
    s_mov_b32 s26, 0x0
    s_mov_b32 s27, 0x0
    s_mov_b32 s30, 0x0
    s_mov_b32 s31, 0xd0000
    s_mov_b32 s32, 0x0
    s_mov_b32 s33, 0xc0000
    s_waitcnt lgkmcnt(0)
    s_mov_b32 s8, s50
    s_and_b32 s9, s51, 0xffff
    s_mov_b32 s10, 2621440
    s_mov_b32 s11, 0x20000
L_par3:
    s_and_b32 s34, s18, 7
    s_lshr_b32 s35, s18, 3
    s_and_b32 s36, s18, 15
    s_lshr_b32 s37, s18, 4
    s_and_b32 s39, s16, 1
    s_bfe_u32 s38, s16, 0x10001
    s_mul_i32 s92, s17, 1179648
    s_add_u32 s92, s92, 10485760
    s_add_u32 s23, s23, s92
    s_add_u32 s22, s22, s92
    s_add_u32 s26, s26, s92
    s_add_u32 s27, s27, s92
    s_add_u32 s30, s30, s92
    s_add_u32 s31, s31, s92
    s_add_u32 s32, s32, s92
    s_add_u32 s33, s33, s92
    s_mul_i32 s56, s17, 20480
    s_add_u32 s21, s21, s56
    s_and_b32 s44, s16, 3
    s_mul_i32 s44, s44, 5120
    s_lshr_b32 s49, s16, 2
    s_mul_i32 s96, s16, 5120
    s_mul_i32 s45, s34, 102400
    s_add_u32 s45, s45, 4718592
    s_add_u32 s45, s45, s44
    s_mul_i32 s46, s36, 122880
    s_add_u32 s46, s46, 5767168
    s_add_u32 s46, s46, s44
    s_mul_i32 s47, s34, 245760
    s_add_u32 s47, s47, 7864320
    s_add_u32 s47, s47, s44
    s_mul_i32 s48, s36, 163840
    s_add_u32 s48, s48, 2097152
    s_add_u32 s48, s48, s44
    s_mul_i32 s41, s18, 163840
    s_add_u32 s41, s41, s20
    s_add_u32 s41, s41, s44
    s_lshl_b32 s50, s25, 15
    s_add_u32 s50, s50, 65536
    s_mul_i32 s51, s18, 0x2aab
    s_lshr_b32 s51, s51, 16
    s_lshl_b32 s51, s51, 11
    s_add_u32 s51, s51, s50
    s_cmp_lg_u32 s49, 0
    s_cselect_b32 s24, s51, s24
    s_add_u32 s95, s18, 32
    s_mul_i32 s95, s95, 0x2aab
    s_lshr_b32 s95, s95, 16
    s_lshl_b32 s95, s95, 11
    s_add_u32 s95, s95, s50
    s_add_u32 s97, s18, 64
    s_mul_i32 s97, s97, 0x2aab
    s_lshr_b32 s97, s97, 16
    s_lshl_b32 s97, s97, 11
    s_add_u32 s97, s97, s50
    v_and_b32 v12, 19, v1
    v_bfe_u32 v13, v1, 2, 1
    v_lshl_or_b32 v12, v13, 3, v12
    v_bfe_u32 v13, v1, 3, 1
    v_lshl_or_b32 v12, v13, 2, v12
    v_lshlrev_b32 v13, 3, v5
    v_xor_b32 v13, v13, v12
    v_lshlrev_b32 v13, 4, v13
    v_lshl_add_u32 v100, v5, 9, v13
    v_and_b32 v101, 3, v12
    v_bfe_u32 v13, v12, 3, 1
    v_lshl_or_b32 v101, v13, 2, v101
    v_bfe_u32 v13, v12, 2, 1
    v_lshl_or_b32 v101, v13, 3, v101
    v_and_b32 v13, 16, v12
    v_or_b32 v101, v101, v13
    v_xor_b32 v101, 264, v101
    v_lshlrev_b32 v101, 3, v101
    v_lshlrev_b32 v12, 30, v5
    v_add_u32 v31, v12, v101
    v_add_u32 v30, v12, v4
    s_mov_b32 s40, s16
    s_mul_i32 s50, s16, 2560
    s_add_u32 s50, s50, 143360
    v_lshlrev_b32 v12, 3, v1
    v_add_u32 v12, s50, v12
    v_and_b32 v13, 7, v1
    v_cmp_eq_u32 vcc, 2, v13
    v_mov_b32 v22, 0x3f803f80
    v_mov_b32 v23, 0x3f80
    v_cndmask_b32 v15, 0, v22, vcc
    v_cmp_eq_u32 vcc, 0, v13
    v_lshrrev_b32 v108, 2, v1
    v_lshlrev_b32 v108, 5, v108
    v_and_or_b32 v108, v1, 3, v108
    v_lshlrev_b32 v108, 2, v108
    v_cndmask_b32 v14, v15, v23, vcc
    ds_write_b64 v12, v[14:15]
    v_mov_b32 v13, 143376
    v_cmp_gt_u32 vcc, 32, v1
    v_sub_u32 v106, 1, v5
    s_nop 0
    v_cndmask_b32 v101, v13, v101, vcc
    s_mov_b32 s28, 0
    s_cmp_ge_u32 s16, 4
    s_cbranch_scc1 L_p1_6
    v_mov_b32 v12, 0
    s_waitcnt vmcnt(0)
    s_mov_b64 exec, 1
    s_cmp_eq_u32 s25, 0
    s_cbranch_scc1 L_p1_6g
    s_cmp_lg_u32 s19, 0
    s_cbranch_scc1 L_p1_6s
    buffer_store_dword v106, v12, s[4:7], s29 offen
    s_branch L_p1_6g
L_p1_6s:
    buffer_store_dword v106, v12, s[4:7], s29 offen sc0 sc1
L_p1_6g:
    buffer_store_dword v106, v12, s[4:7], s24 offen sc0 sc1
    s_mov_b64 exec, -1
    s_barrier
    s_cmp_lg_u32 s25, 0
    s_cbranch_scc1 L_st_skip
    s_load_dwordx2 s[52:53], s[0:1], 16
    s_load_dwordx2 s[54:55], s[0:1], 48
    s_load_dwordx4 s[56:59], s[0:1], 32
    s_mov_b32 s28, 0
    v_bfe_u32 v192, v1, 4, 1
    v_bfe_u32 v193, v1, 2, 2
    v_and_b32 v194, 1, v1
    v_lshlrev_b32 v194, 1, v194
    v_bfe_u32 v195, v1, 1, 1
    v_or_b32 v194, v194, v195
    v_and_b32 v195, 31, v1
    s_lshl_b32 s50, s16, 12
    s_add_u32 s50, s50, 3072
    s_cmp_eq_u32 s16, 0
    s_cselect_b32 s50, 0, s50
    v_lshlrev_b32 v171, 3, v1
    v_add_u32 v171, s50, v171
    v_mov_b32 v172, 0x3f803f80
    v_mov_b32 v173, 0x3f803f80
    v_mov_b32 v174, 0x3f803f80
    v_mov_b32 v175, 0x3f803f80
    s_waitcnt lgkmcnt(0)
    s_mov_b32 s8, s56
    s_and_b32 s9, s57, 0xffff
    s_mov_b32 s10, 0
    s_mov_b32 s11, 0x20000
    s_mov_b32 s12, s58
    s_and_b32 s13, s59, 0xffff
    s_mov_b32 s14, 3072
    s_mov_b32 s15, 0x20000
    s_cmp_lg_u32 s16, 0
    s_cbranch_scc1 L_st_n80a
    s_cmp_ge_u32 s2, 240
    s_cbranch_scc1 L_st_done
    s_cmp_ge_u32 s2, 192
    s_cbranch_scc1 L_st_n80b
    s_mov_b32 s28, 2
    s_mov_b32 s8, s56
    s_and_b32 s9, s57, 0xffff
    s_mov_b32 s10, 1966080
    s_bfe_u32 s90, s2, 0x10002
    s_mul_i32 s90, s90, 24
    s_add_u32 s90, s90, s18
    s_and_b32 s42, s2, 3
    s_mul_i32 s91, s90, 0x5556
    s_lshr_b32 s91, s91, 16
    s_mul_i32 s93, s91, 3
    s_sub_u32 s93, s90, s93
    s_lshl_b32 s90, s90, 5
    v_lshlrev_b32 v196, 4, v192
    v_lshl_add_u32 v196, v194, 2, v196
    v_add_u32 v196, s90, v196
    v_lshl_add_u32 v197, v5, 3, v193
    v_mul_u32_u24 v168, 3072, v197
    v_lshl_add_u32 v168, v196, 1, v168
    s_mov_b32 s84, 49152
    s_mov_b32 s85, 12288
    s_mul_i32 s86, s42, 491520
    v_and_b32 v196, 19, v195
    v_bfe_u32 v197, v195, 2, 1
    v_lshl_or_b32 v196, v197, 3, v196
    v_bfe_u32 v197, v195, 3, 1
    v_lshl_or_b32 v196, v197, 2, v196
    v_add_u32 v196, s90, v196
    v_lshlrev_b32 v170, 1, v196
    buffer_load_ushort v170, v170, s[12:15], 0 offen
    v_mov_b32 v169, v2
    s_mul_i32 s87, s91, 122880
    s_mul_i32 s50, s42, 30720
    s_add_u32 s87, s87, s50
    s_lshl_b32 s50, s93, 10
    s_add_u32 s87, s87, s50
    s_add_u32 s87, s87, 5767168
    s_mov_b32 s88, 3072
    s_lshl_b32 s89, s91, 12
    s_add_u32 s89, s89, s50
    s_lshr_b32 s50, s42, 1
    s_lshl_b32 s50, s50, 9
    s_add_u32 s89, s89, s50
    s_and_b32 s50, s42, 1
    s_lshl_b32 s50, s50, 3
    s_add_u32 s89, s89, s50
    s_add_u32 s89, s89, 294912
    s_mov_b32 s94, s88
    s_branch L_st_done
L_st_n80b:
    s_sub_u32 s50, s2, 192
    s_mul_i32 s90, s50, 0x5556
    s_lshr_b32 s90, s90, 16
    s_mul_i32 s91, s90, 3
    s_sub_u32 s91, s50, s91
    s_and_b32 s93, s90, 7
    s_lshr_b32 s94, s90, 3
    s_add_u32 s94, s94, 32
    s_branch L_st_n80
L_st_n80a:
    s_and_b32 s93, s18, 7
    s_and_b32 s94, s18, 24
    s_add_u32 s94, s94, s17
    s_sub_u32 s91, s16, 1
L_st_n80:
    s_mov_b32 s28, 1
    s_mov_b32 s85, 5120
    s_cmp_lt_u32 s94, 10
    s_cbranch_scc1 L_st_wo
    s_sub_u32 s94, s94, 10
    s_mov_b32 s8, s54
    s_and_b32 s9, s55, 0xffff
    s_mov_b32 s10, 1966080
    s_mov_b32 s84, 40960
    s_mul_i32 s86, s94, 81920
    s_mul_i32 s87, s93, 245760
    s_add_u32 s87, s87, 7864320
    s_mov_b32 s42, 16
    s_mov_b32 s89, 8
    s_branch L_st_go
L_st_wo:
    s_mov_b32 s8, s52
    s_and_b32 s9, s53, 0xffff
    s_mov_b32 s10, 819200
    s_mul_i32 s87, s93, 102400
    s_add_u32 s87, s87, 4718592
    s_mov_b32 s84, 51200
    s_mul_i32 s86, s94, 102400
    s_mov_b32 s42, 20
    s_mov_b32 s89, 8
    s_cmp_lt_u32 s94, 8
    s_cbranch_scc1 L_st_go
    s_mov_b32 s84, 204800
    s_mov_b32 s85, 25600
    s_sub_u32 s86, s94, 8
    s_mul_i32 s86, s86, 409600
    s_add_u32 s86, s86, 20480
    s_mov_b32 s42, 80
    s_mov_b32 s89, 40
L_st_go:
    v_mul_lo_u32 v168, s42, v5
    v_mul_lo_u32 v196, s89, v192
    v_add3_u32 v168, v168, v196, v193
    v_mul_u32_u24 v168, 1280, v168
    s_mul_i32 s50, s93, 160
    s_lshl_b32 s51, s91, 6
    s_add_u32 s50, s50, s51
    s_add_u32 s86, s86, s50
    s_mul_i32 s94, s94, 10240
    s_add_u32 s87, s87, s94
    s_lshl_b32 s50, s91, 11
    s_add_u32 s87, s87, s50
    s_cmp_eq_u32 s91, 2
    s_cselect_b32 s51, 8, 16
    s_mov_b32 s94, 1073741824
    s_cselect_b32 s94, s94, 1024
    s_sub_u32 s88, 5120, s94
    v_and_b32 v196, 3, v1
    v_mul_lo_u32 v196, s51, v196
    v_add_u32 v168, v168, v196
    v_mov_b32 v169, v2
L_st_done:
    s_load_dwordx2 s[52:53], s[0:1], 56
    s_waitcnt lgkmcnt(0)
    s_mov_b32 s12, s52
    s_and_b32 s13, s53, 0xffff
    s_mov_b32 s14, 1280
    s_mov_b32 s15, 0x20000
L_st_skip:
    v_bfe_u32 v12, v1, 2, 2
    v_and_b32 v13, 1, v1
    v_xor_b32 v14, v13, v5
    v_lshl_add_u32 v14, v14, 3, v12
    v_lshlrev_b32 v14, 4, v14
    v_lshl_add_u32 v14, v13, 9, v14
    v_bfe_u32 v13, v1, 1, 1
    v_lshl_add_u32 v14, v13, 3, v14
    v_lshlrev_b32 v12, 3, v12
    v_lshl_add_u32 v12, v5, 5, v12
    v_xor_b32 v13, 1, v13
    v_lshlrev_b32 v13, 3, v13
    v_and_b32 v15, 16, v1
    v_cmp_eq_u32 s[50:51], 0, v15
    v_and_b32 v15, 19, v1
    v_cmp_lt_u32 vcc, 16, v15
    v_mov_b32 v15, 1
    s_nop 0
    v_cndmask_b32 v107, v15, 0, vcc
    v_add_u32 v22, 1024, v14
    v_add_u32 v23, 2368, v12
    v_add_u32 v15, 143552, v13
    v_cndmask_b32 v102, v23, v22, s[50:51]
    v_cndmask_b32 v102, v102, v15, vcc
    v_mov_b32 v8, v102
    v_add_u32 v22, 1088, v14
    v_add_u32 v23, 2304, v12
    v_add_u32 v15, 143488, v13
    v_cndmask_b32 v103, v23, v22, s[50:51]
    v_cndmask_b32 v103, v103, v15, vcc
    v_mov_b32 v9, v103
    v_add_u32 v22, 1280, v14
    v_add_u32 v23, 2496, v12
    v_add_u32 v15, 143424, v13
    v_cndmask_b32 v104, v23, v22, s[50:51]
    v_cndmask_b32 v104, v104, v15, vcc
    v_mov_b32 v10, v104
    v_add_u32 v22, 1344, v14
    v_add_u32 v23, 2432, v12
    v_add_u32 v15, 143360, v13
    v_cndmask_b32 v105, v23, v22, s[50:51]
    v_cndmask_b32 v105, v105, v15, vcc
    v_mov_b32 v11, v105
    v_mov_b32 v6, v100
    v_mov_b32 v7, v101
    v_mov_b32 v84, 0
    v_mov_b32 v85, 0
    v_mov_b32 v86, 0
    v_mov_b32 v87, 0
    v_mov_b32 v88, 0
    v_mov_b32 v89, 0
    v_mov_b32 v90, 0
    v_mov_b32 v91, 0
    v_mov_b32 v92, 0
    v_mov_b32 v93, 0
    v_mov_b32 v94, 0
    v_mov_b32 v95, 0
    v_mov_b32 v96, 0
    v_mov_b32 v97, 0
    v_mov_b32 v98, 0
    v_mov_b32 v99, 0
    v_mov_b32 v40, 0
    v_mov_b32 v41, 0
    v_mov_b32 v42, 0
    v_mov_b32 v43, 0
    v_mov_b32 v48, 0
    v_mov_b32 v49, 0
    v_mov_b32 v50, 0
    v_mov_b32 v51, 0
    v_mov_b32 v82, 0
    v_mov_b32 v83, 0
    s_and_b32 s51, s16, 3
    s_lshl2_add_u32 s50, s18, s51
    s_mul_i32 s50, s50, 6528
    s_add_u32 s92, s92, s50
    s_lshl1_add_u32 s50, s35, s39
    s_mul_i32 s50, s50, 40960
    s_mul_i32 s51, s34, 5120
    s_add_u32 s22, s22, s50
    s_add_u32 s22, s22, s51
    v_add_u32 v110, 4096, v2
    v_and_b32 v109, 31, v1
    v_lshlrev_b32 v109, 2, v109
    s_lshr_b32 s56, s18, 1
    s_add_u32 s56, s56, 32
    s_mul_i32 s56, s56, 163840
    s_lshl3_add_u32 s57, s17, s16
    s_mul_i32 s57, s57, 2560
    s_add_u32 s56, s56, s57
    s_add_u32 s56, s56, s20
    s_and_b32 s57, s18, 1
    s_lshl_b32 s58, s57, 10
    s_add_u32 s58, s58, s56
    s_lshl_b32 s57, s57, 8
    s_add_u32 s57, s57, s56
    s_mul_i32 s59, s18, 163840
    s_add_u32 s59, s59, s20
    s_mul_i32 s56, s17, 20480
    s_add_u32 s59, s59, s56
    s_branch L_p2_7
L_p1_6:
    v_bfe_u32 v12, v1, 2, 2
    v_and_b32 v13, 1, v1
    v_xor_b32 v14, v13, v5
    v_lshl_add_u32 v14, v14, 3, v12
    v_lshlrev_b32 v14, 4, v14
    v_lshl_add_u32 v14, v13, 9, v14
    v_bfe_u32 v13, v1, 1, 1
    v_lshl_add_u32 v14, v13, 3, v14
    v_lshlrev_b32 v12, 3, v12
    v_lshl_add_u32 v12, v5, 5, v12
    v_xor_b32 v13, 1, v13
    v_lshlrev_b32 v13, 3, v13
    v_and_b32 v15, 16, v1
    v_cmp_eq_u32 s[50:51], 0, v15
    v_and_b32 v15, 19, v1
    v_cmp_lt_u32 vcc, 16, v15
    v_mov_b32 v15, 1
    s_nop 0
    v_cndmask_b32 v107, v15, 0, vcc
    v_add_u32 v22, 1024, v14
    v_add_u32 v23, 2368, v12
    v_add_u32 v15, 143552, v13
    v_cndmask_b32 v102, v23, v22, s[50:51]
    v_cndmask_b32 v102, v102, v15, vcc
    v_mov_b32 v8, v102
    v_add_u32 v22, 1088, v14
    v_add_u32 v23, 2304, v12
    v_add_u32 v15, 143488, v13
    v_cndmask_b32 v103, v23, v22, s[50:51]
    v_cndmask_b32 v103, v103, v15, vcc
    v_mov_b32 v9, v103
    v_add_u32 v22, 1280, v14
    v_add_u32 v23, 2496, v12
    v_add_u32 v15, 143424, v13
    v_cndmask_b32 v104, v23, v22, s[50:51]
    v_cndmask_b32 v104, v104, v15, vcc
    v_mov_b32 v10, v104
    v_add_u32 v22, 1344, v14
    v_add_u32 v23, 2432, v12
    v_add_u32 v15, 143360, v13
    v_cndmask_b32 v105, v23, v22, s[50:51]
    v_cndmask_b32 v105, v105, v15, vcc
    v_mov_b32 v11, v105
    v_mov_b32 v6, v100
    v_mov_b32 v7, v101
    v_mov_b32 v84, 0
    v_mov_b32 v85, 0
    v_mov_b32 v86, 0
    v_mov_b32 v87, 0
    v_mov_b32 v88, 0
    v_mov_b32 v89, 0
    v_mov_b32 v90, 0
    v_mov_b32 v91, 0
    v_mov_b32 v92, 0
    v_mov_b32 v93, 0
    v_mov_b32 v94, 0
    v_mov_b32 v95, 0
    v_mov_b32 v96, 0
    v_mov_b32 v97, 0
    v_mov_b32 v98, 0
    v_mov_b32 v99, 0
    v_mov_b32 v40, 0
    v_mov_b32 v41, 0
    v_mov_b32 v42, 0
    v_mov_b32 v43, 0
    v_mov_b32 v48, 0
    v_mov_b32 v49, 0
    v_mov_b32 v50, 0
    v_mov_b32 v51, 0
    v_mov_b32 v82, 0
    v_mov_b32 v83, 0
    s_and_b32 s51, s16, 3
    s_lshl2_add_u32 s50, s18, s51
    s_mul_i32 s50, s50, 6528
    s_add_u32 s92, s92, s50
    s_lshl1_add_u32 s50, s35, s39
    s_mul_i32 s50, s50, 40960
    s_mul_i32 s51, s34, 5120
    s_add_u32 s22, s22, s50
    s_add_u32 s22, s22, s51
    v_add_u32 v110, 4096, v2
    v_and_b32 v109, 31, v1
    v_lshlrev_b32 v109, 2, v109
    s_lshr_b32 s56, s18, 1
    s_add_u32 s56, s56, 32
    s_mul_i32 s56, s56, 163840
    s_lshl3_add_u32 s57, s17, s16
    s_mul_i32 s57, s57, 2560
    s_add_u32 s56, s56, s57
    s_add_u32 s56, s56, s20
    s_and_b32 s57, s18, 1
    s_lshl_b32 s58, s57, 10
    s_add_u32 s58, s58, s56
    s_lshl_b32 s57, s57, 8
    s_add_u32 s57, s57, s56
    s_mul_i32 s59, s18, 163840
    s_add_u32 s59, s59, s20
    s_mul_i32 s56, s17, 20480
    s_add_u32 s59, s59, s56
    s_cmp_lg_u32 s16, 4
    s_cbranch_scc1 L_p1_6o
    v_lshrrev_b32 v253, 3, v1
    v_mov_b32 v254, s24
    v_mov_b32 v255, s95
    v_cmp_eq_u32 vcc, 1, v253
    v_and_b32 v252, 7, v1
    s_nop 0
    v_cndmask_b32 v254, v254, v255, vcc
    v_mov_b32 v255, s97
    v_cmp_eq_u32 vcc, 2, v253
    s_lshl_b32 s54, s17, 8
    s_nop 0
    v_cndmask_b32 v254, v254, v255, vcc
    s_cmp_lg_u32 s25, 0
    s_cbranch_scc1 L_p1_6l
    v_and_b32 v253, 0x8c, v108
    v_add_u32 v254, v254, v253
    s_branch L_p1_6p
L_p1_6l:
    v_bfe_u32 v254, v254, 11, 4
    v_lshlrev_b32 v254, 2, v254
    v_lshl_add_u32 v254, v252, 7, v254
    s_add_u32 s54, s23, 3072
L_p1_6p:
    s_mov_b32 s55, 0x100000
    s_barrier
L_qp_9:
    buffer_load_dword v252, v254, s[4:7], s54 offen sc1
    s_sub_u32 s55, s55, 1
    s_cbranch_scc1 L_p2_7
    s_waitcnt vmcnt(0)
    v_cmp_eq_u32 vcc, 0, v252
    s_cbranch_vccnz L_qp_9
    s_branch L_p2_7
L_p1_6o:
    s_barrier
L_p2_7:
    s_load_dwordx2 s[90:91], s[0:1], 0
    s_barrier
    s_mov_b32 s29, 0
    buffer_load_dwordx4 v[16:19], v3, s[4:7], s58 offen sc1
    buffer_load_dwordx4 v[24:27], v100, s[4:7], s59 offen
    buffer_load_dwordx2 v[20:21], v30, s[4:7], s57 offen sc1
    buffer_load_dwordx2 v[28:29], v31, s[4:7], s59 offen
    s_mul_i32 s56, s16, 2560
    s_min_u32 s56, s56, 17408
    s_mov_b32 m0, s56
    s_add_u32 s50, s59, s56
    buffer_load_dwordx4 v2, s[4:7], s50 offen offset:0 lds
    buffer_load_dwordx4 v2, s[4:7], s50 offen offset:1024 lds
    buffer_load_dwordx4 v2, s[4:7], s50 offen offset:2048 lds
    v_cmp_gt_u32 vcc, 32, v1
    v_mov_b32 v22, 0x3f803f80
    s_waitcnt vmcnt(3)
    v_cndmask_b32 v28, v22, v28, vcc
    v_cndmask_b32 v29, v22, v29, vcc
    v_mfma_f32_32x32x16_bf16 v[52:67], v[24:27], v[16:19], 0
    s_nop 0
    v_mfma_f32_32x32x8_bf16 v[52:67], v[28:29], v[20:21], v[52:67]
    s_nop 12
    v_max3_f32 v22, v52, v53, v54
    v_max_f32 v22, v22, v55
    v_max3_f32 v22, v22, v56, v57
    v_max3_f32 v22, v22, v58, v59
    v_max3_f32 v22, v22, v60, v61
    v_max3_f32 v22, v22, v62, v63
    v_max3_f32 v22, v22, v64, v65
    v_max3_f32 v22, v22, v66, v67
    v_mov_b32 v12, v22
    s_nop 1
    v_permlane32_swap_b32 v22, v12
    s_nop 1
    v_max_f32 v22, v22, v12
    v_sub_f32 v12, 0, v22
    v_and_b32 v13, 0xffff0000, v12
    v_sub_f32 v12, v12, v13
    v_and_b32 v14, 0xffff0000, v12
    v_sub_f32 v12, v12, v14
    v_lshrrev_b32 v13, 16, v13
    v_cmp_gt_u32 vcc, 32, v1
    v_or_b32 v13, v13, v14
    v_lshrrev_b32 v12, 16, v12
    v_cndmask_b32 v20, v13, v20, vcc
    v_cndmask_b32 v21, v12, v21, vcc
    s_nop 1
    v_mfma_f32_32x32x16_bf16 v[52:67], v[24:27], v[16:19], 0
    v_mfma_f32_32x32x8_bf16 v[52:67], v[28:29], v[20:21], v[52:67]
    v_and_b32 v12, 15, v1
    s_lshl_b32 s50, s38, 4
    v_lshrrev_b32 v13, 4, v1
    v_add_u32 v12, s50, v12
    v_lshlrev_b32 v23, 4, v12
    v_lshl_add_u32 v22, v13, 9, v23
    v_lshl_add_u32 v23, v5, 9, v23
    v_add_u32 v23, 4096, v23
    s_cmp_lg_u32 s49, 0
    s_cselect_b64 vcc, -1, 0
    s_nop 1
    v_cndmask_b32 v22, v22, v2, vcc
    v_cndmask_b32 v23, v23, v110, vcc
    buffer_load_dword v252, v108, s[4:7], s95 offen sc1
    buffer_load_dword v253, v108, s[4:7], s97 offen sc1
    s_waitcnt vmcnt(2) lgkmcnt(0)
    s_barrier
    ds_read_b64_tr_b16 v[36:37], v10
    ds_read_b64_tr_b16 v[38:39], v11
    ds_read_b128 v[24:27], v6 offset:2560
    ds_read_b64 v[28:29], v7 offset:2560
    ds_read_b64_tr_b16 v[32:33], v8
    ds_read_b64_tr_b16 v[34:35], v9
    s_setprio 3
    s_nop 3
    v_exp_f32 v52, v52
    v_cvt_pk_bf16_f32 v51, v82, v83
    v_exp_f32 v53, v53
    v_exp_f32 v54, v54
    v_mfma_f32_32x32x16_bf16 v[84:99], v[40:43], v[48:51], v[84:99]
    ds_read_b64_tr_b16 v[40:41], v10 offset:2560
    ds_read_b64_tr_b16 v[42:43], v11 offset:2560
    v_cvt_pk_bf16_f32 v44, v52, v53
    v_exp_f32 v55, v55
    v_exp_f32 v56, v56
    v_cvt_pk_bf16_f32 v45, v54, v55
    v_exp_f32 v57, v57
    v_exp_f32 v58, v58
    s_waitcnt lgkmcnt(2)
    v_mfma_f32_32x32x16_bf16 v[68:83], v[24:27], v[16:19], 0
    ds_read_b128 v[24:27], v6 offset:5120
    v_cvt_pk_bf16_f32 v46, v56, v57
    v_exp_f32 v59, v59
    v_exp_f32 v60, v60
    v_cvt_pk_bf16_f32 v47, v58, v59
    v_exp_f32 v61, v61
    v_exp_f32 v62, v62
    v_mfma_f32_32x32x8_bf16 v[68:83], v[28:29], v[20:21], v[68:83]
    ds_read_b64 v[28:29], v7 offset:5120
    s_xor_b32 s54, s17, 1
    s_mul_i32 s93, s54, 20480
    s_add_u32 s93, s93, s41
    s_sub_u32 s93, s93, s44
    s_mul_i32 s56, s16, 2560
    s_min_u32 s56, s56, 17408
    s_add_u32 s93, s93, s56
    s_cmp_eq_u32 s29, 0
    s_cbranch_scc1 L_ool_11
L_back_12:
    s_add_u32 m0, s56, 20480
    s_nop 0
    buffer_load_dwordx4 v2, s[4:7], s93 offen offset:0 lds
    v_cvt_pk_bf16_f32 v48, v60, v61
    v_exp_f32 v63, v63
    v_exp_f32 v64, v64
    v_cvt_pk_bf16_f32 v49, v62, v63
    v_exp_f32 v65, v65
    v_exp_f32 v66, v66
    v_mfma_f32_32x32x16_bf16 v[84:99], v[32:35], v[44:47], v[84:99]
    ds_read_b64_tr_b16 v[32:33], v8 offset:2560
    ds_read_b64_tr_b16 v[34:35], v9 offset:2560
    v_cvt_pk_bf16_f32 v50, v64, v65
    v_exp_f32 v67, v67
    v_exp_f32 v68, v68
    v_cvt_pk_bf16_f32 v51, v66, v67
    v_exp_f32 v69, v69
    v_exp_f32 v70, v70
    v_mfma_f32_32x32x16_bf16 v[84:99], v[36:39], v[48:51], v[84:99]
    ds_read_b64_tr_b16 v[36:37], v10 offset:5120
    ds_read_b64_tr_b16 v[38:39], v11 offset:5120
    v_cvt_pk_bf16_f32 v44, v68, v69
    v_exp_f32 v71, v71
    v_exp_f32 v72, v72
    v_cvt_pk_bf16_f32 v45, v70, v71
    v_exp_f32 v73, v73
    v_exp_f32 v74, v74
    s_waitcnt lgkmcnt(2)
    v_mfma_f32_32x32x16_bf16 v[52:67], v[24:27], v[16:19], 0
    ds_read_b128 v[24:27], v6 offset:7680
    buffer_load_dwordx4 v2, s[4:7], s93 offen offset:1024 lds
    v_cvt_pk_bf16_f32 v46, v72, v73
    v_exp_f32 v75, v75
    v_exp_f32 v76, v76
    v_cvt_pk_bf16_f32 v47, v74, v75
    v_exp_f32 v77, v77
    v_exp_f32 v78, v78
    v_mfma_f32_32x32x8_bf16 v[52:67], v[28:29], v[20:21], v[52:67]
    ds_read_b64 v[28:29], v7 offset:7680
    buffer_load_dwordx4 v2, s[4:7], s93 offen offset:2048 lds
    v_cvt_pk_bf16_f32 v48, v76, v77
    v_exp_f32 v79, v79
    v_exp_f32 v80, v80
    v_cvt_pk_bf16_f32 v49, v78, v79
    v_exp_f32 v81, v81
    v_exp_f32 v82, v82
    v_mfma_f32_32x32x16_bf16 v[84:99], v[32:35], v[44:47], v[84:99]
    ds_read_b64_tr_b16 v[32:33], v8 offset:5120
    ds_read_b64_tr_b16 v[34:35], v9 offset:5120
    v_cvt_pk_bf16_f32 v50, v80, v81
    v_exp_f32 v83, v83
    v_exp_f32 v52, v52
    v_cvt_pk_bf16_f32 v51, v82, v83
    v_exp_f32 v53, v53
    v_exp_f32 v54, v54
    v_mfma_f32_32x32x16_bf16 v[84:99], v[40:43], v[48:51], v[84:99]
    ds_read_b64_tr_b16 v[40:41], v10 offset:7680
    ds_read_b64_tr_b16 v[42:43], v11 offset:7680
    v_cvt_pk_bf16_f32 v44, v52, v53
    v_exp_f32 v55, v55
    v_exp_f32 v56, v56
    v_cvt_pk_bf16_f32 v45, v54, v55
    v_exp_f32 v57, v57
    v_exp_f32 v58, v58
    s_waitcnt lgkmcnt(2)
    v_mfma_f32_32x32x16_bf16 v[68:83], v[24:27], v[16:19], 0
    ds_read_b128 v[24:27], v6 offset:10240
    s_setprio 2
    v_cvt_pk_bf16_f32 v46, v56, v57
    v_exp_f32 v59, v59
    v_exp_f32 v60, v60
    v_cvt_pk_bf16_f32 v47, v58, v59
    v_exp_f32 v61, v61
    v_exp_f32 v62, v62
    v_mfma_f32_32x32x8_bf16 v[68:83], v[28:29], v[20:21], v[68:83]
    ds_read_b64 v[28:29], v7 offset:10240
    v_cvt_pk_bf16_f32 v48, v60, v61
    v_exp_f32 v63, v63
    v_exp_f32 v64, v64
    v_cvt_pk_bf16_f32 v49, v62, v63
    v_exp_f32 v65, v65
    v_exp_f32 v66, v66
    v_mfma_f32_32x32x16_bf16 v[84:99], v[32:35], v[44:47], v[84:99]
    ds_read_b64_tr_b16 v[32:33], v8 offset:7680
    ds_read_b64_tr_b16 v[34:35], v9 offset:7680
    v_cvt_pk_bf16_f32 v50, v64, v65
    v_exp_f32 v67, v67
    v_exp_f32 v68, v68
    v_cvt_pk_bf16_f32 v51, v66, v67
    v_exp_f32 v69, v69
    v_exp_f32 v70, v70
    v_mfma_f32_32x32x16_bf16 v[84:99], v[36:39], v[48:51], v[84:99]
    ds_read_b64_tr_b16 v[36:37], v10 offset:10240
    ds_read_b64_tr_b16 v[38:39], v11 offset:10240
    v_cvt_pk_bf16_f32 v44, v68, v69
    v_exp_f32 v71, v71
    v_exp_f32 v72, v72
    v_cvt_pk_bf16_f32 v45, v70, v71
    v_exp_f32 v73, v73
    v_exp_f32 v74, v74
    s_waitcnt lgkmcnt(2)
    v_mfma_f32_32x32x16_bf16 v[52:67], v[24:27], v[16:19], 0
    ds_read_b128 v[24:27], v6 offset:12800
    v_cvt_pk_bf16_f32 v46, v72, v73
    v_exp_f32 v75, v75
    v_exp_f32 v76, v76
    v_cvt_pk_bf16_f32 v47, v74, v75
    v_exp_f32 v77, v77
    v_exp_f32 v78, v78
    v_mfma_f32_32x32x8_bf16 v[52:67], v[28:29], v[20:21], v[52:67]
    ds_read_b64 v[28:29], v7 offset:12800
    s_cmp_eq_u32 s29, 0
    s_cbranch_scc1 L_ool_15
L_back_16:
    v_cvt_pk_bf16_f32 v48, v76, v77
    v_exp_f32 v79, v79
    v_exp_f32 v80, v80
    v_cvt_pk_bf16_f32 v49, v78, v79
    v_exp_f32 v81, v81
    v_exp_f32 v82, v82
    v_mfma_f32_32x32x16_bf16 v[84:99], v[32:35], v[44:47], v[84:99]
    ds_read_b64_tr_b16 v[32:33], v8 offset:10240
    ds_read_b64_tr_b16 v[34:35], v9 offset:10240
    v_cvt_pk_bf16_f32 v50, v80, v81
    v_exp_f32 v83, v83
    v_exp_f32 v52, v52
    v_cvt_pk_bf16_f32 v51, v82, v83
    v_exp_f32 v53, v53
    v_exp_f32 v54, v54
    v_mfma_f32_32x32x16_bf16 v[84:99], v[40:43], v[48:51], v[84:99]
    ds_read_b64_tr_b16 v[40:41], v10 offset:12800
    ds_read_b64_tr_b16 v[42:43], v11 offset:12800
    v_cvt_pk_bf16_f32 v44, v52, v53
    v_exp_f32 v55, v55
    v_exp_f32 v56, v56
    v_cvt_pk_bf16_f32 v45, v54, v55
    v_exp_f32 v57, v57
    v_exp_f32 v58, v58
    s_waitcnt lgkmcnt(2)
    v_mfma_f32_32x32x16_bf16 v[68:83], v[24:27], v[16:19], 0
    ds_read_b128 v[24:27], v6 offset:15360
    s_setprio 1
    v_cvt_pk_bf16_f32 v46, v56, v57
    v_exp_f32 v59, v59
    v_exp_f32 v60, v60
    v_cvt_pk_bf16_f32 v47, v58, v59
    v_exp_f32 v61, v61
    v_exp_f32 v62, v62
    v_mfma_f32_32x32x8_bf16 v[68:83], v[28:29], v[20:21], v[68:83]
    ds_read_b64 v[28:29], v7 offset:15360
    v_cvt_pk_bf16_f32 v48, v60, v61
    v_exp_f32 v63, v63
    v_exp_f32 v64, v64
    v_cvt_pk_bf16_f32 v49, v62, v63
    v_exp_f32 v65, v65
    v_exp_f32 v66, v66
    v_mfma_f32_32x32x16_bf16 v[84:99], v[32:35], v[44:47], v[84:99]
    ds_read_b64_tr_b16 v[32:33], v8 offset:12800
    ds_read_b64_tr_b16 v[34:35], v9 offset:12800
    v_cvt_pk_bf16_f32 v50, v64, v65
    v_exp_f32 v67, v67
    v_exp_f32 v68, v68
    v_cvt_pk_bf16_f32 v51, v66, v67
    v_exp_f32 v69, v69
    v_exp_f32 v70, v70
    v_mfma_f32_32x32x16_bf16 v[84:99], v[36:39], v[48:51], v[84:99]
    ds_read_b64_tr_b16 v[36:37], v10 offset:15360
    ds_read_b64_tr_b16 v[38:39], v11 offset:15360
    v_cvt_pk_bf16_f32 v44, v68, v69
    v_exp_f32 v71, v71
    v_exp_f32 v72, v72
    v_cvt_pk_bf16_f32 v45, v70, v71
    v_exp_f32 v73, v73
    v_exp_f32 v74, v74
    s_waitcnt lgkmcnt(2)
    v_mfma_f32_32x32x16_bf16 v[52:67], v[24:27], v[16:19], 0
    ds_read_b128 v[24:27], v6 offset:17920
    s_setprio 0
    s_xor_b32 s54, s17, 2
    s_mul_i32 s93, s54, 20480
    s_add_u32 s93, s93, s41
    s_sub_u32 s93, s93, s44
    s_mul_i32 s56, s16, 2560
    s_min_u32 s56, s56, 17408
    s_add_u32 s93, s93, s56
    s_cmp_eq_u32 s29, 0
    s_cbranch_scc1 L_ool_17
L_back_18:
    s_add_u32 m0, s56, 40960
    s_nop 0
    buffer_load_dwordx4 v2, s[4:7], s93 offen offset:0 lds
    v_cvt_pk_bf16_f32 v46, v72, v73
    v_exp_f32 v75, v75
    v_exp_f32 v76, v76
    v_cvt_pk_bf16_f32 v47, v74, v75
    v_exp_f32 v77, v77
    v_exp_f32 v78, v78
    v_mfma_f32_32x32x8_bf16 v[52:67], v[28:29], v[20:21], v[52:67]
    ds_read_b64 v[28:29], v7 offset:17920
    buffer_load_dwordx4 v2, s[4:7], s93 offen offset:1024 lds
    v_cvt_pk_bf16_f32 v48, v76, v77
    v_exp_f32 v79, v79
    v_exp_f32 v80, v80
    v_cvt_pk_bf16_f32 v49, v78, v79
    v_exp_f32 v81, v81
    v_exp_f32 v82, v82
    v_mfma_f32_32x32x16_bf16 v[84:99], v[32:35], v[44:47], v[84:99]
    ds_read_b64_tr_b16 v[32:33], v8 offset:15360
    ds_read_b64_tr_b16 v[34:35], v9 offset:15360
    v_cvt_pk_bf16_f32 v50, v80, v81
    v_exp_f32 v83, v83
    v_exp_f32 v52, v52
    v_cvt_pk_bf16_f32 v51, v82, v83
    v_exp_f32 v53, v53
    v_exp_f32 v54, v54
    v_mfma_f32_32x32x16_bf16 v[84:99], v[40:43], v[48:51], v[84:99]
    ds_read_b64_tr_b16 v[40:41], v10 offset:17920
    ds_read_b64_tr_b16 v[42:43], v11 offset:17920
    v_cvt_pk_bf16_f32 v44, v52, v53
    v_exp_f32 v55, v55
    v_exp_f32 v56, v56
    v_cvt_pk_bf16_f32 v45, v54, v55
    v_exp_f32 v57, v57
    v_exp_f32 v58, v58
    s_waitcnt lgkmcnt(2)
    v_mfma_f32_32x32x16_bf16 v[68:83], v[24:27], v[16:19], 0
    s_mov_b32 s43, 20480
    v_add_u32 v6, s43, v100
    v_mad_u32_u24 v7, s43, v106, v101
    s_waitcnt vmcnt(2)
    s_barrier
    ds_read_b128 v[24:27], v6 offset:0
    s_setprio 3
    buffer_load_dwordx4 v2, s[4:7], s93 offen offset:2048 lds
    v_cvt_pk_bf16_f32 v46, v56, v57
    v_exp_f32 v59, v59
    v_exp_f32 v60, v60
    v_cvt_pk_bf16_f32 v47, v58, v59
    v_exp_f32 v61, v61
    v_exp_f32 v62, v62
    v_mfma_f32_32x32x8_bf16 v[68:83], v[28:29], v[20:21], v[68:83]
    ds_read_b64 v[28:29], v7 offset:0
    v_cvt_pk_bf16_f32 v48, v60, v61
    v_exp_f32 v63, v63
    v_exp_f32 v64, v64
    v_cvt_pk_bf16_f32 v49, v62, v63
    v_exp_f32 v65, v65
    v_exp_f32 v66, v66
    v_mfma_f32_32x32x16_bf16 v[84:99], v[32:35], v[44:47], v[84:99]
    ds_read_b64_tr_b16 v[32:33], v8 offset:17920
    ds_read_b64_tr_b16 v[34:35], v9 offset:17920
    v_cvt_pk_bf16_f32 v50, v64, v65
    v_exp_f32 v67, v67
    v_mad_u32_u24 v10, s43, v107, v104
    v_exp_f32 v68, v68
    v_cvt_pk_bf16_f32 v51, v66, v67
    v_mad_u32_u24 v11, s43, v107, v105
    v_exp_f32 v69, v69
    v_exp_f32 v70, v70
    v_mfma_f32_32x32x16_bf16 v[84:99], v[36:39], v[48:51], v[84:99]
    ds_read_b64_tr_b16 v[36:37], v10 offset:0
    ds_read_b64_tr_b16 v[38:39], v11 offset:0
    v_mad_u32_u24 v8, s43, v107, v102
    v_mad_u32_u24 v9, s43, v107, v103
    v_cvt_pk_bf16_f32 v44, v68, v69
    v_exp_f32 v71, v71
    v_exp_f32 v72, v72
    v_cvt_pk_bf16_f32 v45, v70, v71
    v_exp_f32 v73, v73
    v_exp_f32 v74, v74
    s_waitcnt lgkmcnt(2)
    v_mfma_f32_32x32x16_bf16 v[52:67], v[24:27], v[16:19], 0
    ds_read_b128 v[24:27], v6 offset:2560
    v_cvt_pk_bf16_f32 v46, v72, v73
    v_exp_f32 v75, v75
    v_exp_f32 v76, v76
    v_cvt_pk_bf16_f32 v47, v74, v75
    v_exp_f32 v77, v77
    v_exp_f32 v78, v78
    v_mfma_f32_32x32x8_bf16 v[52:67], v[28:29], v[20:21], v[52:67]
    ds_read_b64 v[28:29], v7 offset:2560
    s_cmp_ge_u32 s28, 1
    s_cbranch_scc1 L_ool_21
L_back_22:
    v_cvt_pk_bf16_f32 v48, v76, v77
    v_exp_f32 v79, v79
    v_exp_f32 v80, v80
    v_cvt_pk_bf16_f32 v49, v78, v79
    v_exp_f32 v81, v81
    v_exp_f32 v82, v82
    v_mfma_f32_32x32x16_bf16 v[84:99], v[32:35], v[44:47], v[84:99]
    ds_read_b64_tr_b16 v[32:33], v8 offset:0
    ds_read_b64_tr_b16 v[34:35], v9 offset:0
    v_cvt_pk_bf16_f32 v50, v80, v81
    v_exp_f32 v83, v83
    v_exp_f32 v52, v52
    v_cvt_pk_bf16_f32 v51, v82, v83
    v_exp_f32 v53, v53
    v_exp_f32 v54, v54
    v_mfma_f32_32x32x16_bf16 v[84:99], v[40:43], v[48:51], v[84:99]
    ds_read_b64_tr_b16 v[40:41], v10 offset:2560
    ds_read_b64_tr_b16 v[42:43], v11 offset:2560
    v_cvt_pk_bf16_f32 v44, v52, v53
    v_exp_f32 v55, v55
    v_exp_f32 v56, v56
    v_cvt_pk_bf16_f32 v45, v54, v55
    v_exp_f32 v57, v57
    v_exp_f32 v58, v58
    s_waitcnt lgkmcnt(2)
    v_mfma_f32_32x32x16_bf16 v[68:83], v[24:27], v[16:19], 0
    ds_read_b128 v[24:27], v6 offset:5120
    v_cvt_pk_bf16_f32 v46, v56, v57
    v_exp_f32 v59, v59
    v_exp_f32 v60, v60
    v_cvt_pk_bf16_f32 v47, v58, v59
    v_exp_f32 v61, v61
    v_exp_f32 v62, v62
    v_mfma_f32_32x32x8_bf16 v[68:83], v[28:29], v[20:21], v[68:83]
    ds_read_b64 v[28:29], v7 offset:5120
    s_cmp_ge_u32 s28, 1
    s_cbranch_scc1 L_ool_25
L_back_26:
    v_cvt_pk_bf16_f32 v48, v60, v61
    v_exp_f32 v63, v63
    v_exp_f32 v64, v64
    v_cvt_pk_bf16_f32 v49, v62, v63
    v_exp_f32 v65, v65
    v_exp_f32 v66, v66
    v_mfma_f32_32x32x16_bf16 v[84:99], v[32:35], v[44:47], v[84:99]
    ds_read_b64_tr_b16 v[32:33], v8 offset:2560
    ds_read_b64_tr_b16 v[34:35], v9 offset:2560
    v_cvt_pk_bf16_f32 v50, v64, v65
    v_exp_f32 v67, v67
    v_exp_f32 v68, v68
    v_cvt_pk_bf16_f32 v51, v66, v67
    v_exp_f32 v69, v69
    v_exp_f32 v70, v70
    v_mfma_f32_32x32x16_bf16 v[84:99], v[36:39], v[48:51], v[84:99]
    ds_read_b64_tr_b16 v[36:37], v10 offset:5120
    ds_read_b64_tr_b16 v[38:39], v11 offset:5120
    v_cvt_pk_bf16_f32 v44, v68, v69
    v_exp_f32 v71, v71
    v_exp_f32 v72, v72
    v_cvt_pk_bf16_f32 v45, v70, v71
    v_exp_f32 v73, v73
    v_exp_f32 v74, v74
    s_waitcnt lgkmcnt(2)
    v_mfma_f32_32x32x16_bf16 v[52:67], v[24:27], v[16:19], 0
    ds_read_b128 v[24:27], v6 offset:7680
    s_setprio 2
    v_cvt_pk_bf16_f32 v46, v72, v73
    v_exp_f32 v75, v75
    v_exp_f32 v76, v76
    v_cvt_pk_bf16_f32 v47, v74, v75
    v_exp_f32 v77, v77
    v_exp_f32 v78, v78
    v_mfma_f32_32x32x8_bf16 v[52:67], v[28:29], v[20:21], v[52:67]
    ds_read_b64 v[28:29], v7 offset:7680
    s_cmp_ge_u32 s28, 2
    s_cbranch_scc1 L_ool_29
L_back_30:
    v_cvt_pk_bf16_f32 v48, v76, v77
    v_exp_f32 v79, v79
    v_exp_f32 v80, v80
    v_cvt_pk_bf16_f32 v49, v78, v79
    v_exp_f32 v81, v81
    v_exp_f32 v82, v82
    v_mfma_f32_32x32x16_bf16 v[84:99], v[32:35], v[44:47], v[84:99]
    ds_read_b64_tr_b16 v[32:33], v8 offset:5120
    ds_read_b64_tr_b16 v[34:35], v9 offset:5120
    v_cvt_pk_bf16_f32 v50, v80, v81
    v_exp_f32 v83, v83
    v_exp_f32 v52, v52
    v_cvt_pk_bf16_f32 v51, v82, v83
    v_exp_f32 v53, v53
    v_exp_f32 v54, v54
    v_mfma_f32_32x32x16_bf16 v[84:99], v[40:43], v[48:51], v[84:99]
    ds_read_b64_tr_b16 v[40:41], v10 offset:7680
    ds_read_b64_tr_b16 v[42:43], v11 offset:7680
    v_cvt_pk_bf16_f32 v44, v52, v53
    v_exp_f32 v55, v55
    v_exp_f32 v56, v56
    v_cvt_pk_bf16_f32 v45, v54, v55
    v_exp_f32 v57, v57
    v_exp_f32 v58, v58
    s_waitcnt lgkmcnt(2)
    v_mfma_f32_32x32x16_bf16 v[68:83], v[24:27], v[16:19], 0
    ds_read_b128 v[24:27], v6 offset:10240
    v_cvt_pk_bf16_f32 v46, v56, v57
    v_exp_f32 v59, v59
    v_exp_f32 v60, v60
    v_cvt_pk_bf16_f32 v47, v58, v59
    v_exp_f32 v61, v61
    v_exp_f32 v62, v62
    v_mfma_f32_32x32x8_bf16 v[68:83], v[28:29], v[20:21], v[68:83]
    ds_read_b64 v[28:29], v7 offset:10240
    s_cmp_ge_u32 s28, 2
    s_cbranch_scc1 L_ool_31
L_back_32:
    v_cvt_pk_bf16_f32 v48, v60, v61
    v_exp_f32 v63, v63
    v_exp_f32 v64, v64
    v_cvt_pk_bf16_f32 v49, v62, v63
    v_exp_f32 v65, v65
    v_exp_f32 v66, v66
    v_mfma_f32_32x32x16_bf16 v[84:99], v[32:35], v[44:47], v[84:99]
    ds_read_b64_tr_b16 v[32:33], v8 offset:7680
    ds_read_b64_tr_b16 v[34:35], v9 offset:7680
    v_cvt_pk_bf16_f32 v50, v64, v65
    v_exp_f32 v67, v67
    v_exp_f32 v68, v68
    v_cvt_pk_bf16_f32 v51, v66, v67
    v_exp_f32 v69, v69
    v_exp_f32 v70, v70
    v_mfma_f32_32x32x16_bf16 v[84:99], v[36:39], v[48:51], v[84:99]
    ds_read_b64_tr_b16 v[36:37], v10 offset:10240
    ds_read_b64_tr_b16 v[38:39], v11 offset:10240
    v_cvt_pk_bf16_f32 v44, v68, v69
    v_exp_f32 v71, v71
    v_exp_f32 v72, v72
    v_cvt_pk_bf16_f32 v45, v70, v71
    v_exp_f32 v73, v73
    v_exp_f32 v74, v74
    s_waitcnt lgkmcnt(2)
    v_mfma_f32_32x32x16_bf16 v[52:67], v[24:27], v[16:19], 0
    ds_read_b128 v[24:27], v6 offset:12800
    s_setprio 1
    v_cvt_pk_bf16_f32 v46, v72, v73
    v_exp_f32 v75, v75
    v_exp_f32 v76, v76
    v_cvt_pk_bf16_f32 v47, v74, v75
    v_exp_f32 v77, v77
    v_exp_f32 v78, v78
    v_mfma_f32_32x32x8_bf16 v[52:67], v[28:29], v[20:21], v[52:67]
    ds_read_b64 v[28:29], v7 offset:12800
    s_cmp_eq_u32 s29, 0
    s_cbranch_scc1 L_ool_33
L_back_34:
    s_cmp_ge_u32 s28, 2
    s_cbranch_scc1 L_ool_35
L_back_36:
    v_cvt_pk_bf16_f32 v48, v76, v77
    v_exp_f32 v79, v79
    v_exp_f32 v80, v80
    v_cvt_pk_bf16_f32 v49, v78, v79
    v_exp_f32 v81, v81
    v_exp_f32 v82, v82
    v_mfma_f32_32x32x16_bf16 v[84:99], v[32:35], v[44:47], v[84:99]
    ds_read_b64_tr_b16 v[32:33], v8 offset:10240
    ds_read_b64_tr_b16 v[34:35], v9 offset:10240
    v_cvt_pk_bf16_f32 v50, v80, v81
    v_exp_f32 v83, v83
    v_exp_f32 v52, v52
    v_cvt_pk_bf16_f32 v51, v82, v83
    v_exp_f32 v53, v53
    v_exp_f32 v54, v54
    v_mfma_f32_32x32x16_bf16 v[84:99], v[40:43], v[48:51], v[84:99]
    ds_read_b64_tr_b16 v[40:41], v10 offset:12800
    ds_read_b64_tr_b16 v[42:43], v11 offset:12800
    v_cvt_pk_bf16_f32 v44, v52, v53
    v_exp_f32 v55, v55
    v_exp_f32 v56, v56
    v_cvt_pk_bf16_f32 v45, v54, v55
    v_exp_f32 v57, v57
    v_exp_f32 v58, v58
    s_waitcnt lgkmcnt(2)
    v_mfma_f32_32x32x16_bf16 v[68:83], v[24:27], v[16:19], 0
    ds_read_b128 v[24:27], v6 offset:15360
    v_cvt_pk_bf16_f32 v46, v56, v57
    v_exp_f32 v59, v59
    v_exp_f32 v60, v60
    v_cvt_pk_bf16_f32 v47, v58, v59
    v_exp_f32 v61, v61
    v_exp_f32 v62, v62
    v_mfma_f32_32x32x8_bf16 v[68:83], v[28:29], v[20:21], v[68:83]
    ds_read_b64 v[28:29], v7 offset:15360
    v_cvt_pk_bf16_f32 v48, v60, v61
    v_exp_f32 v63, v63
    v_exp_f32 v64, v64
    v_cvt_pk_bf16_f32 v49, v62, v63
    v_exp_f32 v65, v65
    v_exp_f32 v66, v66
    v_mfma_f32_32x32x16_bf16 v[84:99], v[32:35], v[44:47], v[84:99]
    ds_read_b64_tr_b16 v[32:33], v8 offset:12800
    ds_read_b64_tr_b16 v[34:35], v9 offset:12800
    v_cvt_pk_bf16_f32 v50, v64, v65
    v_exp_f32 v67, v67
    v_exp_f32 v68, v68
    v_cvt_pk_bf16_f32 v51, v66, v67
    v_exp_f32 v69, v69
    v_exp_f32 v70, v70
    v_mfma_f32_32x32x16_bf16 v[84:99], v[36:39], v[48:51], v[84:99]
    ds_read_b64_tr_b16 v[36:37], v10 offset:15360
    ds_read_b64_tr_b16 v[38:39], v11 offset:15360
    v_cvt_pk_bf16_f32 v44, v68, v69
    v_exp_f32 v71, v71
    v_exp_f32 v72, v72
    v_cvt_pk_bf16_f32 v45, v70, v71
    v_exp_f32 v73, v73
    v_exp_f32 v74, v74
    s_waitcnt lgkmcnt(2)
    v_mfma_f32_32x32x16_bf16 v[52:67], v[24:27], v[16:19], 0
    ds_read_b128 v[24:27], v6 offset:17920
    s_setprio 0
    s_add_u32 s54, s49, 3
    s_xor_b32 s54, s54, s17
    s_and_b32 s54, s54, 7
    s_mul_i32 s93, s54, 20480
    s_add_u32 s93, s93, s41
    s_cmp_eq_u32 s29, 0
    s_cbranch_scc1 L_ool_37
L_back_38:
    s_add_u32 m0, s96, 61440
    s_nop 0
    buffer_load_dwordx4 v2, s[4:7], s93 offen offset:0 lds
    v_cvt_pk_bf16_f32 v46, v72, v73
    v_exp_f32 v75, v75
    v_exp_f32 v76, v76
    v_cvt_pk_bf16_f32 v47, v74, v75
    v_exp_f32 v77, v77
    v_exp_f32 v78, v78
    v_mfma_f32_32x32x8_bf16 v[52:67], v[28:29], v[20:21], v[52:67]
    ds_read_b64 v[28:29], v7 offset:17920
    v_cvt_pk_bf16_f32 v48, v76, v77
    v_exp_f32 v79, v79
    v_exp_f32 v80, v80
    v_cvt_pk_bf16_f32 v49, v78, v79
    v_exp_f32 v81, v81
    v_exp_f32 v82, v82
    v_mfma_f32_32x32x16_bf16 v[84:99], v[32:35], v[44:47], v[84:99]
    ds_read_b64_tr_b16 v[32:33], v8 offset:15360
    ds_read_b64_tr_b16 v[34:35], v9 offset:15360
    v_cvt_pk_bf16_f32 v50, v80, v81
    v_exp_f32 v83, v83
    v_exp_f32 v52, v52
    v_cvt_pk_bf16_f32 v51, v82, v83
    v_exp_f32 v53, v53
    v_exp_f32 v54, v54
    v_mfma_f32_32x32x16_bf16 v[84:99], v[40:43], v[48:51], v[84:99]
    ds_read_b64_tr_b16 v[40:41], v10 offset:17920
    ds_read_b64_tr_b16 v[42:43], v11 offset:17920
    v_cvt_pk_bf16_f32 v44, v52, v53
    v_exp_f32 v55, v55
    v_exp_f32 v56, v56
    v_cvt_pk_bf16_f32 v45, v54, v55
    v_exp_f32 v57, v57
    v_exp_f32 v58, v58
    s_waitcnt lgkmcnt(2)
    v_mfma_f32_32x32x16_bf16 v[68:83], v[24:27], v[16:19], 0
    s_mov_b32 s43, 40960
    v_add_u32 v6, s43, v100
    v_mad_u32_u24 v7, s43, v106, v101
    s_waitcnt vmcnt(1)
    s_barrier
    ds_read_b128 v[24:27], v6 offset:0
    s_setprio 3
    buffer_load_dwordx4 v2, s[4:7], s93 offen offset:1024 lds
    v_cvt_pk_bf16_f32 v46, v56, v57
    v_exp_f32 v59, v59
    v_exp_f32 v60, v60
    v_cvt_pk_bf16_f32 v47, v58, v59
    v_exp_f32 v61, v61
    v_exp_f32 v62, v62
    v_mfma_f32_32x32x8_bf16 v[68:83], v[28:29], v[20:21], v[68:83]
    ds_read_b64 v[28:29], v7 offset:0
    s_cmp_ge_u32 s28, 1
    s_cbranch_scc1 L_ool_41
L_back_42:
    v_cvt_pk_bf16_f32 v48, v60, v61
    v_exp_f32 v63, v63
    v_exp_f32 v64, v64
    v_cvt_pk_bf16_f32 v49, v62, v63
    v_exp_f32 v65, v65
    v_exp_f32 v66, v66
    v_mfma_f32_32x32x16_bf16 v[84:99], v[32:35], v[44:47], v[84:99]
    ds_read_b64_tr_b16 v[32:33], v8 offset:17920
    ds_read_b64_tr_b16 v[34:35], v9 offset:17920
    v_cvt_pk_bf16_f32 v50, v64, v65
    v_exp_f32 v67, v67
    v_mad_u32_u24 v10, s43, v107, v104
    v_exp_f32 v68, v68
    v_cvt_pk_bf16_f32 v51, v66, v67
    v_mad_u32_u24 v11, s43, v107, v105
    v_exp_f32 v69, v69
    v_exp_f32 v70, v70
    v_mfma_f32_32x32x16_bf16 v[84:99], v[36:39], v[48:51], v[84:99]
    ds_read_b64_tr_b16 v[36:37], v10 offset:0
    ds_read_b64_tr_b16 v[38:39], v11 offset:0
    v_mad_u32_u24 v8, s43, v107, v102
    v_mad_u32_u24 v9, s43, v107, v103
    v_cvt_pk_bf16_f32 v44, v68, v69
    v_exp_f32 v71, v71
    v_exp_f32 v72, v72
    v_cvt_pk_bf16_f32 v45, v70, v71
    v_exp_f32 v73, v73
    v_exp_f32 v74, v74
    s_waitcnt lgkmcnt(2)
    v_mfma_f32_32x32x16_bf16 v[52:67], v[24:27], v[16:19], 0
    ds_read_b128 v[24:27], v6 offset:2560
    buffer_load_dwordx4 v2, s[4:7], s93 offen offset:2048 lds
    v_cvt_pk_bf16_f32 v46, v72, v73
    v_exp_f32 v75, v75
    v_exp_f32 v76, v76
    v_cvt_pk_bf16_f32 v47, v74, v75
    v_exp_f32 v77, v77
    v_exp_f32 v78, v78
    v_mfma_f32_32x32x8_bf16 v[52:67], v[28:29], v[20:21], v[52:67]
    ds_read_b64 v[28:29], v7 offset:2560
    s_cmp_ge_u32 s28, 1
    s_cbranch_scc1 L_ool_45
L_back_46:
    v_cvt_pk_bf16_f32 v48, v76, v77
    v_exp_f32 v79, v79
    v_exp_f32 v80, v80
    v_cvt_pk_bf16_f32 v49, v78, v79
    v_exp_f32 v81, v81
    v_exp_f32 v82, v82
    v_mfma_f32_32x32x16_bf16 v[84:99], v[32:35], v[44:47], v[84:99]
    ds_read_b64_tr_b16 v[32:33], v8 offset:0
    ds_read_b64_tr_b16 v[34:35], v9 offset:0
    v_cvt_pk_bf16_f32 v50, v80, v81
    v_exp_f32 v83, v83
    v_exp_f32 v52, v52
    v_cvt_pk_bf16_f32 v51, v82, v83
    v_exp_f32 v53, v53
    v_exp_f32 v54, v54
    v_mfma_f32_32x32x16_bf16 v[84:99], v[40:43], v[48:51], v[84:99]
    ds_read_b64_tr_b16 v[40:41], v10 offset:2560
    ds_read_b64_tr_b16 v[42:43], v11 offset:2560
    v_cvt_pk_bf16_f32 v44, v52, v53
    v_exp_f32 v55, v55
    v_exp_f32 v56, v56
    v_cvt_pk_bf16_f32 v45, v54, v55
    v_exp_f32 v57, v57
    v_exp_f32 v58, v58
    s_waitcnt lgkmcnt(2)
    v_mfma_f32_32x32x16_bf16 v[68:83], v[24:27], v[16:19], 0
    ds_read_b128 v[24:27], v6 offset:5120
    buffer_load_dwordx4 v2, s[4:7], s93 offen offset:3072 lds
    v_cvt_pk_bf16_f32 v46, v56, v57
    v_exp_f32 v59, v59
    v_exp_f32 v60, v60
    v_cvt_pk_bf16_f32 v47, v58, v59
    v_exp_f32 v61, v61
    v_exp_f32 v62, v62
    v_mfma_f32_32x32x8_bf16 v[68:83], v[28:29], v[20:21], v[68:83]
    ds_read_b64 v[28:29], v7 offset:5120
    s_cmp_ge_u32 s28, 1
    s_cbranch_scc1 L_ool_48
L_back_49:
    v_cvt_pk_bf16_f32 v48, v60, v61
    v_exp_f32 v63, v63
    v_exp_f32 v64, v64
    v_cvt_pk_bf16_f32 v49, v62, v63
    v_exp_f32 v65, v65
    v_exp_f32 v66, v66
    v_mfma_f32_32x32x16_bf16 v[84:99], v[32:35], v[44:47], v[84:99]
    ds_read_b64_tr_b16 v[32:33], v8 offset:2560
    ds_read_b64_tr_b16 v[34:35], v9 offset:2560
    v_cvt_pk_bf16_f32 v50, v64, v65
    v_exp_f32 v67, v67
    v_exp_f32 v68, v68
    v_cvt_pk_bf16_f32 v51, v66, v67
    v_exp_f32 v69, v69
    v_exp_f32 v70, v70
    v_mfma_f32_32x32x16_bf16 v[84:99], v[36:39], v[48:51], v[84:99]
    ds_read_b64_tr_b16 v[36:37], v10 offset:5120
    ds_read_b64_tr_b16 v[38:39], v11 offset:5120
    v_cvt_pk_bf16_f32 v44, v68, v69
    v_exp_f32 v71, v71
    v_exp_f32 v72, v72
    v_cvt_pk_bf16_f32 v45, v70, v71
    v_exp_f32 v73, v73
    v_exp_f32 v74, v74
    s_waitcnt lgkmcnt(2)
    v_mfma_f32_32x32x16_bf16 v[52:67], v[24:27], v[16:19], 0
    ds_read_b128 v[24:27], v6 offset:7680
    s_setprio 2
    s_add_u32 m0, m0, 4096
    s_nop 0
    buffer_load_dwordx4 v110, s[4:7], s93 offen lds
    v_cvt_pk_bf16_f32 v46, v72, v73
    v_exp_f32 v75, v75
    v_exp_f32 v76, v76
    v_cvt_pk_bf16_f32 v47, v74, v75
    v_exp_f32 v77, v77
    v_exp_f32 v78, v78
    v_mfma_f32_32x32x8_bf16 v[52:67], v[28:29], v[20:21], v[52:67]
    ds_read_b64 v[28:29], v7 offset:7680
    s_cmp_ge_u32 s28, 2
    s_cbranch_scc1 L_ool_51
L_back_52:
    v_cvt_pk_bf16_f32 v48, v76, v77
    v_exp_f32 v79, v79
    v_exp_f32 v80, v80
    v_cvt_pk_bf16_f32 v49, v78, v79
    v_exp_f32 v81, v81
    v_exp_f32 v82, v82
    v_mfma_f32_32x32x16_bf16 v[84:99], v[32:35], v[44:47], v[84:99]
    ds_read_b64_tr_b16 v[32:33], v8 offset:5120
    ds_read_b64_tr_b16 v[34:35], v9 offset:5120
    v_cvt_pk_bf16_f32 v50, v80, v81
    v_exp_f32 v83, v83
    v_exp_f32 v52, v52
    v_cvt_pk_bf16_f32 v51, v82, v83
    v_exp_f32 v53, v53
    v_exp_f32 v54, v54
    v_mfma_f32_32x32x16_bf16 v[84:99], v[40:43], v[48:51], v[84:99]
    ds_read_b64_tr_b16 v[40:41], v10 offset:7680
    ds_read_b64_tr_b16 v[42:43], v11 offset:7680
    v_cvt_pk_bf16_f32 v44, v52, v53
    v_exp_f32 v55, v55
    v_exp_f32 v56, v56
    v_cvt_pk_bf16_f32 v45, v54, v55
    v_exp_f32 v57, v57
    v_exp_f32 v58, v58
    s_waitcnt lgkmcnt(2)
    v_mfma_f32_32x32x16_bf16 v[68:83], v[24:27], v[16:19], 0
    ds_read_b128 v[24:27], v6 offset:10240
    v_cvt_pk_bf16_f32 v46, v56, v57
    v_exp_f32 v59, v59
    v_exp_f32 v60, v60
    v_cvt_pk_bf16_f32 v47, v58, v59
    v_exp_f32 v61, v61
    v_exp_f32 v62, v62
    v_mfma_f32_32x32x8_bf16 v[68:83], v[28:29], v[20:21], v[68:83]
    ds_read_b64 v[28:29], v7 offset:10240
    s_cmp_ge_u32 s28, 2
    s_cbranch_scc1 L_ool_53
L_back_54:
    v_cvt_pk_bf16_f32 v48, v60, v61
    v_exp_f32 v63, v63
    v_exp_f32 v64, v64
    v_cvt_pk_bf16_f32 v49, v62, v63
    v_exp_f32 v65, v65
    v_exp_f32 v66, v66
    v_mfma_f32_32x32x16_bf16 v[84:99], v[32:35], v[44:47], v[84:99]
    ds_read_b64_tr_b16 v[32:33], v8 offset:7680
    ds_read_b64_tr_b16 v[34:35], v9 offset:7680
    v_cvt_pk_bf16_f32 v50, v64, v65
    v_exp_f32 v67, v67
    v_exp_f32 v68, v68
    v_cvt_pk_bf16_f32 v51, v66, v67
    v_exp_f32 v69, v69
    v_exp_f32 v70, v70
    v_mfma_f32_32x32x16_bf16 v[84:99], v[36:39], v[48:51], v[84:99]
    ds_read_b64_tr_b16 v[36:37], v10 offset:10240
    ds_read_b64_tr_b16 v[38:39], v11 offset:10240
    v_cvt_pk_bf16_f32 v44, v68, v69
    v_exp_f32 v71, v71
    v_exp_f32 v72, v72
    v_cvt_pk_bf16_f32 v45, v70, v71
    v_exp_f32 v73, v73
    v_exp_f32 v74, v74
    s_waitcnt lgkmcnt(2)
    v_mfma_f32_32x32x16_bf16 v[52:67], v[24:27], v[16:19], 0
    ds_read_b128 v[24:27], v6 offset:12800
    s_setprio 1
    v_cvt_pk_bf16_f32 v46, v72, v73
    v_exp_f32 v75, v75
    v_exp_f32 v76, v76
    v_cvt_pk_bf16_f32 v47, v74, v75
    v_exp_f32 v77, v77
    v_exp_f32 v78, v78
    v_mfma_f32_32x32x8_bf16 v[52:67], v[28:29], v[20:21], v[52:67]
    ds_read_b64 v[28:29], v7 offset:12800
    s_cmp_ge_u32 s28, 2
    s_cbranch_scc1 L_ool_55
L_back_56:
    v_cvt_pk_bf16_f32 v48, v76, v77
    v_exp_f32 v79, v79
    v_exp_f32 v80, v80
    v_cvt_pk_bf16_f32 v49, v78, v79
    v_exp_f32 v81, v81
    v_exp_f32 v82, v82
    v_mfma_f32_32x32x16_bf16 v[84:99], v[32:35], v[44:47], v[84:99]
    ds_read_b64_tr_b16 v[32:33], v8 offset:10240
    ds_read_b64_tr_b16 v[34:35], v9 offset:10240
    v_cvt_pk_bf16_f32 v50, v80, v81
    v_exp_f32 v83, v83
    v_exp_f32 v52, v52
    v_cvt_pk_bf16_f32 v51, v82, v83
    v_exp_f32 v53, v53
    v_exp_f32 v54, v54
    v_mfma_f32_32x32x16_bf16 v[84:99], v[40:43], v[48:51], v[84:99]
    ds_read_b64_tr_b16 v[40:41], v10 offset:12800
    ds_read_b64_tr_b16 v[42:43], v11 offset:12800
    v_cvt_pk_bf16_f32 v44, v52, v53
    v_exp_f32 v55, v55
    v_exp_f32 v56, v56
    v_cvt_pk_bf16_f32 v45, v54, v55
    v_exp_f32 v57, v57
    v_exp_f32 v58, v58
    s_waitcnt lgkmcnt(2)
    v_mfma_f32_32x32x16_bf16 v[68:83], v[24:27], v[16:19], 0
    ds_read_b128 v[24:27], v6 offset:15360
    v_cvt_pk_bf16_f32 v46, v56, v57
    v_exp_f32 v59, v59
    v_exp_f32 v60, v60
    v_cvt_pk_bf16_f32 v47, v58, v59
    v_exp_f32 v61, v61
    v_exp_f32 v62, v62
    v_mfma_f32_32x32x8_bf16 v[68:83], v[28:29], v[20:21], v[68:83]
    ds_read_b64 v[28:29], v7 offset:15360
    s_cmp_eq_u32 s29, 0
    s_cbranch_scc1 L_ool_57
L_back_58:
    s_cmp_ge_u32 s28, 2
    s_cbranch_scc1 L_ool_59
L_back_60:
    v_cvt_pk_bf16_f32 v48, v60, v61
    v_exp_f32 v63, v63
    v_exp_f32 v64, v64
    v_cvt_pk_bf16_f32 v49, v62, v63
    v_exp_f32 v65, v65
    v_exp_f32 v66, v66
    v_mfma_f32_32x32x16_bf16 v[84:99], v[32:35], v[44:47], v[84:99]
    ds_read_b64_tr_b16 v[32:33], v8 offset:12800
    ds_read_b64_tr_b16 v[34:35], v9 offset:12800
    v_cvt_pk_bf16_f32 v50, v64, v65
    v_exp_f32 v67, v67
    v_exp_f32 v68, v68
    v_cvt_pk_bf16_f32 v51, v66, v67
    v_exp_f32 v69, v69
    v_exp_f32 v70, v70
    v_mfma_f32_32x32x16_bf16 v[84:99], v[36:39], v[48:51], v[84:99]
    ds_read_b64_tr_b16 v[36:37], v10 offset:15360
    ds_read_b64_tr_b16 v[38:39], v11 offset:15360
    v_cvt_pk_bf16_f32 v44, v68, v69
    v_exp_f32 v71, v71
    v_exp_f32 v72, v72
    v_cvt_pk_bf16_f32 v45, v70, v71
    v_exp_f32 v73, v73
    v_exp_f32 v74, v74
    s_waitcnt lgkmcnt(2)
    v_mfma_f32_32x32x16_bf16 v[52:67], v[24:27], v[16:19], 0
    ds_read_b128 v[24:27], v6 offset:17920
    s_setprio 0
    v_cvt_pk_bf16_f32 v46, v72, v73
    v_exp_f32 v75, v75
    v_exp_f32 v76, v76
    v_cvt_pk_bf16_f32 v47, v74, v75
    v_exp_f32 v77, v77
    v_exp_f32 v78, v78
    v_mfma_f32_32x32x8_bf16 v[52:67], v[28:29], v[20:21], v[52:67]
    ds_read_b64 v[28:29], v7 offset:17920
    v_cvt_pk_bf16_f32 v48, v76, v77
    v_exp_f32 v79, v79
    v_exp_f32 v80, v80
    v_cvt_pk_bf16_f32 v49, v78, v79
    v_exp_f32 v81, v81
    v_exp_f32 v82, v82
    v_mfma_f32_32x32x16_bf16 v[84:99], v[32:35], v[44:47], v[84:99]
    ds_read_b64_tr_b16 v[32:33], v8 offset:15360
    ds_read_b64_tr_b16 v[34:35], v9 offset:15360
    v_cvt_pk_bf16_f32 v50, v80, v81
    v_exp_f32 v83, v83
    v_exp_f32 v52, v52
    v_cvt_pk_bf16_f32 v51, v82, v83
    v_exp_f32 v53, v53
    v_exp_f32 v54, v54
    v_mfma_f32_32x32x16_bf16 v[84:99], v[40:43], v[48:51], v[84:99]
    ds_read_b64_tr_b16 v[40:41], v10 offset:17920
    ds_read_b64_tr_b16 v[42:43], v11 offset:17920
    v_cvt_pk_bf16_f32 v44, v52, v53
    v_exp_f32 v55, v55
    v_exp_f32 v56, v56
    v_cvt_pk_bf16_f32 v45, v54, v55
    v_exp_f32 v57, v57
    v_exp_f32 v58, v58
    s_waitcnt lgkmcnt(2)
    v_mfma_f32_32x32x16_bf16 v[68:83], v[24:27], v[16:19], 0
    s_mov_b32 s43, 61440
    v_add_u32 v6, s43, v100
    v_mad_u32_u24 v7, s43, v106, v101
    s_waitcnt vmcnt(0)
    s_barrier
    ds_read_b128 v[24:27], v6 offset:0
    s_setprio 3
    v_cvt_pk_bf16_f32 v46, v56, v57
    v_exp_f32 v59, v59
    v_exp_f32 v60, v60
    v_cvt_pk_bf16_f32 v47, v58, v59
    v_exp_f32 v61, v61
    v_exp_f32 v62, v62
    v_mfma_f32_32x32x8_bf16 v[68:83], v[28:29], v[20:21], v[68:83]
    ds_read_b64 v[28:29], v7 offset:0
    s_or_b32 s50, s16, s25
    s_cbranch_scc0 L_ool_61
L_back_62:
    s_add_u32 s54, s49, 5
    s_xor_b32 s54, s54, s17
    s_and_b32 s54, s54, 7
    s_mul_i32 s93, s54, 20480
    s_add_u32 s93, s93, s41
    s_cmp_eq_u32 s29, 0
    s_cbranch_scc1 L_ool_63
L_back_64:
    s_add_u32 m0, s96, 102400
    s_nop 0
    buffer_load_dwordx4 v2, s[4:7], s93 offen offset:0 lds
    v_cvt_pk_bf16_f32 v48, v60, v61
    v_exp_f32 v63, v63
    v_exp_f32 v64, v64
    v_cvt_pk_bf16_f32 v49, v62, v63
    v_exp_f32 v65, v65
    v_exp_f32 v66, v66
    v_mfma_f32_32x32x16_bf16 v[84:99], v[32:35], v[44:47], v[84:99]
    ds_read_b64_tr_b16 v[32:33], v8 offset:17920
    ds_read_b64_tr_b16 v[34:35], v9 offset:17920
    v_cvt_pk_bf16_f32 v50, v64, v65
    v_exp_f32 v67, v67
    v_mad_u32_u24 v10, s43, v107, v104
    v_exp_f32 v68, v68
    v_cvt_pk_bf16_f32 v51, v66, v67
    v_mad_u32_u24 v11, s43, v107, v105
    v_exp_f32 v69, v69
    v_exp_f32 v70, v70
    v_mfma_f32_32x32x16_bf16 v[84:99], v[36:39], v[48:51], v[84:99]
    ds_read_b64_tr_b16 v[36:37], v10 offset:0
    ds_read_b64_tr_b16 v[38:39], v11 offset:0
    v_mad_u32_u24 v8, s43, v107, v102
    v_mad_u32_u24 v9, s43, v107, v103
    v_cvt_pk_bf16_f32 v44, v68, v69
    v_exp_f32 v71, v71
    v_exp_f32 v72, v72
    v_cvt_pk_bf16_f32 v45, v70, v71
    v_exp_f32 v73, v73
    v_exp_f32 v74, v74
    s_waitcnt lgkmcnt(2)
    v_mfma_f32_32x32x16_bf16 v[52:67], v[24:27], v[16:19], 0
    ds_read_b128 v[24:27], v6 offset:2560
    v_cvt_pk_bf16_f32 v46, v72, v73
    v_exp_f32 v75, v75
    v_exp_f32 v76, v76
    v_cvt_pk_bf16_f32 v47, v74, v75
    v_exp_f32 v77, v77
    v_exp_f32 v78, v78
    v_mfma_f32_32x32x8_bf16 v[52:67], v[28:29], v[20:21], v[52:67]
    ds_read_b64 v[28:29], v7 offset:2560
    buffer_load_dwordx4 v2, s[4:7], s93 offen offset:1024 lds
    v_cvt_pk_bf16_f32 v48, v76, v77
    v_exp_f32 v79, v79
    v_exp_f32 v80, v80
    v_cvt_pk_bf16_f32 v49, v78, v79
    v_exp_f32 v81, v81
    v_exp_f32 v82, v82
    v_mfma_f32_32x32x16_bf16 v[84:99], v[32:35], v[44:47], v[84:99]
    ds_read_b64_tr_b16 v[32:33], v8 offset:0
    ds_read_b64_tr_b16 v[34:35], v9 offset:0
    v_cvt_pk_bf16_f32 v50, v80, v81
    v_exp_f32 v83, v83
    v_exp_f32 v52, v52
    v_cvt_pk_bf16_f32 v51, v82, v83
    v_exp_f32 v53, v53
    v_exp_f32 v54, v54
    v_mfma_f32_32x32x16_bf16 v[84:99], v[40:43], v[48:51], v[84:99]
    ds_read_b64_tr_b16 v[40:41], v10 offset:2560
    ds_read_b64_tr_b16 v[42:43], v11 offset:2560
    v_cvt_pk_bf16_f32 v44, v52, v53
    v_exp_f32 v55, v55
    v_exp_f32 v56, v56
    v_cvt_pk_bf16_f32 v45, v54, v55
    v_exp_f32 v57, v57
    v_exp_f32 v58, v58
    s_waitcnt lgkmcnt(2)
    v_mfma_f32_32x32x16_bf16 v[68:83], v[24:27], v[16:19], 0
    ds_read_b128 v[24:27], v6 offset:5120
    v_cvt_pk_bf16_f32 v46, v56, v57
    v_exp_f32 v59, v59
    v_exp_f32 v60, v60
    v_cvt_pk_bf16_f32 v47, v58, v59
    v_exp_f32 v61, v61
    v_exp_f32 v62, v62
    v_mfma_f32_32x32x8_bf16 v[68:83], v[28:29], v[20:21], v[68:83]
    ds_read_b64 v[28:29], v7 offset:5120
    buffer_load_dwordx4 v2, s[4:7], s93 offen offset:2048 lds
    v_cvt_pk_bf16_f32 v48, v60, v61
    v_exp_f32 v63, v63
    v_exp_f32 v64, v64
    v_cvt_pk_bf16_f32 v49, v62, v63
    v_exp_f32 v65, v65
    v_exp_f32 v66, v66
    v_mfma_f32_32x32x16_bf16 v[84:99], v[32:35], v[44:47], v[84:99]
    ds_read_b64_tr_b16 v[32:33], v8 offset:2560
    ds_read_b64_tr_b16 v[34:35], v9 offset:2560
    v_cvt_pk_bf16_f32 v50, v64, v65
    v_exp_f32 v67, v67
    v_exp_f32 v68, v68
    v_cvt_pk_bf16_f32 v51, v66, v67
    v_exp_f32 v69, v69
    v_exp_f32 v70, v70
    v_mfma_f32_32x32x16_bf16 v[84:99], v[36:39], v[48:51], v[84:99]
    ds_read_b64_tr_b16 v[36:37], v10 offset:5120
    ds_read_b64_tr_b16 v[38:39], v11 offset:5120
    v_cvt_pk_bf16_f32 v44, v68, v69
    v_exp_f32 v71, v71
    v_exp_f32 v72, v72
    v_cvt_pk_bf16_f32 v45, v70, v71
    v_exp_f32 v73, v73
    v_exp_f32 v74, v74
    s_waitcnt lgkmcnt(2)
    v_mfma_f32_32x32x16_bf16 v[52:67], v[24:27], v[16:19], 0
    ds_read_b128 v[24:27], v6 offset:7680
    v_cvt_pk_bf16_f32 v46, v72, v73
    v_exp_f32 v75, v75
    v_exp_f32 v76, v76
    v_cvt_pk_bf16_f32 v47, v74, v75
    v_exp_f32 v77, v77
    v_exp_f32 v78, v78
    v_mfma_f32_32x32x8_bf16 v[52:67], v[28:29], v[20:21], v[52:67]
    ds_read_b64 v[28:29], v7 offset:7680
    buffer_load_dwordx4 v2, s[4:7], s93 offen offset:3072 lds
    v_cvt_pk_bf16_f32 v48, v76, v77
    v_exp_f32 v79, v79
    v_exp_f32 v80, v80
    v_cvt_pk_bf16_f32 v49, v78, v79
    v_exp_f32 v81, v81
    v_exp_f32 v82, v82
    v_mfma_f32_32x32x16_bf16 v[84:99], v[32:35], v[44:47], v[84:99]
    ds_read_b64_tr_b16 v[32:33], v8 offset:5120
    ds_read_b64_tr_b16 v[34:35], v9 offset:5120
    v_cvt_pk_bf16_f32 v50, v80, v81
    v_exp_f32 v83, v83
    v_exp_f32 v52, v52
    v_cvt_pk_bf16_f32 v51, v82, v83
    v_exp_f32 v53, v53
    v_exp_f32 v54, v54
    v_mfma_f32_32x32x16_bf16 v[84:99], v[40:43], v[48:51], v[84:99]
    ds_read_b64_tr_b16 v[40:41], v10 offset:7680
    ds_read_b64_tr_b16 v[42:43], v11 offset:7680
    v_cvt_pk_bf16_f32 v44, v52, v53
    v_exp_f32 v55, v55
    v_exp_f32 v56, v56
    v_cvt_pk_bf16_f32 v45, v54, v55
    v_exp_f32 v57, v57
    v_exp_f32 v58, v58
    s_waitcnt lgkmcnt(2)
    v_mfma_f32_32x32x16_bf16 v[68:83], v[24:27], v[16:19], 0
    ds_read_b128 v[24:27], v6 offset:10240
    v_cvt_pk_bf16_f32 v46, v56, v57
    v_exp_f32 v59, v59
    v_exp_f32 v60, v60
    v_cvt_pk_bf16_f32 v47, v58, v59
    v_exp_f32 v61, v61
    v_exp_f32 v62, v62
    v_mfma_f32_32x32x8_bf16 v[68:83], v[28:29], v[20:21], v[68:83]
    ds_read_b64 v[28:29], v7 offset:10240
    s_add_u32 m0, m0, 4096
    s_nop 0
    buffer_load_dwordx4 v110, s[4:7], s93 offen lds
    v_cvt_pk_bf16_f32 v48, v60, v61
    v_exp_f32 v63, v63
    v_exp_f32 v64, v64
    v_cvt_pk_bf16_f32 v49, v62, v63
    v_exp_f32 v65, v65
    v_exp_f32 v66, v66
    v_mfma_f32_32x32x16_bf16 v[84:99], v[32:35], v[44:47], v[84:99]
    ds_read_b64_tr_b16 v[32:33], v8 offset:7680
    ds_read_b64_tr_b16 v[34:35], v9 offset:7680
    v_cvt_pk_bf16_f32 v50, v64, v65
    v_exp_f32 v67, v67
    v_exp_f32 v68, v68
    v_cvt_pk_bf16_f32 v51, v66, v67
    v_exp_f32 v69, v69
    v_exp_f32 v70, v70
    v_mfma_f32_32x32x16_bf16 v[84:99], v[36:39], v[48:51], v[84:99]
    ds_read_b64_tr_b16 v[36:37], v10 offset:10240
    ds_read_b64_tr_b16 v[38:39], v11 offset:10240
    v_cvt_pk_bf16_f32 v44, v68, v69
    v_exp_f32 v71, v71
    v_exp_f32 v72, v72
    v_cvt_pk_bf16_f32 v45, v70, v71
    v_exp_f32 v73, v73
    v_exp_f32 v74, v74
    s_waitcnt lgkmcnt(2)
    v_mfma_f32_32x32x16_bf16 v[52:67], v[24:27], v[16:19], 0
    ds_read_b128 v[24:27], v6 offset:12800
    v_cvt_pk_bf16_f32 v46, v72, v73
    v_exp_f32 v75, v75
    v_exp_f32 v76, v76
    v_cvt_pk_bf16_f32 v47, v74, v75
    v_exp_f32 v77, v77
    v_exp_f32 v78, v78
    v_mfma_f32_32x32x8_bf16 v[52:67], v[28:29], v[20:21], v[52:67]
    ds_read_b64 v[28:29], v7 offset:12800
    v_cvt_pk_bf16_f32 v48, v76, v77
    v_exp_f32 v79, v79
    v_exp_f32 v80, v80
    v_cvt_pk_bf16_f32 v49, v78, v79
    v_exp_f32 v81, v81
    v_exp_f32 v82, v82
    v_mfma_f32_32x32x16_bf16 v[84:99], v[32:35], v[44:47], v[84:99]
    ds_read_b64_tr_b16 v[32:33], v8 offset:10240
    ds_read_b64_tr_b16 v[34:35], v9 offset:10240
    v_cvt_pk_bf16_f32 v50, v80, v81
    v_exp_f32 v83, v83
    v_exp_f32 v52, v52
    v_cvt_pk_bf16_f32 v51, v82, v83
    v_exp_f32 v53, v53
    v_exp_f32 v54, v54
    v_mfma_f32_32x32x16_bf16 v[84:99], v[40:43], v[48:51], v[84:99]
    ds_read_b64_tr_b16 v[40:41], v10 offset:12800
    ds_read_b64_tr_b16 v[42:43], v11 offset:12800
    v_cvt_pk_bf16_f32 v44, v52, v53
    v_exp_f32 v55, v55
    v_exp_f32 v56, v56
    v_cvt_pk_bf16_f32 v45, v54, v55
    v_exp_f32 v57, v57
    v_exp_f32 v58, v58
    s_waitcnt lgkmcnt(2)
    v_mfma_f32_32x32x16_bf16 v[68:83], v[24:27], v[16:19], 0
    ds_read_b128 v[24:27], v6 offset:15360
    s_setprio 2
    v_cvt_pk_bf16_f32 v46, v56, v57
    v_exp_f32 v59, v59
    v_exp_f32 v60, v60
    v_cvt_pk_bf16_f32 v47, v58, v59
    v_exp_f32 v61, v61
    v_exp_f32 v62, v62
    v_mfma_f32_32x32x8_bf16 v[68:83], v[28:29], v[20:21], v[68:83]
    ds_read_b64 v[28:29], v7 offset:15360
    v_cvt_pk_bf16_f32 v48, v60, v61
    v_exp_f32 v63, v63
    v_exp_f32 v64, v64
    v_cvt_pk_bf16_f32 v49, v62, v63
    v_exp_f32 v65, v65
    v_exp_f32 v66, v66
    v_mfma_f32_32x32x16_bf16 v[84:99], v[32:35], v[44:47], v[84:99]
    ds_read_b64_tr_b16 v[32:33], v8 offset:12800
    ds_read_b64_tr_b16 v[34:35], v9 offset:12800
    v_cvt_pk_bf16_f32 v50, v64, v65
    v_exp_f32 v67, v67
    v_exp_f32 v68, v68
    v_cvt_pk_bf16_f32 v51, v66, v67
    v_exp_f32 v69, v69
    v_exp_f32 v70, v70
    v_mfma_f32_32x32x16_bf16 v[84:99], v[36:39], v[48:51], v[84:99]
    ds_read_b64_tr_b16 v[36:37], v10 offset:15360
    ds_read_b64_tr_b16 v[38:39], v11 offset:15360
    v_cvt_pk_bf16_f32 v44, v68, v69
    v_exp_f32 v71, v71
    v_exp_f32 v72, v72
    v_cvt_pk_bf16_f32 v45, v70, v71
    v_exp_f32 v73, v73
    v_exp_f32 v74, v74
    s_waitcnt lgkmcnt(2)
    v_mfma_f32_32x32x16_bf16 v[52:67], v[24:27], v[16:19], 0
    ds_read_b128 v[24:27], v6 offset:17920
    v_cvt_pk_bf16_f32 v46, v72, v73
    v_exp_f32 v75, v75
    v_exp_f32 v76, v76
    v_cvt_pk_bf16_f32 v47, v74, v75
    v_exp_f32 v77, v77
    v_exp_f32 v78, v78
    v_mfma_f32_32x32x8_bf16 v[52:67], v[28:29], v[20:21], v[52:67]
    ds_read_b64 v[28:29], v7 offset:17920
    v_cvt_pk_bf16_f32 v48, v76, v77
    v_exp_f32 v79, v79
    v_exp_f32 v80, v80
    v_cvt_pk_bf16_f32 v49, v78, v79
    v_exp_f32 v81, v81
    v_exp_f32 v82, v82
    v_mfma_f32_32x32x16_bf16 v[84:99], v[32:35], v[44:47], v[84:99]
    ds_read_b64_tr_b16 v[32:33], v8 offset:15360
    ds_read_b64_tr_b16 v[34:35], v9 offset:15360
    v_cvt_pk_bf16_f32 v50, v80, v81
    v_exp_f32 v83, v83
    v_exp_f32 v52, v52
    v_cvt_pk_bf16_f32 v51, v82, v83
    v_exp_f32 v53, v53
    v_exp_f32 v54, v54
    v_mfma_f32_32x32x16_bf16 v[84:99], v[40:43], v[48:51], v[84:99]
    ds_read_b64_tr_b16 v[40:41], v10 offset:17920
    ds_read_b64_tr_b16 v[42:43], v11 offset:17920
    v_cvt_pk_bf16_f32 v44, v52, v53
    v_exp_f32 v55, v55
    v_exp_f32 v56, v56
    v_cvt_pk_bf16_f32 v45, v54, v55
    v_exp_f32 v57, v57
    v_exp_f32 v58, v58
    s_waitcnt lgkmcnt(2)
    v_mfma_f32_32x32x16_bf16 v[68:83], v[24:27], v[16:19], 0
    s_mov_b32 s43, 81920
    v_add_u32 v6, s43, v100
    v_mad_u32_u24 v7, s43, v106, v101
    ds_read_b128 v[24:27], v6 offset:0
    v_cvt_pk_bf16_f32 v46, v56, v57
    v_exp_f32 v59, v59
    v_exp_f32 v60, v60
    v_cvt_pk_bf16_f32 v47, v58, v59
    v_exp_f32 v61, v61
    v_exp_f32 v62, v62
    v_mfma_f32_32x32x8_bf16 v[68:83], v[28:29], v[20:21], v[68:83]
    ds_read_b64 v[28:29], v7 offset:0
    v_cvt_pk_bf16_f32 v48, v60, v61
    v_exp_f32 v63, v63
    v_exp_f32 v64, v64
    v_cvt_pk_bf16_f32 v49, v62, v63
    v_exp_f32 v65, v65
    v_exp_f32 v66, v66
    v_mfma_f32_32x32x16_bf16 v[84:99], v[32:35], v[44:47], v[84:99]
    ds_read_b64_tr_b16 v[32:33], v8 offset:17920
    ds_read_b64_tr_b16 v[34:35], v9 offset:17920
    v_cvt_pk_bf16_f32 v50, v64, v65
    v_exp_f32 v67, v67
    v_mad_u32_u24 v10, s43, v107, v104
    v_exp_f32 v68, v68
    v_cvt_pk_bf16_f32 v51, v66, v67
    v_mad_u32_u24 v11, s43, v107, v105
    v_exp_f32 v69, v69
    v_exp_f32 v70, v70
    v_mfma_f32_32x32x16_bf16 v[84:99], v[36:39], v[48:51], v[84:99]
    ds_read_b64_tr_b16 v[36:37], v10 offset:0
    ds_read_b64_tr_b16 v[38:39], v11 offset:0
    v_mad_u32_u24 v8, s43, v107, v102
    v_mad_u32_u24 v9, s43, v107, v103
    v_cvt_pk_bf16_f32 v44, v68, v69
    v_exp_f32 v71, v71
    v_exp_f32 v72, v72
    v_cvt_pk_bf16_f32 v45, v70, v71
    v_exp_f32 v73, v73
    v_exp_f32 v74, v74
    s_waitcnt lgkmcnt(2)
    v_mfma_f32_32x32x16_bf16 v[52:67], v[24:27], v[16:19], 0
    ds_read_b128 v[24:27], v6 offset:2560
    v_cvt_pk_bf16_f32 v46, v72, v73
    v_exp_f32 v75, v75
    v_exp_f32 v76, v76
    v_cvt_pk_bf16_f32 v47, v74, v75
    v_exp_f32 v77, v77
    v_exp_f32 v78, v78
    v_mfma_f32_32x32x8_bf16 v[52:67], v[28:29], v[20:21], v[52:67]
    ds_read_b64 v[28:29], v7 offset:2560
    buffer_load_dwordx4 v[252:255], v2, s[4:7], 0 offen sc1
    v_cvt_pk_bf16_f32 v48, v76, v77
    v_exp_f32 v79, v79
    v_exp_f32 v80, v80
    v_cvt_pk_bf16_f32 v49, v78, v79
    v_exp_f32 v81, v81
    v_exp_f32 v82, v82
    v_mfma_f32_32x32x16_bf16 v[84:99], v[32:35], v[44:47], v[84:99]
    ds_read_b64_tr_b16 v[32:33], v8 offset:0
    ds_read_b64_tr_b16 v[34:35], v9 offset:0
    v_cvt_pk_bf16_f32 v50, v80, v81
    v_exp_f32 v83, v83
    v_exp_f32 v52, v52
    v_cvt_pk_bf16_f32 v51, v82, v83
    v_exp_f32 v53, v53
    v_exp_f32 v54, v54
    v_mfma_f32_32x32x16_bf16 v[84:99], v[40:43], v[48:51], v[84:99]
    ds_read_b64_tr_b16 v[40:41], v10 offset:2560
    ds_read_b64_tr_b16 v[42:43], v11 offset:2560
    v_cvt_pk_bf16_f32 v44, v52, v53
    v_exp_f32 v55, v55
    v_exp_f32 v56, v56
    v_cvt_pk_bf16_f32 v45, v54, v55
    v_exp_f32 v57, v57
    v_exp_f32 v58, v58
    s_waitcnt lgkmcnt(2)
    v_mfma_f32_32x32x16_bf16 v[68:83], v[24:27], v[16:19], 0
    ds_read_b128 v[24:27], v6 offset:5120
    v_cvt_pk_bf16_f32 v46, v56, v57
    v_exp_f32 v59, v59
    v_exp_f32 v60, v60
    v_cvt_pk_bf16_f32 v47, v58, v59
    v_exp_f32 v61, v61
    v_exp_f32 v62, v62
    v_mfma_f32_32x32x8_bf16 v[68:83], v[28:29], v[20:21], v[68:83]
    ds_read_b64 v[28:29], v7 offset:5120
    v_cvt_pk_bf16_f32 v48, v60, v61
    v_exp_f32 v63, v63
    v_exp_f32 v64, v64
    v_cvt_pk_bf16_f32 v49, v62, v63
    v_exp_f32 v65, v65
    v_exp_f32 v66, v66
    v_mfma_f32_32x32x16_bf16 v[84:99], v[32:35], v[44:47], v[84:99]
    ds_read_b64_tr_b16 v[32:33], v8 offset:2560
    ds_read_b64_tr_b16 v[34:35], v9 offset:2560
    v_cvt_pk_bf16_f32 v50, v64, v65
    v_exp_f32 v67, v67
    v_exp_f32 v68, v68
    v_cvt_pk_bf16_f32 v51, v66, v67
    v_exp_f32 v69, v69
    v_exp_f32 v70, v70
    v_mfma_f32_32x32x16_bf16 v[84:99], v[36:39], v[48:51], v[84:99]
    ds_read_b64_tr_b16 v[36:37], v10 offset:5120
    ds_read_b64_tr_b16 v[38:39], v11 offset:5120
    v_cvt_pk_bf16_f32 v44, v68, v69
    v_exp_f32 v71, v71
    v_exp_f32 v72, v72
    v_cvt_pk_bf16_f32 v45, v70, v71
    v_exp_f32 v73, v73
    v_exp_f32 v74, v74
    s_waitcnt lgkmcnt(2)
    v_mfma_f32_32x32x16_bf16 v[52:67], v[24:27], v[16:19], 0
    ds_read_b128 v[24:27], v6 offset:7680
    s_setprio 1
    v_cvt_pk_bf16_f32 v46, v72, v73
    v_exp_f32 v75, v75
    v_exp_f32 v76, v76
    v_cvt_pk_bf16_f32 v47, v74, v75
    v_exp_f32 v77, v77
    v_exp_f32 v78, v78
    v_mfma_f32_32x32x8_bf16 v[52:67], v[28:29], v[20:21], v[52:67]
    ds_read_b64 v[28:29], v7 offset:7680
    s_waitcnt vmcnt(0)
    v_and_b32 v252, v252, v253
    v_and_b32 v254, v254, v255
    v_and_b32 v252, v252, v254
    v_cmp_eq_u32 vcc, 0, v252
    s_cbranch_vccnz L_ool_67
L_back_68:
    v_cvt_pk_bf16_f32 v48, v76, v77
    v_exp_f32 v79, v79
    v_exp_f32 v80, v80
    v_cvt_pk_bf16_f32 v49, v78, v79
    v_exp_f32 v81, v81
    v_exp_f32 v82, v82
    v_mfma_f32_32x32x16_bf16 v[84:99], v[32:35], v[44:47], v[84:99]
    ds_read_b64_tr_b16 v[32:33], v8 offset:5120
    ds_read_b64_tr_b16 v[34:35], v9 offset:5120
    v_cvt_pk_bf16_f32 v50, v80, v81
    v_exp_f32 v83, v83
    v_exp_f32 v52, v52
    v_cvt_pk_bf16_f32 v51, v82, v83
    v_exp_f32 v53, v53
    v_exp_f32 v54, v54
    v_mfma_f32_32x32x16_bf16 v[84:99], v[40:43], v[48:51], v[84:99]
    ds_read_b64_tr_b16 v[40:41], v10 offset:7680
    ds_read_b64_tr_b16 v[42:43], v11 offset:7680
    v_cvt_pk_bf16_f32 v44, v52, v53
    v_exp_f32 v55, v55
    v_exp_f32 v56, v56
    v_cvt_pk_bf16_f32 v45, v54, v55
    v_exp_f32 v57, v57
    v_exp_f32 v58, v58
    s_waitcnt lgkmcnt(2)
    v_mfma_f32_32x32x16_bf16 v[68:83], v[24:27], v[16:19], 0
    ds_read_b128 v[24:27], v6 offset:10240
    s_add_u32 s94, s47, 143360
    s_add_u32 s50, s47, 102400
    s_cmp_lg_u32 s25, 0
    s_cselect_b32 s94, s50, s94
    s_cmp_eq_u32 s49, 0
    s_cselect_b32 s94, 0x40000000, s94
    buffer_load_dwordx4 v[112:115], v2, s[4:7], s94 offen offset:0
    v_cvt_pk_bf16_f32 v46, v56, v57
    v_exp_f32 v59, v59
    v_exp_f32 v60, v60
    v_cvt_pk_bf16_f32 v47, v58, v59
    v_exp_f32 v61, v61
    v_exp_f32 v62, v62
    v_mfma_f32_32x32x8_bf16 v[68:83], v[28:29], v[20:21], v[68:83]
    ds_read_b64 v[28:29], v7 offset:10240
    buffer_load_dwordx4 v[116:119], v2, s[4:7], s94 offen offset:1024
    v_cvt_pk_bf16_f32 v48, v60, v61
    v_exp_f32 v63, v63
    v_exp_f32 v64, v64
    v_cvt_pk_bf16_f32 v49, v62, v63
    v_exp_f32 v65, v65
    v_exp_f32 v66, v66
    v_mfma_f32_32x32x16_bf16 v[84:99], v[32:35], v[44:47], v[84:99]
    ds_read_b64_tr_b16 v[32:33], v8 offset:7680
    ds_read_b64_tr_b16 v[34:35], v9 offset:7680
    v_cvt_pk_bf16_f32 v50, v64, v65
    v_exp_f32 v67, v67
    v_exp_f32 v68, v68
    v_cvt_pk_bf16_f32 v51, v66, v67
    v_exp_f32 v69, v69
    v_exp_f32 v70, v70
    v_mfma_f32_32x32x16_bf16 v[84:99], v[36:39], v[48:51], v[84:99]
    ds_read_b64_tr_b16 v[36:37], v10 offset:10240
    ds_read_b64_tr_b16 v[38:39], v11 offset:10240
    v_cvt_pk_bf16_f32 v44, v68, v69
    v_exp_f32 v71, v71
    v_exp_f32 v72, v72
    v_cvt_pk_bf16_f32 v45, v70, v71
    v_exp_f32 v73, v73
    v_exp_f32 v74, v74
    s_waitcnt lgkmcnt(2)
    v_mfma_f32_32x32x16_bf16 v[52:67], v[24:27], v[16:19], 0
    ds_read_b128 v[24:27], v6 offset:12800
    buffer_load_dwordx4 v[120:123], v2, s[4:7], s94 offen offset:2048
    v_cvt_pk_bf16_f32 v46, v72, v73
    v_exp_f32 v75, v75
    v_exp_f32 v76, v76
    v_cvt_pk_bf16_f32 v47, v74, v75
    v_exp_f32 v77, v77
    v_exp_f32 v78, v78
    v_mfma_f32_32x32x8_bf16 v[52:67], v[28:29], v[20:21], v[52:67]
    ds_read_b64 v[28:29], v7 offset:12800
    buffer_load_dwordx4 v[124:127], v2, s[4:7], s94 offen offset:3072
    v_cvt_pk_bf16_f32 v48, v76, v77
    v_exp_f32 v79, v79
    v_exp_f32 v80, v80
    v_cvt_pk_bf16_f32 v49, v78, v79
    v_exp_f32 v81, v81
    v_exp_f32 v82, v82
    v_mfma_f32_32x32x16_bf16 v[84:99], v[32:35], v[44:47], v[84:99]
    ds_read_b64_tr_b16 v[32:33], v8 offset:10240
    ds_read_b64_tr_b16 v[34:35], v9 offset:10240
    v_cvt_pk_bf16_f32 v50, v80, v81
    v_exp_f32 v83, v83
    v_exp_f32 v52, v52
    v_cvt_pk_bf16_f32 v51, v82, v83
    v_exp_f32 v53, v53
    v_exp_f32 v54, v54
    v_mfma_f32_32x32x16_bf16 v[84:99], v[40:43], v[48:51], v[84:99]
    ds_read_b64_tr_b16 v[40:41], v10 offset:12800
    ds_read_b64_tr_b16 v[42:43], v11 offset:12800
    v_cvt_pk_bf16_f32 v44, v52, v53
    v_exp_f32 v55, v55
    v_exp_f32 v56, v56
    v_cvt_pk_bf16_f32 v45, v54, v55
    v_exp_f32 v57, v57
    v_exp_f32 v58, v58
    s_waitcnt lgkmcnt(2)
    v_mfma_f32_32x32x16_bf16 v[68:83], v[24:27], v[16:19], 0
    ds_read_b128 v[24:27], v6 offset:15360
    s_setprio 0
    buffer_load_dwordx4 v[128:131], v110, s[4:7], s94 offen
    v_cvt_pk_bf16_f32 v46, v56, v57
    v_exp_f32 v59, v59
    v_exp_f32 v60, v60
    v_cvt_pk_bf16_f32 v47, v58, v59
    v_exp_f32 v61, v61
    v_exp_f32 v62, v62
    v_mfma_f32_32x32x8_bf16 v[68:83], v[28:29], v[20:21], v[68:83]
    ds_read_b64 v[28:29], v7 offset:15360
    s_add_u32 s94, s47, 225280
    s_add_u32 s50, s47, 184320
    s_cmp_lg_u32 s25, 0
    s_cselect_b32 s94, s50, s94
    s_cmp_eq_u32 s49, 0
    s_cselect_b32 s94, 0x40000000, s94
    buffer_load_dwordx4 v[192:195], v2, s[4:7], s94 offen offset:0
    v_cvt_pk_bf16_f32 v48, v60, v61
    v_exp_f32 v63, v63
    v_exp_f32 v64, v64
    v_cvt_pk_bf16_f32 v49, v62, v63
    v_exp_f32 v65, v65
    v_exp_f32 v66, v66
    v_mfma_f32_32x32x16_bf16 v[84:99], v[32:35], v[44:47], v[84:99]
    ds_read_b64_tr_b16 v[32:33], v8 offset:12800
    ds_read_b64_tr_b16 v[34:35], v9 offset:12800
    v_cvt_pk_bf16_f32 v50, v64, v65
    v_exp_f32 v67, v67
    v_exp_f32 v68, v68
    v_cvt_pk_bf16_f32 v51, v66, v67
    v_exp_f32 v69, v69
    v_exp_f32 v70, v70
    v_mfma_f32_32x32x16_bf16 v[84:99], v[36:39], v[48:51], v[84:99]
    ds_read_b64_tr_b16 v[36:37], v10 offset:15360
    ds_read_b64_tr_b16 v[38:39], v11 offset:15360
    v_cvt_pk_bf16_f32 v44, v68, v69
    v_exp_f32 v71, v71
    v_exp_f32 v72, v72
    v_cvt_pk_bf16_f32 v45, v70, v71
    v_exp_f32 v73, v73
    v_exp_f32 v74, v74
    s_waitcnt lgkmcnt(2)
    v_mfma_f32_32x32x16_bf16 v[52:67], v[24:27], v[16:19], 0
    ds_read_b128 v[24:27], v6 offset:17920
    buffer_load_dwordx4 v[196:199], v2, s[4:7], s94 offen offset:1024
    v_cvt_pk_bf16_f32 v46, v72, v73
    v_exp_f32 v75, v75
    v_exp_f32 v76, v76
    v_cvt_pk_bf16_f32 v47, v74, v75
    v_exp_f32 v77, v77
    v_exp_f32 v78, v78
    v_mfma_f32_32x32x8_bf16 v[52:67], v[28:29], v[20:21], v[52:67]
    ds_read_b64 v[28:29], v7 offset:17920
    s_cmp_eq_u32 s29, 0
    s_cbranch_scc1 L_ool_71
L_back_72:
    buffer_load_dwordx4 v[200:203], v2, s[4:7], s94 offen offset:2048
    v_cvt_pk_bf16_f32 v48, v76, v77
    v_exp_f32 v79, v79
    v_exp_f32 v80, v80
    v_cvt_pk_bf16_f32 v49, v78, v79
    v_exp_f32 v81, v81
    v_exp_f32 v82, v82
    v_mfma_f32_32x32x16_bf16 v[84:99], v[32:35], v[44:47], v[84:99]
    ds_read_b64_tr_b16 v[32:33], v8 offset:15360
    ds_read_b64_tr_b16 v[34:35], v9 offset:15360
    v_cvt_pk_bf16_f32 v50, v80, v81
    v_exp_f32 v83, v83
    v_exp_f32 v52, v52
    v_cvt_pk_bf16_f32 v51, v82, v83
    v_exp_f32 v53, v53
    v_exp_f32 v54, v54
    v_mfma_f32_32x32x16_bf16 v[84:99], v[40:43], v[48:51], v[84:99]
    ds_read_b64_tr_b16 v[40:41], v10 offset:17920
    ds_read_b64_tr_b16 v[42:43], v11 offset:17920
    v_cvt_pk_bf16_f32 v44, v52, v53
    v_exp_f32 v55, v55
    v_exp_f32 v56, v56
    v_cvt_pk_bf16_f32 v45, v54, v55
    v_exp_f32 v57, v57
    v_exp_f32 v58, v58
    s_waitcnt lgkmcnt(2)
    v_mfma_f32_32x32x16_bf16 v[68:83], v[24:27], v[16:19], 0
    s_mov_b32 s43, 102400
    v_add_u32 v6, s43, v100
    v_mad_u32_u24 v7, s43, v106, v101
    s_barrier
    ds_read_b128 v[24:27], v6 offset:0
    s_setprio 3
    buffer_load_dwordx4 v[204:207], v2, s[4:7], s94 offen offset:3072
    v_cvt_pk_bf16_f32 v46, v56, v57
    v_exp_f32 v59, v59
    v_exp_f32 v60, v60
    v_cvt_pk_bf16_f32 v47, v58, v59
    v_exp_f32 v61, v61
    v_exp_f32 v62, v62
    v_mfma_f32_32x32x8_bf16 v[68:83], v[28:29], v[20:21], v[68:83]
    ds_read_b64 v[28:29], v7 offset:0
    buffer_load_dwordx4 v[208:211], v110, s[4:7], s94 offen
    v_cvt_pk_bf16_f32 v48, v60, v61
    v_exp_f32 v63, v63
    v_exp_f32 v64, v64
    v_cvt_pk_bf16_f32 v49, v62, v63
    v_exp_f32 v65, v65
    v_exp_f32 v66, v66
    v_mfma_f32_32x32x16_bf16 v[84:99], v[32:35], v[44:47], v[84:99]
    ds_read_b64_tr_b16 v[32:33], v8 offset:17920
    ds_read_b64_tr_b16 v[34:35], v9 offset:17920
    v_cvt_pk_bf16_f32 v50, v64, v65
    v_exp_f32 v67, v67
    v_mad_u32_u24 v10, s43, v107, v104
    v_exp_f32 v68, v68
    v_cvt_pk_bf16_f32 v51, v66, v67
    v_mad_u32_u24 v11, s43, v107, v105
    v_exp_f32 v69, v69
    v_exp_f32 v70, v70
    v_mfma_f32_32x32x16_bf16 v[84:99], v[36:39], v[48:51], v[84:99]
    ds_read_b64_tr_b16 v[36:37], v10 offset:0
    ds_read_b64_tr_b16 v[38:39], v11 offset:0
    v_mad_u32_u24 v8, s43, v107, v102
    v_mad_u32_u24 v9, s43, v107, v103
    v_cvt_pk_bf16_f32 v44, v68, v69
    v_exp_f32 v71, v71
    v_exp_f32 v72, v72
    v_cvt_pk_bf16_f32 v45, v70, v71
    v_exp_f32 v73, v73
    v_exp_f32 v74, v74
    s_waitcnt lgkmcnt(2)
    v_mfma_f32_32x32x16_bf16 v[52:67], v[24:27], v[16:19], 0
    ds_read_b128 v[24:27], v6 offset:2560
    s_add_u32 s54, s49, 7
    s_xor_b32 s54, s54, s17
    s_and_b32 s54, s54, 7
    s_mul_i32 s93, s54, 20480
    s_add_u32 s93, s93, s41
    s_cmp_eq_u32 s29, 0
    s_cbranch_scc1 L_ool_73
L_back_74:
    s_cmp_lg_u32 s49, 0
    s_cselect_b32 s93, s45, s93
    s_add_u32 m0, s96, 0
    s_nop 0
    buffer_load_dwordx4 v2, s[4:7], s93 offen offset:0 lds
    v_cvt_pk_bf16_f32 v46, v72, v73
    v_exp_f32 v75, v75
    v_exp_f32 v76, v76
    v_cvt_pk_bf16_f32 v47, v74, v75
    v_exp_f32 v77, v77
    v_exp_f32 v78, v78
    v_mfma_f32_32x32x8_bf16 v[52:67], v[28:29], v[20:21], v[52:67]
    ds_read_b64 v[28:29], v7 offset:2560
    s_or_b32 s50, s49, s25
    s_cbranch_scc0 L_ool_77
L_back_78:
    buffer_load_dwordx4 v2, s[4:7], s93 offen offset:1024 lds
    v_cvt_pk_bf16_f32 v48, v76, v77
    v_exp_f32 v79, v79
    v_exp_f32 v80, v80
    v_cvt_pk_bf16_f32 v49, v78, v79
    v_exp_f32 v81, v81
    v_exp_f32 v82, v82
    v_mfma_f32_32x32x16_bf16 v[84:99], v[32:35], v[44:47], v[84:99]
    ds_read_b64_tr_b16 v[32:33], v8 offset:0
    ds_read_b64_tr_b16 v[34:35], v9 offset:0
    v_cvt_pk_bf16_f32 v50, v80, v81
    v_exp_f32 v83, v83
    v_exp_f32 v52, v52
    v_cvt_pk_bf16_f32 v51, v82, v83
    v_exp_f32 v53, v53
    v_exp_f32 v54, v54
    v_mfma_f32_32x32x16_bf16 v[84:99], v[40:43], v[48:51], v[84:99]
    ds_read_b64_tr_b16 v[40:41], v10 offset:2560
    ds_read_b64_tr_b16 v[42:43], v11 offset:2560
    v_cvt_pk_bf16_f32 v44, v52, v53
    v_exp_f32 v55, v55
    v_exp_f32 v56, v56
    v_cvt_pk_bf16_f32 v45, v54, v55
    v_exp_f32 v57, v57
    v_exp_f32 v58, v58
    s_waitcnt lgkmcnt(2)
    v_mfma_f32_32x32x16_bf16 v[68:83], v[24:27], v[16:19], 0
    ds_read_b128 v[24:27], v6 offset:5120
    buffer_load_dwordx4 v2, s[4:7], s93 offen offset:2048 lds
    v_cvt_pk_bf16_f32 v46, v56, v57
    v_exp_f32 v59, v59
    v_exp_f32 v60, v60
    v_cvt_pk_bf16_f32 v47, v58, v59
    v_exp_f32 v61, v61
    v_exp_f32 v62, v62
    v_mfma_f32_32x32x8_bf16 v[68:83], v[28:29], v[20:21], v[68:83]
    ds_read_b64 v[28:29], v7 offset:5120
    buffer_load_dwordx4 v2, s[4:7], s93 offen offset:3072 lds
    v_cvt_pk_bf16_f32 v48, v60, v61
    v_exp_f32 v63, v63
    v_exp_f32 v64, v64
    v_cvt_pk_bf16_f32 v49, v62, v63
    v_exp_f32 v65, v65
    v_exp_f32 v66, v66
    v_mfma_f32_32x32x16_bf16 v[84:99], v[32:35], v[44:47], v[84:99]
    ds_read_b64_tr_b16 v[32:33], v8 offset:2560
    ds_read_b64_tr_b16 v[34:35], v9 offset:2560
    v_cvt_pk_bf16_f32 v50, v64, v65
    v_exp_f32 v67, v67
    v_exp_f32 v68, v68
    v_cvt_pk_bf16_f32 v51, v66, v67
    v_exp_f32 v69, v69
    v_exp_f32 v70, v70
    v_mfma_f32_32x32x16_bf16 v[84:99], v[36:39], v[48:51], v[84:99]
    ds_read_b64_tr_b16 v[36:37], v10 offset:5120
    ds_read_b64_tr_b16 v[38:39], v11 offset:5120
    v_cvt_pk_bf16_f32 v44, v68, v69
    v_exp_f32 v71, v71
    v_exp_f32 v72, v72
    v_cvt_pk_bf16_f32 v45, v70, v71
    v_exp_f32 v73, v73
    v_exp_f32 v74, v74
    s_waitcnt lgkmcnt(2)
    v_mfma_f32_32x32x16_bf16 v[52:67], v[24:27], v[16:19], 0
    ds_read_b128 v[24:27], v6 offset:7680
    s_add_u32 m0, m0, 4096
    s_nop 0
    buffer_load_dwordx4 v110, s[4:7], s93 offen lds
    v_cvt_pk_bf16_f32 v46, v72, v73
    v_exp_f32 v75, v75
    v_exp_f32 v76, v76
    v_cvt_pk_bf16_f32 v47, v74, v75
    v_exp_f32 v77, v77
    v_exp_f32 v78, v78
    v_mfma_f32_32x32x8_bf16 v[52:67], v[28:29], v[20:21], v[52:67]
    ds_read_b64 v[28:29], v7 offset:7680
    s_mul_i32 s93, s49, 20480
    s_add_u32 s93, s93, s45
    s_add_u32 s93, s93, 20480
    s_add_u32 m0, s96, 40960
    s_nop 0
    buffer_load_dwordx4 v2, s[4:7], s93 offen offset:0 lds
    v_cvt_pk_bf16_f32 v48, v76, v77
    v_exp_f32 v79, v79
    v_exp_f32 v80, v80
    v_cvt_pk_bf16_f32 v49, v78, v79
    v_exp_f32 v81, v81
    v_exp_f32 v82, v82
    v_mfma_f32_32x32x16_bf16 v[84:99], v[32:35], v[44:47], v[84:99]
    ds_read_b64_tr_b16 v[32:33], v8 offset:5120
    ds_read_b64_tr_b16 v[34:35], v9 offset:5120
    v_cvt_pk_bf16_f32 v50, v80, v81
    v_exp_f32 v83, v83
    v_exp_f32 v52, v52
    v_cvt_pk_bf16_f32 v51, v82, v83
    v_exp_f32 v53, v53
    v_exp_f32 v54, v54
    v_mfma_f32_32x32x16_bf16 v[84:99], v[40:43], v[48:51], v[84:99]
    ds_read_b64_tr_b16 v[40:41], v10 offset:7680
    ds_read_b64_tr_b16 v[42:43], v11 offset:7680
    v_cvt_pk_bf16_f32 v44, v52, v53
    v_exp_f32 v55, v55
    v_exp_f32 v56, v56
    v_cvt_pk_bf16_f32 v45, v54, v55
    v_exp_f32 v57, v57
    v_exp_f32 v58, v58
    s_waitcnt lgkmcnt(2)
    v_mfma_f32_32x32x16_bf16 v[68:83], v[24:27], v[16:19], 0
    ds_read_b128 v[24:27], v6 offset:10240
    buffer_load_dwordx4 v2, s[4:7], s93 offen offset:1024 lds
    v_cvt_pk_bf16_f32 v46, v56, v57
    v_exp_f32 v59, v59
    v_exp_f32 v60, v60
    v_cvt_pk_bf16_f32 v47, v58, v59
    v_exp_f32 v61, v61
    v_exp_f32 v62, v62
    v_mfma_f32_32x32x8_bf16 v[68:83], v[28:29], v[20:21], v[68:83]
    ds_read_b64 v[28:29], v7 offset:10240
    buffer_load_dwordx4 v2, s[4:7], s93 offen offset:2048 lds
    v_cvt_pk_bf16_f32 v48, v60, v61
    v_exp_f32 v63, v63
    v_exp_f32 v64, v64
    v_cvt_pk_bf16_f32 v49, v62, v63
    v_exp_f32 v65, v65
    v_exp_f32 v66, v66
    v_mfma_f32_32x32x16_bf16 v[84:99], v[32:35], v[44:47], v[84:99]
    ds_read_b64_tr_b16 v[32:33], v8 offset:7680
    ds_read_b64_tr_b16 v[34:35], v9 offset:7680
    v_cvt_pk_bf16_f32 v50, v64, v65
    v_exp_f32 v67, v67
    v_exp_f32 v68, v68
    v_cvt_pk_bf16_f32 v51, v66, v67
    v_exp_f32 v69, v69
    v_exp_f32 v70, v70
    v_mfma_f32_32x32x16_bf16 v[84:99], v[36:39], v[48:51], v[84:99]
    ds_read_b64_tr_b16 v[36:37], v10 offset:10240
    ds_read_b64_tr_b16 v[38:39], v11 offset:10240
    v_cvt_pk_bf16_f32 v44, v68, v69
    v_exp_f32 v71, v71
    v_exp_f32 v72, v72
    v_cvt_pk_bf16_f32 v45, v70, v71
    v_exp_f32 v73, v73
    v_exp_f32 v74, v74
    s_waitcnt lgkmcnt(2)
    v_mfma_f32_32x32x16_bf16 v[52:67], v[24:27], v[16:19], 0
    ds_read_b128 v[24:27], v6 offset:12800
    buffer_load_dwordx4 v2, s[4:7], s93 offen offset:3072 lds
    v_cvt_pk_bf16_f32 v46, v72, v73
    v_exp_f32 v75, v75
    v_exp_f32 v76, v76
    v_cvt_pk_bf16_f32 v47, v74, v75
    v_exp_f32 v77, v77
    v_exp_f32 v78, v78
    v_mfma_f32_32x32x8_bf16 v[52:67], v[28:29], v[20:21], v[52:67]
    ds_read_b64 v[28:29], v7 offset:12800
    s_add_u32 m0, m0, 4096
    s_nop 0
    buffer_load_dwordx4 v110, s[4:7], s93 offen lds
    v_cvt_pk_bf16_f32 v48, v76, v77
    v_exp_f32 v79, v79
    v_exp_f32 v80, v80
    v_cvt_pk_bf16_f32 v49, v78, v79
    v_exp_f32 v81, v81
    v_exp_f32 v82, v82
    v_mfma_f32_32x32x16_bf16 v[84:99], v[32:35], v[44:47], v[84:99]
    ds_read_b64_tr_b16 v[32:33], v8 offset:10240
    ds_read_b64_tr_b16 v[34:35], v9 offset:10240
    v_cvt_pk_bf16_f32 v50, v80, v81
    v_exp_f32 v83, v83
    v_exp_f32 v52, v52
    v_cvt_pk_bf16_f32 v51, v82, v83
    v_exp_f32 v53, v53
    v_exp_f32 v54, v54
    v_mfma_f32_32x32x16_bf16 v[84:99], v[40:43], v[48:51], v[84:99]
    ds_read_b64_tr_b16 v[40:41], v10 offset:12800
    ds_read_b64_tr_b16 v[42:43], v11 offset:12800
    v_cvt_pk_bf16_f32 v44, v52, v53
    v_exp_f32 v55, v55
    v_exp_f32 v56, v56
    v_cvt_pk_bf16_f32 v45, v54, v55
    v_exp_f32 v57, v57
    v_exp_f32 v58, v58
    s_waitcnt lgkmcnt(2)
    v_mfma_f32_32x32x16_bf16 v[68:83], v[24:27], v[16:19], 0
    ds_read_b128 v[24:27], v6 offset:15360
    s_setprio 2
    s_add_u32 s94, s47, 184320
    s_add_u32 s50, s47, 143360
    s_cmp_lg_u32 s25, 0
    s_cselect_b32 s94, s50, s94
    s_add_u32 s50, s46, 0
    s_cmp_eq_u32 s49, 0
    s_cselect_b32 s94, s50, s94
    buffer_load_dwordx4 v[152:155], v2, s[4:7], s94 offen offset:0
    v_cvt_pk_bf16_f32 v46, v56, v57
    v_exp_f32 v59, v59
    v_exp_f32 v60, v60
    v_cvt_pk_bf16_f32 v47, v58, v59
    v_exp_f32 v61, v61
    v_exp_f32 v62, v62
    v_mfma_f32_32x32x8_bf16 v[68:83], v[28:29], v[20:21], v[68:83]
    ds_read_b64 v[28:29], v7 offset:15360
    buffer_load_dwordx4 v[156:159], v2, s[4:7], s94 offen offset:1024
    v_cvt_pk_bf16_f32 v48, v60, v61
    v_exp_f32 v63, v63
    v_exp_f32 v64, v64
    v_cvt_pk_bf16_f32 v49, v62, v63
    v_exp_f32 v65, v65
    v_exp_f32 v66, v66
    v_mfma_f32_32x32x16_bf16 v[84:99], v[32:35], v[44:47], v[84:99]
    ds_read_b64_tr_b16 v[32:33], v8 offset:12800
    ds_read_b64_tr_b16 v[34:35], v9 offset:12800
    v_cvt_pk_bf16_f32 v50, v64, v65
    v_exp_f32 v67, v67
    v_exp_f32 v68, v68
    v_cvt_pk_bf16_f32 v51, v66, v67
    v_exp_f32 v69, v69
    v_exp_f32 v70, v70
    v_mfma_f32_32x32x16_bf16 v[84:99], v[36:39], v[48:51], v[84:99]
    ds_read_b64_tr_b16 v[36:37], v10 offset:15360
    ds_read_b64_tr_b16 v[38:39], v11 offset:15360
    v_cvt_pk_bf16_f32 v44, v68, v69
    v_exp_f32 v71, v71
    v_exp_f32 v72, v72
    v_cvt_pk_bf16_f32 v45, v70, v71
    v_exp_f32 v73, v73
    v_exp_f32 v74, v74
    s_waitcnt lgkmcnt(2)
    v_mfma_f32_32x32x16_bf16 v[52:67], v[24:27], v[16:19], 0
    ds_read_b128 v[24:27], v6 offset:17920
    buffer_load_dwordx4 v[160:163], v2, s[4:7], s94 offen offset:2048
    v_cvt_pk_bf16_f32 v46, v72, v73
    v_exp_f32 v75, v75
    v_exp_f32 v76, v76
    v_cvt_pk_bf16_f32 v47, v74, v75
    v_exp_f32 v77, v77
    v_exp_f32 v78, v78
    v_mfma_f32_32x32x8_bf16 v[52:67], v[28:29], v[20:21], v[52:67]
    ds_read_b64 v[28:29], v7 offset:17920
    buffer_load_dwordx4 v[164:167], v2, s[4:7], s94 offen offset:3072
    v_cvt_pk_bf16_f32 v48, v76, v77
    v_exp_f32 v79, v79
    v_exp_f32 v80, v80
    v_cvt_pk_bf16_f32 v49, v78, v79
    v_exp_f32 v81, v81
    v_exp_f32 v82, v82
    v_mfma_f32_32x32x16_bf16 v[84:99], v[32:35], v[44:47], v[84:99]
    ds_read_b64_tr_b16 v[32:33], v8 offset:15360
    ds_read_b64_tr_b16 v[34:35], v9 offset:15360
    v_cvt_pk_bf16_f32 v50, v80, v81
    v_exp_f32 v83, v83
    v_exp_f32 v52, v52
    v_cvt_pk_bf16_f32 v51, v82, v83
    v_exp_f32 v53, v53
    v_exp_f32 v54, v54
    v_mfma_f32_32x32x16_bf16 v[84:99], v[40:43], v[48:51], v[84:99]
    ds_read_b64_tr_b16 v[40:41], v10 offset:17920
    ds_read_b64_tr_b16 v[42:43], v11 offset:17920
    v_cvt_pk_bf16_f32 v44, v52, v53
    v_exp_f32 v55, v55
    v_exp_f32 v56, v56
    v_cvt_pk_bf16_f32 v45, v54, v55
    v_exp_f32 v57, v57
    v_exp_f32 v58, v58
    s_waitcnt lgkmcnt(2)
    v_mfma_f32_32x32x16_bf16 v[68:83], v[24:27], v[16:19], 0
    s_mov_b32 s43, 122880
    v_add_u32 v6, s43, v100
    v_mad_u32_u24 v7, s43, v106, v101
    ds_read_b128 v[24:27], v6 offset:0
    buffer_load_dwordx4 v[168:171], v110, s[4:7], s94 offen
    v_cvt_pk_bf16_f32 v46, v56, v57
    v_exp_f32 v59, v59
    v_exp_f32 v60, v60
    v_cvt_pk_bf16_f32 v47, v58, v59
    v_exp_f32 v61, v61
    v_exp_f32 v62, v62
    v_mfma_f32_32x32x8_bf16 v[68:83], v[28:29], v[20:21], v[68:83]
    ds_read_b64 v[28:29], v7 offset:0
    s_add_u32 s94, s47, 204800
    s_add_u32 s50, s47, 163840
    s_cmp_lg_u32 s25, 0
    s_cselect_b32 s94, s50, s94
    s_add_u32 s50, s46, 20480
    s_cmp_eq_u32 s49, 0
    s_cselect_b32 s94, s50, s94
    buffer_load_dwordx4 v[172:175], v2, s[4:7], s94 offen offset:0
    v_cvt_pk_bf16_f32 v48, v60, v61
    v_exp_f32 v63, v63
    v_exp_f32 v64, v64
    v_cvt_pk_bf16_f32 v49, v62, v63
    v_exp_f32 v65, v65
    v_exp_f32 v66, v66
    v_mfma_f32_32x32x16_bf16 v[84:99], v[32:35], v[44:47], v[84:99]
    ds_read_b64_tr_b16 v[32:33], v8 offset:17920
    ds_read_b64_tr_b16 v[34:35], v9 offset:17920
    v_cvt_pk_bf16_f32 v50, v64, v65
    v_exp_f32 v67, v67
    v_mad_u32_u24 v10, s43, v107, v104
    v_exp_f32 v68, v68
    v_cvt_pk_bf16_f32 v51, v66, v67
    v_mad_u32_u24 v11, s43, v107, v105
    v_exp_f32 v69, v69
    v_exp_f32 v70, v70
    v_mfma_f32_32x32x16_bf16 v[84:99], v[36:39], v[48:51], v[84:99]
    ds_read_b64_tr_b16 v[36:37], v10 offset:0
    ds_read_b64_tr_b16 v[38:39], v11 offset:0
    v_mad_u32_u24 v8, s43, v107, v102
    v_mad_u32_u24 v9, s43, v107, v103
    v_cvt_pk_bf16_f32 v44, v68, v69
    v_exp_f32 v71, v71
    v_exp_f32 v72, v72
    v_cvt_pk_bf16_f32 v45, v70, v71
    v_exp_f32 v73, v73
    v_exp_f32 v74, v74
    s_waitcnt lgkmcnt(2)
    v_mfma_f32_32x32x16_bf16 v[52:67], v[24:27], v[16:19], 0
    ds_read_b128 v[24:27], v6 offset:2560
    buffer_load_dwordx4 v[176:179], v2, s[4:7], s94 offen offset:1024
    v_cvt_pk_bf16_f32 v46, v72, v73
    v_exp_f32 v75, v75
    v_exp_f32 v76, v76
    v_cvt_pk_bf16_f32 v47, v74, v75
    v_exp_f32 v77, v77
    v_exp_f32 v78, v78
    v_mfma_f32_32x32x8_bf16 v[52:67], v[28:29], v[20:21], v[52:67]
    ds_read_b64 v[28:29], v7 offset:2560
    buffer_load_dwordx4 v[180:183], v2, s[4:7], s94 offen offset:2048
    v_cvt_pk_bf16_f32 v48, v76, v77
    v_exp_f32 v79, v79
    v_exp_f32 v80, v80
    v_cvt_pk_bf16_f32 v49, v78, v79
    v_exp_f32 v81, v81
    v_exp_f32 v82, v82
    v_mfma_f32_32x32x16_bf16 v[84:99], v[32:35], v[44:47], v[84:99]
    ds_read_b64_tr_b16 v[32:33], v8 offset:0
    ds_read_b64_tr_b16 v[34:35], v9 offset:0
    v_cvt_pk_bf16_f32 v50, v80, v81
    v_exp_f32 v83, v83
    v_exp_f32 v52, v52
    v_cvt_pk_bf16_f32 v51, v82, v83
    v_exp_f32 v53, v53
    v_exp_f32 v54, v54
    v_mfma_f32_32x32x16_bf16 v[84:99], v[40:43], v[48:51], v[84:99]
    ds_read_b64_tr_b16 v[40:41], v10 offset:2560
    ds_read_b64_tr_b16 v[42:43], v11 offset:2560
    v_cvt_pk_bf16_f32 v44, v52, v53
    v_exp_f32 v55, v55
    v_exp_f32 v56, v56
    v_cvt_pk_bf16_f32 v45, v54, v55
    v_exp_f32 v57, v57
    v_exp_f32 v58, v58
    s_waitcnt lgkmcnt(2)
    v_mfma_f32_32x32x16_bf16 v[68:83], v[24:27], v[16:19], 0
    ds_read_b128 v[24:27], v6 offset:5120
    buffer_load_dwordx4 v[184:187], v2, s[4:7], s94 offen offset:3072
    v_cvt_pk_bf16_f32 v46, v56, v57
    v_exp_f32 v59, v59
    v_exp_f32 v60, v60
    v_cvt_pk_bf16_f32 v47, v58, v59
    v_exp_f32 v61, v61
    v_exp_f32 v62, v62
    v_mfma_f32_32x32x8_bf16 v[68:83], v[28:29], v[20:21], v[68:83]
    ds_read_b64 v[28:29], v7 offset:5120
    buffer_load_dwordx4 v[188:191], v110, s[4:7], s94 offen
    v_cvt_pk_bf16_f32 v48, v60, v61
    v_exp_f32 v63, v63
    v_exp_f32 v64, v64
    v_cvt_pk_bf16_f32 v49, v62, v63
    v_exp_f32 v65, v65
    v_exp_f32 v66, v66
    v_mfma_f32_32x32x16_bf16 v[84:99], v[32:35], v[44:47], v[84:99]
    ds_read_b64_tr_b16 v[32:33], v8 offset:2560
    ds_read_b64_tr_b16 v[34:35], v9 offset:2560
    v_cvt_pk_bf16_f32 v50, v64, v65
    v_exp_f32 v67, v67
    v_exp_f32 v68, v68
    v_cvt_pk_bf16_f32 v51, v66, v67
    v_exp_f32 v69, v69
    v_exp_f32 v70, v70
    v_mfma_f32_32x32x16_bf16 v[84:99], v[36:39], v[48:51], v[84:99]
    ds_read_b64_tr_b16 v[36:37], v10 offset:5120
    ds_read_b64_tr_b16 v[38:39], v11 offset:5120
    v_cvt_pk_bf16_f32 v44, v68, v69
    v_exp_f32 v71, v71
    v_exp_f32 v72, v72
    v_cvt_pk_bf16_f32 v45, v70, v71
    v_exp_f32 v73, v73
    v_exp_f32 v74, v74
    s_waitcnt lgkmcnt(2)
    v_mfma_f32_32x32x16_bf16 v[52:67], v[24:27], v[16:19], 0
    ds_read_b128 v[24:27], v6 offset:7680
    s_setprio 1
    s_add_u32 s94, s48, 61440
    s_add_u32 s50, s47, 204800
    s_cmp_lg_u32 s25, 0
    s_cselect_b32 s94, s50, s94
    s_add_u32 s50, s92, 0
    s_cmp_eq_u32 s49, 0
    s_cselect_b32 s94, s50, s94
    buffer_load_dwordx4 v[212:215], v2, s[4:7], s94 offen offset:0
    v_cvt_pk_bf16_f32 v46, v72, v73
    v_exp_f32 v75, v75
    v_exp_f32 v76, v76
    v_cvt_pk_bf16_f32 v47, v74, v75
    v_exp_f32 v77, v77
    v_exp_f32 v78, v78
    v_mfma_f32_32x32x8_bf16 v[52:67], v[28:29], v[20:21], v[52:67]
    ds_read_b64 v[28:29], v7 offset:7680
    v_cvt_pk_bf16_f32 v48, v76, v77
    v_exp_f32 v79, v79
    v_exp_f32 v80, v80
    v_cvt_pk_bf16_f32 v49, v78, v79
    v_exp_f32 v81, v81
    v_exp_f32 v82, v82
    v_mfma_f32_32x32x16_bf16 v[84:99], v[32:35], v[44:47], v[84:99]
    ds_read_b64_tr_b16 v[32:33], v8 offset:5120
    ds_read_b64_tr_b16 v[34:35], v9 offset:5120
    v_cvt_pk_bf16_f32 v50, v80, v81
    v_exp_f32 v83, v83
    v_exp_f32 v52, v52
    v_cvt_pk_bf16_f32 v51, v82, v83
    v_exp_f32 v53, v53
    v_exp_f32 v54, v54
    v_mfma_f32_32x32x16_bf16 v[84:99], v[40:43], v[48:51], v[84:99]
    ds_read_b64_tr_b16 v[40:41], v10 offset:7680
    ds_read_b64_tr_b16 v[42:43], v11 offset:7680
    v_cvt_pk_bf16_f32 v44, v52, v53
    v_exp_f32 v55, v55
    v_exp_f32 v56, v56
    v_cvt_pk_bf16_f32 v45, v54, v55
    v_exp_f32 v57, v57
    v_exp_f32 v58, v58
    s_waitcnt lgkmcnt(2)
    v_mfma_f32_32x32x16_bf16 v[68:83], v[24:27], v[16:19], 0
    ds_read_b128 v[24:27], v6 offset:10240
    buffer_load_dwordx4 v[216:219], v2, s[4:7], s94 offen offset:1024
    v_cvt_pk_bf16_f32 v46, v56, v57
    v_exp_f32 v59, v59
    v_exp_f32 v60, v60
    v_cvt_pk_bf16_f32 v47, v58, v59
    v_exp_f32 v61, v61
    v_exp_f32 v62, v62
    v_mfma_f32_32x32x8_bf16 v[68:83], v[28:29], v[20:21], v[68:83]
    ds_read_b64 v[28:29], v7 offset:10240
    s_lshl_b32 s50, s17, 7
    s_add_u32 s50, s50, 1024
    buffer_load_dword v109, v109, s[4:7], s50 offen sc1
    v_cvt_pk_bf16_f32 v48, v60, v61
    v_exp_f32 v63, v63
    v_exp_f32 v64, v64
    v_cvt_pk_bf16_f32 v49, v62, v63
    v_exp_f32 v65, v65
    v_exp_f32 v66, v66
    v_mfma_f32_32x32x16_bf16 v[84:99], v[32:35], v[44:47], v[84:99]
    ds_read_b64_tr_b16 v[32:33], v8 offset:7680
    ds_read_b64_tr_b16 v[34:35], v9 offset:7680
    v_cvt_pk_bf16_f32 v50, v64, v65
    v_exp_f32 v67, v67
    v_exp_f32 v68, v68
    v_cvt_pk_bf16_f32 v51, v66, v67
    v_exp_f32 v69, v69
    v_exp_f32 v70, v70
    v_mfma_f32_32x32x16_bf16 v[84:99], v[36:39], v[48:51], v[84:99]
    ds_read_b64_tr_b16 v[36:37], v10 offset:10240
    ds_read_b64_tr_b16 v[38:39], v11 offset:10240
    v_cvt_pk_bf16_f32 v44, v68, v69
    v_exp_f32 v71, v71
    v_exp_f32 v72, v72
    v_cvt_pk_bf16_f32 v45, v70, v71
    v_exp_f32 v73, v73
    v_exp_f32 v74, v74
    s_waitcnt lgkmcnt(2)
    v_mfma_f32_32x32x16_bf16 v[52:67], v[24:27], v[16:19], 0
    ds_read_b128 v[24:27], v6 offset:12800
    buffer_load_dwordx4 v[220:223], v2, s[4:7], s94 offen offset:2048
    v_cvt_pk_bf16_f32 v46, v72, v73
    v_exp_f32 v75, v75
    v_exp_f32 v76, v76
    v_cvt_pk_bf16_f32 v47, v74, v75
    v_exp_f32 v77, v77
    v_exp_f32 v78, v78
    v_mfma_f32_32x32x8_bf16 v[52:67], v[28:29], v[20:21], v[52:67]
    ds_read_b64 v[28:29], v7 offset:12800
    v_cvt_pk_bf16_f32 v48, v76, v77
    v_exp_f32 v79, v79
    v_exp_f32 v80, v80
    v_cvt_pk_bf16_f32 v49, v78, v79
    v_exp_f32 v81, v81
    v_exp_f32 v82, v82
    v_mfma_f32_32x32x16_bf16 v[84:99], v[32:35], v[44:47], v[84:99]
    ds_read_b64_tr_b16 v[32:33], v8 offset:10240
    ds_read_b64_tr_b16 v[34:35], v9 offset:10240
    v_cvt_pk_bf16_f32 v50, v80, v81
    v_exp_f32 v83, v83
    v_exp_f32 v52, v52
    v_cvt_pk_bf16_f32 v51, v82, v83
    v_exp_f32 v53, v53
    v_exp_f32 v54, v54
    v_mfma_f32_32x32x16_bf16 v[84:99], v[40:43], v[48:51], v[84:99]
    ds_read_b64_tr_b16 v[40:41], v10 offset:12800
    ds_read_b64_tr_b16 v[42:43], v11 offset:12800
    v_cvt_pk_bf16_f32 v44, v52, v53
    v_exp_f32 v55, v55
    v_exp_f32 v56, v56
    v_cvt_pk_bf16_f32 v45, v54, v55
    v_exp_f32 v57, v57
    v_exp_f32 v58, v58
    s_waitcnt lgkmcnt(2)
    v_mfma_f32_32x32x16_bf16 v[68:83], v[24:27], v[16:19], 0
    ds_read_b128 v[24:27], v6 offset:15360
    s_setprio 0
    buffer_load_dwordx4 v[224:227], v2, s[4:7], s94 offen offset:3072
    v_cvt_pk_bf16_f32 v46, v56, v57
    v_exp_f32 v59, v59
    v_exp_f32 v60, v60
    v_cvt_pk_bf16_f32 v47, v58, v59
    v_exp_f32 v61, v61
    v_exp_f32 v62, v62
    v_mfma_f32_32x32x8_bf16 v[68:83], v[28:29], v[20:21], v[68:83]
    ds_read_b64 v[28:29], v7 offset:15360
    v_cvt_pk_bf16_f32 v48, v60, v61
    v_exp_f32 v63, v63
    v_exp_f32 v64, v64
    v_cvt_pk_bf16_f32 v49, v62, v63
    v_exp_f32 v65, v65
    v_exp_f32 v66, v66
    v_mfma_f32_32x32x16_bf16 v[84:99], v[32:35], v[44:47], v[84:99]
    ds_read_b64_tr_b16 v[32:33], v8 offset:12800
    ds_read_b64_tr_b16 v[34:35], v9 offset:12800
    v_cvt_pk_bf16_f32 v50, v64, v65
    v_exp_f32 v67, v67
    v_exp_f32 v68, v68
    v_cvt_pk_bf16_f32 v51, v66, v67
    v_exp_f32 v69, v69
    v_exp_f32 v70, v70
    v_mfma_f32_32x32x16_bf16 v[84:99], v[36:39], v[48:51], v[84:99]
    ds_read_b64_tr_b16 v[36:37], v10 offset:15360
    ds_read_b64_tr_b16 v[38:39], v11 offset:15360
    v_cvt_pk_bf16_f32 v44, v68, v69
    v_exp_f32 v71, v71
    v_exp_f32 v72, v72
    v_cvt_pk_bf16_f32 v45, v70, v71
    v_exp_f32 v73, v73
    v_exp_f32 v74, v74
    s_waitcnt lgkmcnt(2)
    v_mfma_f32_32x32x16_bf16 v[52:67], v[24:27], v[16:19], 0
    ds_read_b128 v[24:27], v6 offset:17920
    buffer_load_dwordx4 v[228:231], v110, s[4:7], s94 offen
    v_cvt_pk_bf16_f32 v46, v72, v73
    v_exp_f32 v75, v75
    v_exp_f32 v76, v76
    v_cvt_pk_bf16_f32 v47, v74, v75
    v_exp_f32 v77, v77
    v_exp_f32 v78, v78
    v_mfma_f32_32x32x8_bf16 v[52:67], v[28:29], v[20:21], v[52:67]
    ds_read_b64 v[28:29], v7 offset:17920
    v_cvt_pk_bf16_f32 v48, v76, v77
    v_exp_f32 v79, v79
    v_exp_f32 v80, v80
    v_cvt_pk_bf16_f32 v49, v78, v79
    v_exp_f32 v81, v81
    v_exp_f32 v82, v82
    v_mfma_f32_32x32x16_bf16 v[84:99], v[32:35], v[44:47], v[84:99]
    ds_read_b64_tr_b16 v[32:33], v8 offset:15360
    ds_read_b64_tr_b16 v[34:35], v9 offset:15360
    v_cvt_pk_bf16_f32 v50, v80, v81
    v_exp_f32 v83, v83
    v_exp_f32 v52, v52
    v_cvt_pk_bf16_f32 v51, v82, v83
    v_exp_f32 v53, v53
    v_exp_f32 v54, v54
    v_mfma_f32_32x32x16_bf16 v[84:99], v[40:43], v[48:51], v[84:99]
    ds_read_b64_tr_b16 v[40:41], v10 offset:17920
    ds_read_b64_tr_b16 v[42:43], v11 offset:17920
    v_cvt_pk_bf16_f32 v44, v52, v53
    v_exp_f32 v55, v55
    v_exp_f32 v56, v56
    v_cvt_pk_bf16_f32 v45, v54, v55
    v_exp_f32 v57, v57
    v_exp_f32 v58, v58
    s_waitcnt lgkmcnt(2)
    v_mfma_f32_32x32x16_bf16 v[68:83], v[24:27], v[16:19], 0
    s_mov_b32 s43, 0
    v_add_u32 v6, s43, v100
    v_mad_u32_u24 v7, s43, v106, v101
    s_waitcnt vmcnt(21)
    s_barrier
    ds_read_b128 v[24:27], v6 offset:0
    s_setprio 3
    s_mul_i32 s93, s49, 20480
    s_add_u32 s93, s93, s45
    s_add_u32 s93, s93, 61440
    s_add_u32 m0, s96, 81920
    s_nop 0
    buffer_load_dwordx4 v2, s[4:7], s93 offen offset:0 lds
    v_cvt_pk_bf16_f32 v46, v56, v57
    v_exp_f32 v59, v59
    v_exp_f32 v60, v60
    v_cvt_pk_bf16_f32 v47, v58, v59
    v_exp_f32 v61, v61
    v_exp_f32 v62, v62
    v_mfma_f32_32x32x8_bf16 v[68:83], v[28:29], v[20:21], v[68:83]
    ds_read_b64 v[28:29], v7 offset:0
    buffer_load_dwordx4 v2, s[4:7], s93 offen offset:1024 lds
    v_cvt_pk_bf16_f32 v48, v60, v61
    v_exp_f32 v63, v63
    v_exp_f32 v64, v64
    v_cvt_pk_bf16_f32 v49, v62, v63
    v_exp_f32 v65, v65
    v_exp_f32 v66, v66
    v_mfma_f32_32x32x16_bf16 v[84:99], v[32:35], v[44:47], v[84:99]
    ds_read_b64_tr_b16 v[32:33], v8 offset:17920
    ds_read_b64_tr_b16 v[34:35], v9 offset:17920
    v_cvt_pk_bf16_f32 v50, v64, v65
    v_exp_f32 v67, v67
    v_mad_u32_u24 v10, s43, v107, v104
    v_exp_f32 v68, v68
    v_cvt_pk_bf16_f32 v51, v66, v67
    v_mad_u32_u24 v11, s43, v107, v105
    v_exp_f32 v69, v69
    v_exp_f32 v70, v70
    v_mfma_f32_32x32x16_bf16 v[84:99], v[36:39], v[48:51], v[84:99]
    ds_read_b64_tr_b16 v[36:37], v10 offset:0
    ds_read_b64_tr_b16 v[38:39], v11 offset:0
    v_mad_u32_u24 v8, s43, v107, v102
    v_mad_u32_u24 v9, s43, v107, v103
    v_cvt_pk_bf16_f32 v44, v68, v69
    v_exp_f32 v71, v71
    v_exp_f32 v72, v72
    v_cvt_pk_bf16_f32 v45, v70, v71
    v_exp_f32 v73, v73
    v_exp_f32 v74, v74
    s_waitcnt lgkmcnt(2)
    v_mfma_f32_32x32x16_bf16 v[52:67], v[24:27], v[16:19], 0
    ds_read_b128 v[24:27], v6 offset:2560
    buffer_load_dwordx4 v2, s[4:7], s93 offen offset:2048 lds
    v_cvt_pk_bf16_f32 v46, v72, v73
    v_exp_f32 v75, v75
    v_exp_f32 v76, v76
    v_cvt_pk_bf16_f32 v47, v74, v75
    v_exp_f32 v77, v77
    v_exp_f32 v78, v78
    v_mfma_f32_32x32x8_bf16 v[52:67], v[28:29], v[20:21], v[52:67]
    ds_read_b64 v[28:29], v7 offset:2560
    buffer_load_dwordx4 v2, s[4:7], s93 offen offset:3072 lds
    v_cvt_pk_bf16_f32 v48, v76, v77
    v_exp_f32 v79, v79
    v_exp_f32 v80, v80
    v_cvt_pk_bf16_f32 v49, v78, v79
    v_exp_f32 v81, v81
    v_exp_f32 v82, v82
    v_mfma_f32_32x32x16_bf16 v[84:99], v[32:35], v[44:47], v[84:99]
    ds_read_b64_tr_b16 v[32:33], v8 offset:0
    ds_read_b64_tr_b16 v[34:35], v9 offset:0
    v_cvt_pk_bf16_f32 v50, v80, v81
    v_exp_f32 v83, v83
    v_exp_f32 v52, v52
    v_cvt_pk_bf16_f32 v51, v82, v83
    v_exp_f32 v53, v53
    v_exp_f32 v54, v54
    v_mfma_f32_32x32x16_bf16 v[84:99], v[40:43], v[48:51], v[84:99]
    ds_read_b64_tr_b16 v[40:41], v10 offset:2560
    ds_read_b64_tr_b16 v[42:43], v11 offset:2560
    v_cvt_pk_bf16_f32 v44, v52, v53
    v_exp_f32 v55, v55
    v_exp_f32 v56, v56
    v_cvt_pk_bf16_f32 v45, v54, v55
    v_exp_f32 v57, v57
    v_exp_f32 v58, v58
    s_waitcnt lgkmcnt(2)
    v_mfma_f32_32x32x16_bf16 v[68:83], v[24:27], v[16:19], 0
    ds_read_b128 v[24:27], v6 offset:5120
    s_add_u32 m0, m0, 4096
    s_nop 0
    buffer_load_dwordx4 v110, s[4:7], s93 offen lds
    v_cvt_pk_bf16_f32 v46, v56, v57
    v_exp_f32 v59, v59
    v_exp_f32 v60, v60
    v_cvt_pk_bf16_f32 v47, v58, v59
    v_exp_f32 v61, v61
    v_exp_f32 v62, v62
    v_mfma_f32_32x32x8_bf16 v[68:83], v[28:29], v[20:21], v[68:83]
    ds_read_b64 v[28:29], v7 offset:5120
    s_add_u32 s94, s48, 81920
    s_add_u32 s50, s47, 225280
    s_cmp_lg_u32 s25, 0
    s_cselect_b32 s94, s50, s94
    s_add_u32 s50, s92, 2048
    s_cmp_eq_u32 s49, 0
    s_cselect_b32 s94, s50, s94
    buffer_load_dwordx4 v[232:235], v2, s[4:7], s94 offen offset:0
    v_cvt_pk_bf16_f32 v48, v60, v61
    v_exp_f32 v63, v63
    v_exp_f32 v64, v64
    v_cvt_pk_bf16_f32 v49, v62, v63
    v_exp_f32 v65, v65
    v_exp_f32 v66, v66
    v_mfma_f32_32x32x16_bf16 v[84:99], v[32:35], v[44:47], v[84:99]
    ds_read_b64_tr_b16 v[32:33], v8 offset:2560
    ds_read_b64_tr_b16 v[34:35], v9 offset:2560
    v_cvt_pk_bf16_f32 v50, v64, v65
    v_exp_f32 v67, v67
    v_exp_f32 v68, v68
    v_cvt_pk_bf16_f32 v51, v66, v67
    v_exp_f32 v69, v69
    v_exp_f32 v70, v70
    v_mfma_f32_32x32x16_bf16 v[84:99], v[36:39], v[48:51], v[84:99]
    ds_read_b64_tr_b16 v[36:37], v10 offset:5120
    ds_read_b64_tr_b16 v[38:39], v11 offset:5120
    v_cvt_pk_bf16_f32 v44, v68, v69
    v_exp_f32 v71, v71
    v_exp_f32 v72, v72
    v_cvt_pk_bf16_f32 v45, v70, v71
    v_exp_f32 v73, v73
    v_exp_f32 v74, v74
    s_waitcnt lgkmcnt(2)
    v_mfma_f32_32x32x16_bf16 v[52:67], v[24:27], v[16:19], 0
    ds_read_b128 v[24:27], v6 offset:7680
    buffer_load_dwordx4 v[236:239], v2, s[4:7], s94 offen offset:1024
    v_cvt_pk_bf16_f32 v46, v72, v73
    v_exp_f32 v75, v75
    v_exp_f32 v76, v76
    v_cvt_pk_bf16_f32 v47, v74, v75
    v_exp_f32 v77, v77
    v_exp_f32 v78, v78
    v_mfma_f32_32x32x8_bf16 v[52:67], v[28:29], v[20:21], v[52:67]
    ds_read_b64 v[28:29], v7 offset:7680
    buffer_load_dwordx4 v[240:243], v2, s[4:7], s94 offen offset:2048
    v_cvt_pk_bf16_f32 v48, v76, v77
    v_exp_f32 v79, v79
    v_exp_f32 v80, v80
    v_cvt_pk_bf16_f32 v49, v78, v79
    v_exp_f32 v81, v81
    v_exp_f32 v82, v82
    v_mfma_f32_32x32x16_bf16 v[84:99], v[32:35], v[44:47], v[84:99]
    ds_read_b64_tr_b16 v[32:33], v8 offset:5120
    ds_read_b64_tr_b16 v[34:35], v9 offset:5120
    v_cvt_pk_bf16_f32 v50, v80, v81
    v_exp_f32 v83, v83
    v_exp_f32 v52, v52
    v_cvt_pk_bf16_f32 v51, v82, v83
    v_exp_f32 v53, v53
    v_exp_f32 v54, v54
    v_mfma_f32_32x32x16_bf16 v[84:99], v[40:43], v[48:51], v[84:99]
    ds_read_b64_tr_b16 v[40:41], v10 offset:7680
    ds_read_b64_tr_b16 v[42:43], v11 offset:7680
    v_cvt_pk_bf16_f32 v44, v52, v53
    v_exp_f32 v55, v55
    v_exp_f32 v56, v56
    v_cvt_pk_bf16_f32 v45, v54, v55
    v_exp_f32 v57, v57
    v_exp_f32 v58, v58
    s_waitcnt lgkmcnt(2)
    v_mfma_f32_32x32x16_bf16 v[68:83], v[24:27], v[16:19], 0
    ds_read_b128 v[24:27], v6 offset:10240
    buffer_load_dwordx4 v[244:247], v2, s[4:7], s94 offen offset:3072
    v_cvt_pk_bf16_f32 v46, v56, v57
    v_exp_f32 v59, v59
    v_exp_f32 v60, v60
    v_cvt_pk_bf16_f32 v47, v58, v59
    v_exp_f32 v61, v61
    v_exp_f32 v62, v62
    v_mfma_f32_32x32x8_bf16 v[68:83], v[28:29], v[20:21], v[68:83]
    ds_read_b64 v[28:29], v7 offset:10240
    buffer_load_dwordx4 v[248:251], v110, s[4:7], s94 offen
    v_cvt_pk_bf16_f32 v48, v60, v61
    v_exp_f32 v63, v63
    v_exp_f32 v64, v64
    v_cvt_pk_bf16_f32 v49, v62, v63
    v_exp_f32 v65, v65
    v_exp_f32 v66, v66
    v_mfma_f32_32x32x16_bf16 v[84:99], v[32:35], v[44:47], v[84:99]
    ds_read_b64_tr_b16 v[32:33], v8 offset:7680
    ds_read_b64_tr_b16 v[34:35], v9 offset:7680
    v_cvt_pk_bf16_f32 v50, v64, v65
    v_exp_f32 v67, v67
    v_exp_f32 v68, v68
    v_cvt_pk_bf16_f32 v51, v66, v67
    v_exp_f32 v69, v69
    v_exp_f32 v70, v70
    v_mfma_f32_32x32x16_bf16 v[84:99], v[36:39], v[48:51], v[84:99]
    ds_read_b64_tr_b16 v[36:37], v10 offset:10240
    ds_read_b64_tr_b16 v[38:39], v11 offset:10240
    v_cvt_pk_bf16_f32 v44, v68, v69
    v_exp_f32 v71, v71
    v_exp_f32 v72, v72
    v_cvt_pk_bf16_f32 v45, v70, v71
    v_exp_f32 v73, v73
    v_exp_f32 v74, v74
    s_waitcnt lgkmcnt(2)
    v_mfma_f32_32x32x16_bf16 v[52:67], v[24:27], v[16:19], 0
    ds_read_b128 v[24:27], v6 offset:12800
    s_setprio 2
    s_add_u32 s94, s47, 163840
    s_add_u32 s50, s47, 122880
    s_cmp_lg_u32 s25, 0
    s_cselect_b32 s94, s50, s94
    s_cmp_eq_u32 s49, 0
    s_cselect_b32 s94, s22, s94
    buffer_load_dwordx4 v[132:135], v22, s[4:7], s94 offen offset:0 sc1
    v_cvt_pk_bf16_f32 v46, v72, v73
    v_exp_f32 v75, v75
    v_exp_f32 v76, v76
    v_cvt_pk_bf16_f32 v47, v74, v75
    v_exp_f32 v77, v77
    v_exp_f32 v78, v78
    v_mfma_f32_32x32x8_bf16 v[52:67], v[28:29], v[20:21], v[52:67]
    ds_read_b64 v[28:29], v7 offset:12800
    buffer_load_dwordx4 v[136:139], v22, s[4:7], s94 offen offset:1024 sc1
    v_cvt_pk_bf16_f32 v48, v76, v77
    v_exp_f32 v79, v79
    v_exp_f32 v80, v80
    v_cvt_pk_bf16_f32 v49, v78, v79
    v_exp_f32 v81, v81
    v_exp_f32 v82, v82
    v_mfma_f32_32x32x16_bf16 v[84:99], v[32:35], v[44:47], v[84:99]
    ds_read_b64_tr_b16 v[32:33], v8 offset:10240
    ds_read_b64_tr_b16 v[34:35], v9 offset:10240
    v_cvt_pk_bf16_f32 v50, v80, v81
    v_exp_f32 v83, v83
    v_exp_f32 v52, v52
    v_cvt_pk_bf16_f32 v51, v82, v83
    v_exp_f32 v53, v53
    v_exp_f32 v54, v54
    v_mfma_f32_32x32x16_bf16 v[84:99], v[40:43], v[48:51], v[84:99]
    ds_read_b64_tr_b16 v[40:41], v10 offset:12800
    ds_read_b64_tr_b16 v[42:43], v11 offset:12800
    v_cvt_pk_bf16_f32 v44, v52, v53
    v_exp_f32 v55, v55
    v_exp_f32 v56, v56
    v_cvt_pk_bf16_f32 v45, v54, v55
    v_exp_f32 v57, v57
    v_exp_f32 v58, v58
    s_waitcnt lgkmcnt(2)
    v_mfma_f32_32x32x16_bf16 v[68:83], v[24:27], v[16:19], 0
    ds_read_b128 v[24:27], v6 offset:15360
    buffer_load_dwordx4 v[140:143], v22, s[4:7], s94 offen offset:2048 sc1
    v_cvt_pk_bf16_f32 v46, v56, v57
    v_exp_f32 v59, v59
    v_exp_f32 v60, v60
    v_cvt_pk_bf16_f32 v47, v58, v59
    v_exp_f32 v61, v61
    v_exp_f32 v62, v62
    v_mfma_f32_32x32x8_bf16 v[68:83], v[28:29], v[20:21], v[68:83]
    ds_read_b64 v[28:29], v7 offset:15360
    buffer_load_dwordx4 v[144:147], v22, s[4:7], s94 offen offset:3072 sc1
    v_cvt_pk_bf16_f32 v48, v60, v61
    v_exp_f32 v63, v63
    v_exp_f32 v64, v64
    v_cvt_pk_bf16_f32 v49, v62, v63
    v_exp_f32 v65, v65
    v_exp_f32 v66, v66
    v_mfma_f32_32x32x16_bf16 v[84:99], v[32:35], v[44:47], v[84:99]
    ds_read_b64_tr_b16 v[32:33], v8 offset:12800
    ds_read_b64_tr_b16 v[34:35], v9 offset:12800
    v_cvt_pk_bf16_f32 v50, v64, v65
    v_exp_f32 v67, v67
    v_exp_f32 v68, v68
    v_cvt_pk_bf16_f32 v51, v66, v67
    v_exp_f32 v69, v69
    v_exp_f32 v70, v70
    v_mfma_f32_32x32x16_bf16 v[84:99], v[36:39], v[48:51], v[84:99]
    ds_read_b64_tr_b16 v[36:37], v10 offset:15360
    ds_read_b64_tr_b16 v[38:39], v11 offset:15360
    v_cvt_pk_bf16_f32 v44, v68, v69
    v_exp_f32 v71, v71
    v_exp_f32 v72, v72
    v_cvt_pk_bf16_f32 v45, v70, v71
    v_exp_f32 v73, v73
    v_exp_f32 v74, v74
    s_waitcnt lgkmcnt(2)
    v_mfma_f32_32x32x16_bf16 v[52:67], v[24:27], v[16:19], 0
    ds_read_b128 v[24:27], v6 offset:17920
    s_setprio 1
    buffer_load_dwordx4 v[148:151], v23, s[4:7], s94 offen sc1
    v_cvt_pk_bf16_f32 v46, v72, v73
    v_exp_f32 v75, v75
    v_exp_f32 v76, v76
    v_cvt_pk_bf16_f32 v47, v74, v75
    v_exp_f32 v77, v77
    v_exp_f32 v78, v78
    v_mfma_f32_32x32x8_bf16 v[52:67], v[28:29], v[20:21], v[52:67]
    ds_read_b64 v[28:29], v7 offset:17920
    v_cvt_pk_bf16_f32 v48, v76, v77
    v_exp_f32 v79, v79
    v_exp_f32 v80, v80
    v_cvt_pk_bf16_f32 v49, v78, v79
    v_exp_f32 v81, v81
    v_exp_f32 v82, v82
    v_mfma_f32_32x32x16_bf16 v[84:99], v[32:35], v[44:47], v[84:99]
    ds_read_b64_tr_b16 v[32:33], v8 offset:15360
    ds_read_b64_tr_b16 v[34:35], v9 offset:15360
    v_cvt_pk_bf16_f32 v50, v80, v81
    v_exp_f32 v83, v83
    v_exp_f32 v52, v52
    v_cvt_pk_bf16_f32 v51, v82, v83
    v_exp_f32 v53, v53
    v_exp_f32 v54, v54
    v_mfma_f32_32x32x16_bf16 v[84:99], v[40:43], v[48:51], v[84:99]
    ds_read_b64_tr_b16 v[40:41], v10 offset:17920
    ds_read_b64_tr_b16 v[42:43], v11 offset:17920
    v_cvt_pk_bf16_f32 v44, v52, v53
    v_exp_f32 v55, v55
    v_exp_f32 v56, v56
    v_cvt_pk_bf16_f32 v45, v54, v55
    v_exp_f32 v57, v57
    v_exp_f32 v58, v58
    s_waitcnt lgkmcnt(2)
    v_mfma_f32_32x32x16_bf16 v[68:83], v[24:27], v[16:19], 0
    v_cvt_pk_bf16_f32 v46, v56, v57
    v_exp_f32 v59, v59
    v_exp_f32 v60, v60
    v_cvt_pk_bf16_f32 v47, v58, v59
    v_exp_f32 v61, v61
    v_exp_f32 v62, v62
    v_mfma_f32_32x32x8_bf16 v[68:83], v[28:29], v[20:21], v[68:83]
    v_cvt_pk_bf16_f32 v48, v60, v61
    v_exp_f32 v63, v63
    v_exp_f32 v64, v64
    v_cvt_pk_bf16_f32 v49, v62, v63
    v_exp_f32 v65, v65
    v_exp_f32 v66, v66
    v_mfma_f32_32x32x16_bf16 v[84:99], v[32:35], v[44:47], v[84:99]
    ds_read_b64_tr_b16 v[32:33], v8 offset:17920
    ds_read_b64_tr_b16 v[34:35], v9 offset:17920
    v_cvt_pk_bf16_f32 v50, v64, v65
    v_exp_f32 v67, v67
    v_exp_f32 v68, v68
    v_cvt_pk_bf16_f32 v51, v66, v67
    v_exp_f32 v69, v69
    v_exp_f32 v70, v70
    v_mfma_f32_32x32x16_bf16 v[84:99], v[36:39], v[48:51], v[84:99]
    v_cvt_pk_bf16_f32 v44, v68, v69
    v_exp_f32 v71, v71
    v_exp_f32 v72, v72
    v_cvt_pk_bf16_f32 v45, v70, v71
    v_exp_f32 v73, v73
    v_exp_f32 v74, v74
    s_waitcnt lgkmcnt(0)
    s_setprio 0
    v_cvt_pk_bf16_f32 v46, v72, v73
    v_exp_f32 v75, v75
    v_exp_f32 v76, v76
    v_cvt_pk_bf16_f32 v47, v74, v75
    v_exp_f32 v77, v77
    v_exp_f32 v78, v78
    v_cvt_pk_bf16_f32 v48, v76, v77
    v_exp_f32 v79, v79
    v_exp_f32 v80, v80
    v_cvt_pk_bf16_f32 v49, v78, v79
    v_exp_f32 v81, v81
    v_exp_f32 v82, v82
    v_mfma_f32_32x32x16_bf16 v[84:99], v[32:35], v[44:47], v[84:99]
    v_cvt_pk_bf16_f32 v50, v80, v81
    v_exp_f32 v83, v83
    s_nop 0
    v_cvt_pk_bf16_f32 v51, v82, v83
    s_setprio 0
    s_nop 0
    v_mfma_f32_32x32x16_bf16 v[84:99], v[40:43], v[48:51], v[84:99]
    s_mul_i32 s54, s40, 98304
    s_add_u32 s54, s54, s30
    s_lshl_b32 s55, s18, 10
    s_add_u32 s55, s55, s54
    s_lshr_b32 s56, s18, 1
    s_lshl_b32 s56, s56, 9
    s_add_u32 s54, s54, s56
    s_and_b32 s56, s18, 1
    s_lshl_b32 s56, s56, 3
    s_add_u32 s54, s54, s56
    s_add_u32 s54, s54, 32768
    v_lshlrev_b32 v23, 30, v5
    v_add_u32 v23, v23, v2
    s_mov_b32 s56, 0x5f800000
    s_nop 5
    v_cmp_lt_f32 vcc, v96, s56
    s_cmp_eq_u64 vcc, -1
    s_cbranch_scc0 L_att_fallback
L_att_fin:
    v_rcp_f32 v22, v96
    s_nop 0
    v_pk_mul_f32 v[84:85], v[84:85], v[22:23] op_sel_hi:[1,0]
    v_pk_mul_f32 v[86:87], v[86:87], v[22:23] op_sel_hi:[1,0]
    v_pk_mul_f32 v[88:89], v[88:89], v[22:23] op_sel_hi:[1,0]
    v_pk_mul_f32 v[90:91], v[90:91], v[22:23] op_sel_hi:[1,0]
    v_pk_mul_f32 v[92:93], v[92:93], v[22:23] op_sel_hi:[1,0]
    v_pk_mul_f32 v[94:95], v[94:95], v[22:23] op_sel_hi:[1,0]
    v_cvt_pk_bf16_f32 v84, v84, v85
    v_cvt_pk_bf16_f32 v85, v86, v87
    v_cvt_pk_bf16_f32 v86, v88, v89
    v_cvt_pk_bf16_f32 v87, v90, v91
    v_cvt_pk_bf16_f32 v88, v92, v93
    v_cvt_pk_bf16_f32 v89, v94, v95
    buffer_store_dwordx4 v[84:87], v2, s[4:7], s55 offen
    buffer_store_dwordx2 v[88:89], v23, s[4:7], s54 offen
    s_waitcnt vmcnt(2)
    v_readfirstlane_b32 s50, v109
    s_nop 1
    v_cmp_ne_u32 vcc, s50, v109
    s_cmp_lg_u64 vcc, 0
    s_cselect_b32 s19, 1, 0
    s_waitcnt lgkmcnt(0)
    s_lshl_b32 s55, s40, 7
    s_add_u32 s55, s55, s23
    s_lshl2_add_u32 s55, s18, s55
    v_mov_b32 v13, 1
    s_cmp_lg_u32 s19, 0
    s_cbranch_scc1 L_pubslow_81
    s_mov_b64 exec, 1
    s_waitcnt vmcnt(0)
    buffer_store_dword v13, v2, s[4:7], s55 offen offset:0
L_pubdone_82:
    s_mov_b64 exec, -1
    s_cmp_ge_u32 s16, 4
    s_cbranch_scc1 L_loader_main
    s_setprio 1
    s_mul_i32 s50, s34, 160
    v_lshrrev_b32 v12, 4, v1
    v_lshlrev_b32 v13, 3, v12
    v_lshlrev_b32 v12, 4, v12
    buffer_load_dwordx4 v[24:27], v12, s[12:15], s50 offen
    buffer_load_dwordx4 v[28:31], v12, s[12:15], s50 offen offset:64
    buffer_load_dwordx2 v[32:33], v13, s[12:15], s50 offen offset:128
    s_lshl_b32 s50, s36, 12
    s_add_u32 s50, s50, 294912
    buffer_load_dwordx4 v[36:39], v2, s[4:7], s50 offen offset:0
    buffer_load_dwordx4 v[40:43], v2, s[4:7], s50 offen offset:1024
    buffer_load_dwordx4 v[44:47], v2, s[4:7], s50 offen offset:2048
    s_cmp_eq_u32 s25, 0
    s_cbranch_scc1 L_res_x
    s_mov_b32 s50, 0xffff0000
    s_mov_b32 s51, 0xffff0000
    v_cndmask_b32 v148, v148, v150, s[50:51]
    v_cndmask_b32 v149, v149, v151, s[50:51]
    v_lshlrev_b32 v208, 16, v132
    v_and_b32 v209, 0xffff0000, v132
    v_lshlrev_b32 v210, 16, v133
    v_and_b32 v211, 0xffff0000, v133
    v_lshlrev_b32 v212, 16, v134
    v_and_b32 v213, 0xffff0000, v134
    v_lshlrev_b32 v214, 16, v135
    v_and_b32 v215, 0xffff0000, v135
    v_lshlrev_b32 v216, 16, v140
    v_and_b32 v217, 0xffff0000, v140
    v_lshlrev_b32 v218, 16, v141
    v_and_b32 v219, 0xffff0000, v141
    v_lshlrev_b32 v220, 16, v142
    v_and_b32 v221, 0xffff0000, v142
    v_lshlrev_b32 v222, 16, v143
    v_and_b32 v223, 0xffff0000, v143
    v_lshlrev_b32 v224, 16, v148
    v_and_b32 v225, 0xffff0000, v148
    v_lshlrev_b32 v226, 16, v149
    v_and_b32 v227, 0xffff0000, v149
    s_branch L_res_done
L_res_x:
    v_lshlrev_b32 v208, 16, v112
    v_and_b32 v209, 0xffff0000, v112
    v_lshlrev_b32 v210, 16, v113
    v_and_b32 v211, 0xffff0000, v113
    v_lshlrev_b32 v212, 16, v114
    v_and_b32 v213, 0xffff0000, v114
    v_lshlrev_b32 v214, 16, v115
    v_and_b32 v215, 0xffff0000, v115
    v_lshlrev_b32 v216, 16, v116
    v_and_b32 v217, 0xffff0000, v116
    v_lshlrev_b32 v218, 16, v117
    v_and_b32 v219, 0xffff0000, v117
    v_lshlrev_b32 v220, 16, v118
    v_and_b32 v221, 0xffff0000, v118
    v_lshlrev_b32 v222, 16, v119
    v_and_b32 v223, 0xffff0000, v119
    v_lshlrev_b32 v224, 16, v120
    v_and_b32 v225, 0xffff0000, v120
    v_lshlrev_b32 v226, 16, v121
    v_and_b32 v227, 0xffff0000, v121
L_res_done:
    s_barrier
    s_lshl_b32 s40, s35, 1
    s_add_u32 s40, s40, s39
    v_and_b32 v12, 15, v1
    s_lshl_b32 s50, s38, 4
    v_lshrrev_b32 v13, 4, v1
    v_add_u32 v12, s50, v12
    v_lshlrev_b32 v22, 4, v12
    v_lshl_add_u32 v10, v13, 9, v22
    v_lshl_add_u32 v22, v5, 9, v22
    s_mul_i32 s50, s38, 10240
    v_add_u32 v9, s50, v2
    v_xor_b32 v11, 256, v10
    v_add_u32 v6, 20480, v9
    ds_read_b128 v[48:51], v6 offset:0
    ds_read_b128 v[52:55], v6 offset:1024
    ds_read_b128 v[56:59], v6 offset:2048
    ds_read_b128 v[60:63], v6 offset:3072
    ds_read_b128 v[112:115], v6 offset:4096
    ds_read_b128 v[116:119], v6 offset:5120
    ds_read_b128 v[120:123], v6 offset:6144
    ds_read_b128 v[124:127], v6 offset:7168
    ds_read_b128 v[192:195], v6 offset:8192
    ds_read_b128 v[196:199], v6 offset:9216
    s_mul_i32 s56, s40, 98304
    s_add_u32 s56, s56, s30
    s_lshl_b32 s50, s38, 12
    s_add_u32 s56, s56, s50
    s_lshl_b32 s50, s40, 7
    s_add_u32 s50, s50, s23
    v_lshrrev_b32 v12, 2, v2
    s_mov_b32 s51, 0x100000
    s_mov_b32 exec_hi, 0
L_poll_83:
    buffer_load_dword v13, v12, s[4:7], s50 offen offset:0 sc1
    s_sub_u32 s51, s51, 1
    s_cbranch_scc1 L_polld_84
    s_waitcnt vmcnt(0)
    v_cmp_eq_u32 vcc, 0, v13
    s_cbranch_vccnz L_poll_83
L_polld_84:
    s_mov_b64 exec, -1
    s_cmp_lg_u32 s19, 0
    s_cbranch_scc1 L_ool_85
L_back_86:
    s_add_u32 s53, s56, 0
    buffer_load_dwordx4 v[64:67], v10, s[4:7], s53 offen offset:0 sc1
    buffer_load_dwordx4 v[68:71], v11, s[4:7], s53 offen offset:0 sc1
    buffer_load_dwordx4 v[72:75], v10, s[4:7], s53 offen offset:2048 sc1
    buffer_load_dwordx4 v[76:79], v11, s[4:7], s53 offen offset:2048 sc1
    s_add_u32 s53, s56, 8192
    buffer_load_dwordx4 v[80:83], v10, s[4:7], s53 offen offset:0 sc1
    buffer_load_dwordx4 v[84:87], v11, s[4:7], s53 offen offset:0 sc1
    buffer_load_dwordx4 v[88:91], v10, s[4:7], s53 offen offset:2048 sc1
    buffer_load_dwordx4 v[92:95], v11, s[4:7], s53 offen offset:2048 sc1
    s_mul_i32 s50, s16, 5120
    s_add_u32 s50, s50, 143360
    v_add_u32 v20, s50, v2
    s_xor_b32 s50, s16, 2
    s_mul_i32 s50, s50, 5120
    s_add_u32 s50, s50, 143360
    v_add_u32 v21, s50, v2
    v_bfe_u32 v12, v1, 4, 1
    v_lshlrev_b32 v13, 30, v12
    v_add_u32 v35, v13, v22
    v_lshl_add_u32 v22, v12, 3, v22
    s_mul_i32 s84, s40, 40960
    s_add_u32 s84, s84, s31
    s_mul_i32 s86, s40, 4096
    s_add_u32 s86, s86, s33
    s_mul_i32 s50, s34, 5120
    s_add_u32 s84, s84, s50
    s_add_u32 s85, s84, 4096
    s_lshl1_add_u32 s87, s34, s38
    s_lshr_b32 s50, s34, 2
    s_lshl_b32 s50, s50, 10
    s_add_u32 s86, s86, s50
    s_and_b32 s50, s34, 3
    s_lshl2_add_u32 s86, s50, s86
    v_add_u32 v12, s44, v2
    v_add_u32 v13, 122880, v12
    v_add_u32 v14, 0, v12
    s_waitcnt lgkmcnt(0)
    ds_write_b128 v13, v[152:155] offset:0
    ds_write_b128 v13, v[156:159] offset:1024
    ds_write_b128 v13, v[160:163] offset:2048
    ds_write_b128 v13, v[164:167] offset:3072
    ds_write_b128 v13, v[168:171] offset:4096
    ds_write_b128 v14, v[172:175] offset:0
    ds_write_b128 v14, v[176:179] offset:1024
    ds_write_b128 v14, v[180:183] offset:2048
    ds_write_b128 v14, v[184:187] offset:3072
    ds_write_b128 v14, v[188:191] offset:4096
    s_waitcnt vmcnt(7)
    v_mfma_f32_16x16x32_bf16 v[208:211], v[48:51], v[64:67], v[208:211]
    s_waitcnt vmcnt(6)
    v_mfma_f32_16x16x32_bf16 v[228:231], v[48:51], v[68:71], 0
    v_add_u32 v6, 40960, v9
    ds_read_b128 v[48:51], v6 offset:0
    v_mfma_f32_16x16x32_bf16 v[212:215], v[52:55], v[64:67], v[212:215]
    s_add_u32 s53, s56, 16384
    buffer_load_dwordx4 v[96:99], v10, s[4:7], s53 offen offset:0 sc1
    v_mfma_f32_16x16x32_bf16 v[232:235], v[52:55], v[68:71], 0
    ds_read_b128 v[52:55], v6 offset:1024
    v_mfma_f32_16x16x32_bf16 v[216:219], v[56:59], v[64:67], v[216:219]
    v_mfma_f32_16x16x32_bf16 v[236:239], v[56:59], v[68:71], 0
    ds_read_b128 v[56:59], v6 offset:2048
    v_mfma_f32_16x16x32_bf16 v[220:223], v[60:63], v[64:67], v[220:223]
    buffer_load_dwordx4 v[100:103], v11, s[4:7], s53 offen offset:0 sc1
    v_mfma_f32_16x16x32_bf16 v[240:243], v[60:63], v[68:71], 0
    ds_read_b128 v[60:63], v6 offset:3072
    v_mfma_f32_16x16x32_bf16 v[224:227], v[112:115], v[64:67], v[224:227]
    v_mfma_f32_16x16x32_bf16 v[244:247], v[112:115], v[68:71], 0
    ds_read_b128 v[112:115], v6 offset:4096
    s_waitcnt vmcnt(7)
    v_mfma_f32_16x16x32_bf16 v[208:211], v[116:119], v[72:75], v[208:211]
    s_waitcnt vmcnt(6)
    v_mfma_f32_16x16x32_bf16 v[228:231], v[116:119], v[76:79], v[228:231]
    ds_read_b128 v[116:119], v6 offset:5120
    v_mfma_f32_16x16x32_bf16 v[212:215], v[120:123], v[72:75], v[212:215]
    buffer_load_dwordx4 v[104:107], v10, s[4:7], s53 offen offset:2048 sc1
    v_mfma_f32_16x16x32_bf16 v[232:235], v[120:123], v[76:79], v[232:235]
    ds_read_b128 v[120:123], v6 offset:6144
    v_mfma_f32_16x16x32_bf16 v[216:219], v[124:127], v[72:75], v[216:219]
    buffer_load_dwordx4 v[108:111], v11, s[4:7], s53 offen offset:2048 sc1
    v_mfma_f32_16x16x32_bf16 v[236:239], v[124:127], v[76:79], v[236:239]
    ds_read_b128 v[124:127], v6 offset:7168
    v_mfma_f32_16x16x32_bf16 v[220:223], v[192:195], v[72:75], v[220:223]
    s_add_u32 s53, s56, 24576
    buffer_load_dwordx4 v[64:67], v10, s[4:7], s53 offen offset:0 sc1
    v_mfma_f32_16x16x32_bf16 v[240:243], v[192:195], v[76:79], v[240:243]
    ds_read_b128 v[192:195], v6 offset:8192
    v_mfma_f32_16x16x32_bf16 v[224:227], v[196:199], v[72:75], v[224:227]
    v_mfma_f32_16x16x32_bf16 v[244:247], v[196:199], v[76:79], v[244:247]
    ds_read_b128 v[196:199], v6 offset:9216
    s_waitcnt vmcnt(8) lgkmcnt(9)
    v_mfma_f32_16x16x32_bf16 v[208:211], v[48:51], v[80:83], v[208:211]
    s_waitcnt vmcnt(7)
    v_mfma_f32_16x16x32_bf16 v[228:231], v[48:51], v[84:87], v[228:231]
    v_add_u32 v6, 61440, v9
    ds_read_b128 v[48:51], v6 offset:0
    s_waitcnt lgkmcnt(9)
    v_mfma_f32_16x16x32_bf16 v[212:215], v[52:55], v[80:83], v[212:215]
    buffer_load_dwordx4 v[68:71], v11, s[4:7], s53 offen offset:0 sc1
    v_mfma_f32_16x16x32_bf16 v[232:235], v[52:55], v[84:87], v[232:235]
    ds_read_b128 v[52:55], v6 offset:1024
    s_waitcnt lgkmcnt(9)
    v_mfma_f32_16x16x32_bf16 v[216:219], v[56:59], v[80:83], v[216:219]
    v_mfma_f32_16x16x32_bf16 v[236:239], v[56:59], v[84:87], v[236:239]
    ds_read_b128 v[56:59], v6 offset:2048
    s_waitcnt lgkmcnt(9)
    v_mfma_f32_16x16x32_bf16 v[220:223], v[60:63], v[80:83], v[220:223]
    buffer_load_dwordx4 v[72:75], v10, s[4:7], s53 offen offset:2048 sc1
    v_mfma_f32_16x16x32_bf16 v[240:243], v[60:63], v[84:87], v[240:243]
    ds_read_b128 v[60:63], v6 offset:3072
    s_waitcnt lgkmcnt(9)
    v_mfma_f32_16x16x32_bf16 v[224:227], v[112:115], v[80:83], v[224:227]
    v_mfma_f32_16x16x32_bf16 v[244:247], v[112:115], v[84:87], v[244:247]
    ds_read_b128 v[112:115], v6 offset:4096
    s_waitcnt vmcnt(8) lgkmcnt(9)
    v_mfma_f32_16x16x32_bf16 v[208:211], v[116:119], v[88:91], v[208:211]
    s_waitcnt vmcnt(7)
    v_mfma_f32_16x16x32_bf16 v[228:231], v[116:119], v[92:95], v[228:231]
    ds_read_b128 v[116:119], v6 offset:5120
    s_waitcnt lgkmcnt(9)
    v_mfma_f32_16x16x32_bf16 v[212:215], v[120:123], v[88:91], v[212:215]
    buffer_load_dwordx4 v[76:79], v11, s[4:7], s53 offen offset:2048 sc1
    v_mfma_f32_16x16x32_bf16 v[232:235], v[120:123], v[92:95], v[232:235]
    ds_read_b128 v[120:123], v6 offset:6144
    s_waitcnt lgkmcnt(9)
    v_mfma_f32_16x16x32_bf16 v[216:219], v[124:127], v[88:91], v[216:219]
    s_add_u32 s53, s56, 32768
    buffer_load_dwordx4 v[80:83], v10, s[4:7], s53 offen offset:0 sc1
    v_mfma_f32_16x16x32_bf16 v[236:239], v[124:127], v[92:95], v[236:239]
    ds_read_b128 v[124:127], v6 offset:7168
    s_waitcnt lgkmcnt(9)
    v_mfma_f32_16x16x32_bf16 v[220:223], v[192:195], v[88:91], v[220:223]
    buffer_load_dwordx4 v[84:87], v11, s[4:7], s53 offen offset:0 sc1
    v_mfma_f32_16x16x32_bf16 v[240:243], v[192:195], v[92:95], v[240:243]
    ds_read_b128 v[192:195], v6 offset:8192
    s_waitcnt lgkmcnt(9)
    v_mfma_f32_16x16x32_bf16 v[224:227], v[196:199], v[88:91], v[224:227]
    v_mfma_f32_16x16x32_bf16 v[244:247], v[196:199], v[92:95], v[244:247]
    ds_read_b128 v[196:199], v6 offset:9216
    s_waitcnt vmcnt(9) lgkmcnt(9)
    v_mfma_f32_16x16x32_bf16 v[208:211], v[48:51], v[96:99], v[208:211]
    s_waitcnt vmcnt(8)
    v_mfma_f32_16x16x32_bf16 v[228:231], v[48:51], v[100:103], v[228:231]
    v_add_u32 v6, 81920, v9
    ds_read_b128 v[48:51], v6 offset:0
    s_waitcnt lgkmcnt(9)
    v_mfma_f32_16x16x32_bf16 v[212:215], v[52:55], v[96:99], v[212:215]
    buffer_load_dwordx4 v[88:91], v10, s[4:7], s53 offen offset:2048 sc1
    v_mfma_f32_16x16x32_bf16 v[232:235], v[52:55], v[100:103], v[232:235]
    ds_read_b128 v[52:55], v6 offset:1024
    s_waitcnt lgkmcnt(9)
    v_mfma_f32_16x16x32_bf16 v[216:219], v[56:59], v[96:99], v[216:219]
    v_mfma_f32_16x16x32_bf16 v[236:239], v[56:59], v[100:103], v[236:239]
    ds_read_b128 v[56:59], v6 offset:2048
    s_waitcnt lgkmcnt(9)
    v_mfma_f32_16x16x32_bf16 v[220:223], v[60:63], v[96:99], v[220:223]
    buffer_load_dwordx4 v[92:95], v11, s[4:7], s53 offen offset:2048 sc1
    s_barrier
    v_mfma_f32_16x16x32_bf16 v[240:243], v[60:63], v[100:103], v[240:243]
    ds_read_b128 v[60:63], v6 offset:3072
    s_waitcnt lgkmcnt(9)
    v_mfma_f32_16x16x32_bf16 v[224:227], v[112:115], v[96:99], v[224:227]
    v_mfma_f32_16x16x32_bf16 v[244:247], v[112:115], v[100:103], v[244:247]
    ds_read_b128 v[112:115], v6 offset:4096
    s_waitcnt vmcnt(9) lgkmcnt(9)
    v_mfma_f32_16x16x32_bf16 v[208:211], v[116:119], v[104:107], v[208:211]
    s_waitcnt vmcnt(8)
    v_mfma_f32_16x16x32_bf16 v[228:231], v[116:119], v[108:111], v[228:231]
    ds_read_b128 v[116:119], v6 offset:5120
    s_waitcnt lgkmcnt(9)
    v_mfma_f32_16x16x32_bf16 v[212:215], v[120:123], v[104:107], v[212:215]
    v_mfma_f32_16x16x32_bf16 v[232:235], v[120:123], v[108:111], v[232:235]
    ds_read_b128 v[120:123], v6 offset:6144
    s_waitcnt lgkmcnt(9)
    v_mfma_f32_16x16x32_bf16 v[216:219], v[124:127], v[104:107], v[216:219]
    v_mfma_f32_16x16x32_bf16 v[236:239], v[124:127], v[108:111], v[236:239]
    ds_read_b128 v[124:127], v6 offset:7168
    s_waitcnt lgkmcnt(9)
    v_mfma_f32_16x16x32_bf16 v[220:223], v[192:195], v[104:107], v[220:223]
    v_mfma_f32_16x16x32_bf16 v[240:243], v[192:195], v[108:111], v[240:243]
    ds_read_b128 v[192:195], v6 offset:8192
    s_waitcnt lgkmcnt(9)
    v_mfma_f32_16x16x32_bf16 v[224:227], v[196:199], v[104:107], v[224:227]
    v_mfma_f32_16x16x32_bf16 v[244:247], v[196:199], v[108:111], v[244:247]
    ds_read_b128 v[196:199], v6 offset:9216
    s_waitcnt vmcnt(7) lgkmcnt(9)
    v_mfma_f32_16x16x32_bf16 v[208:211], v[48:51], v[64:67], v[208:211]
    s_waitcnt vmcnt(6)
    v_mfma_f32_16x16x32_bf16 v[228:231], v[48:51], v[68:71], v[228:231]
    v_add_u32 v6, 102400, v9
    ds_read_b128 v[48:51], v6 offset:0
    s_waitcnt lgkmcnt(9)
    v_mfma_f32_16x16x32_bf16 v[212:215], v[52:55], v[64:67], v[212:215]
    v_mfma_f32_16x16x32_bf16 v[232:235], v[52:55], v[68:71], v[232:235]
    ds_read_b128 v[52:55], v6 offset:1024
    s_waitcnt lgkmcnt(9)
    v_mfma_f32_16x16x32_bf16 v[216:219], v[56:59], v[64:67], v[216:219]
    v_mfma_f32_16x16x32_bf16 v[236:239], v[56:59], v[68:71], v[236:239]
    ds_read_b128 v[56:59], v6 offset:2048
    s_waitcnt lgkmcnt(9)
    v_mfma_f32_16x16x32_bf16 v[220:223], v[60:63], v[64:67], v[220:223]
    v_mfma_f32_16x16x32_bf16 v[240:243], v[60:63], v[68:71], v[240:243]
    ds_read_b128 v[60:63], v6 offset:3072
    s_waitcnt lgkmcnt(9)
    v_mfma_f32_16x16x32_bf16 v[224:227], v[112:115], v[64:67], v[224:227]
    v_mfma_f32_16x16x32_bf16 v[244:247], v[112:115], v[68:71], v[244:247]
    ds_read_b128 v[112:115], v6 offset:4096
    s_waitcnt vmcnt(5) lgkmcnt(9)
    v_mfma_f32_16x16x32_bf16 v[208:211], v[116:119], v[72:75], v[208:211]
    s_waitcnt vmcnt(4)
    v_mfma_f32_16x16x32_bf16 v[228:231], v[116:119], v[76:79], v[228:231]
    ds_read_b128 v[116:119], v6 offset:5120
    s_waitcnt lgkmcnt(9)
    v_mfma_f32_16x16x32_bf16 v[212:215], v[120:123], v[72:75], v[212:215]
    v_mfma_f32_16x16x32_bf16 v[232:235], v[120:123], v[76:79], v[232:235]
    ds_read_b128 v[120:123], v6 offset:6144
    s_waitcnt lgkmcnt(9)
    v_mfma_f32_16x16x32_bf16 v[216:219], v[124:127], v[72:75], v[216:219]
    v_mfma_f32_16x16x32_bf16 v[236:239], v[124:127], v[76:79], v[236:239]
    ds_read_b128 v[124:127], v6 offset:7168
    s_waitcnt lgkmcnt(9)
    v_mfma_f32_16x16x32_bf16 v[220:223], v[192:195], v[72:75], v[220:223]
    v_mfma_f32_16x16x32_bf16 v[240:243], v[192:195], v[76:79], v[240:243]
    ds_read_b128 v[192:195], v6 offset:8192
    s_waitcnt lgkmcnt(9)
    v_mfma_f32_16x16x32_bf16 v[224:227], v[196:199], v[72:75], v[224:227]
    v_mfma_f32_16x16x32_bf16 v[244:247], v[196:199], v[76:79], v[244:247]
    ds_read_b128 v[196:199], v6 offset:9216
    s_waitcnt vmcnt(2) lgkmcnt(9)
    v_mfma_f32_16x16x32_bf16 v[228:231], v[48:51], v[84:87], v[228:231]
    s_waitcnt lgkmcnt(8)
    v_mfma_f32_16x16x32_bf16 v[232:235], v[52:55], v[84:87], v[232:235]
    s_waitcnt lgkmcnt(7)
    v_mfma_f32_16x16x32_bf16 v[236:239], v[56:59], v[84:87], v[236:239]
    s_waitcnt lgkmcnt(6)
    v_mfma_f32_16x16x32_bf16 v[240:243], v[60:63], v[84:87], v[240:243]
    s_waitcnt lgkmcnt(5)
    v_mfma_f32_16x16x32_bf16 v[244:247], v[112:115], v[84:87], v[244:247]
    s_waitcnt vmcnt(0) lgkmcnt(4)
    v_mfma_f32_16x16x32_bf16 v[228:231], v[116:119], v[92:95], v[228:231]
    s_waitcnt lgkmcnt(3)
    v_mfma_f32_16x16x32_bf16 v[232:235], v[120:123], v[92:95], v[232:235]
    s_waitcnt lgkmcnt(2)
    v_mfma_f32_16x16x32_bf16 v[236:239], v[124:127], v[92:95], v[236:239]
    s_waitcnt lgkmcnt(1)
    v_mfma_f32_16x16x32_bf16 v[240:243], v[192:195], v[92:95], v[240:243]
    s_waitcnt lgkmcnt(0)
    v_mfma_f32_16x16x32_bf16 v[244:247], v[196:199], v[92:95], v[244:247]
    v_mfma_f32_16x16x32_bf16 v[208:211], v[48:51], v[80:83], v[208:211]
    v_mfma_f32_16x16x32_bf16 v[212:215], v[52:55], v[80:83], v[212:215]
    v_mfma_f32_16x16x32_bf16 v[216:219], v[56:59], v[80:83], v[216:219]
    v_mfma_f32_16x16x32_bf16 v[220:223], v[60:63], v[80:83], v[220:223]
    ds_write_b128 v20, v[228:231] offset:0
    v_mfma_f32_16x16x32_bf16 v[224:227], v[112:115], v[80:83], v[224:227]
    ds_write_b128 v20, v[232:235] offset:1024
    v_mfma_f32_16x16x32_bf16 v[208:211], v[116:119], v[88:91], v[208:211]
    ds_write_b128 v20, v[236:239] offset:2048
    v_mfma_f32_16x16x32_bf16 v[212:215], v[120:123], v[88:91], v[212:215]
    ds_write_b128 v20, v[240:243] offset:3072
    v_mfma_f32_16x16x32_bf16 v[216:219], v[124:127], v[88:91], v[216:219]
    ds_write_b128 v20, v[244:247] offset:4096
    v_mfma_f32_16x16x32_bf16 v[220:223], v[192:195], v[88:91], v[220:223]
    v_mfma_f32_16x16x32_bf16 v[224:227], v[196:199], v[88:91], v[224:227]
    s_waitcnt lgkmcnt(0)
    s_barrier
    ds_read_b128 v[228:231], v21 offset:0
    ds_read_b128 v[232:235], v21 offset:1024
    ds_read_b128 v[236:239], v21 offset:2048
    ds_read_b128 v[240:243], v21 offset:3072
    ds_read_b128 v[244:247], v21 offset:4096
    v_mov_b32 v16, 0
    v_mov_b32 v17, 0
    v_mov_b32 v18, 0
    v_mov_b32 v19, 0
    s_waitcnt lgkmcnt(3)
    v_pk_add_f32 v[208:209], v[208:209], v[228:229]
    v_pk_add_f32 v[210:211], v[210:211], v[230:231]
    v_pk_add_f32 v[212:213], v[212:213], v[232:233]
    v_pk_add_f32 v[214:215], v[214:215], v[234:235]
    v_cvt_pk_bf16_f32 v112, v208, v209
    v_cvt_pk_bf16_f32 v113, v210, v211
    v_cvt_pk_bf16_f32 v114, v212, v213
    v_cvt_pk_bf16_f32 v115, v214, v215
    buffer_store_dwordx4 v[112:115], v10, s[4:7], s84 offen
    s_waitcnt lgkmcnt(1)
    v_pk_add_f32 v[216:217], v[216:217], v[236:237]
    v_pk_add_f32 v[218:219], v[218:219], v[238:239]
    v_pk_add_f32 v[220:221], v[220:221], v[240:241]
    v_pk_add_f32 v[222:223], v[222:223], v[242:243]
    v_cvt_pk_bf16_f32 v116, v216, v217
    v_cvt_pk_bf16_f32 v117, v218, v219
    v_cvt_pk_bf16_f32 v118, v220, v221
    v_cvt_pk_bf16_f32 v119, v222, v223
    buffer_store_dwordx4 v[116:119], v10, s[4:7], s84 offen offset:2048
    s_waitcnt lgkmcnt(0)
    v_pk_add_f32 v[224:225], v[224:225], v[244:245]
    v_pk_add_f32 v[226:227], v[226:227], v[246:247]
    v_cvt_pk_bf16_f32 v120, v224, v225
    v_cvt_pk_bf16_f32 v121, v226, v227
    buffer_store_dwordx2 v[120:121], v22, s[4:7], s85 offen
    v_pk_add_f32 v[16:17], v[16:17], v[208:209]
    v_pk_fma_f32 v[18:19], v[208:209], v[208:209], v[18:19]
    v_pk_add_f32 v[16:17], v[16:17], v[210:211]
    v_pk_fma_f32 v[18:19], v[210:211], v[210:211], v[18:19]
    v_pk_add_f32 v[16:17], v[16:17], v[212:213]
    v_pk_fma_f32 v[18:19], v[212:213], v[212:213], v[18:19]
    v_pk_add_f32 v[16:17], v[16:17], v[214:215]
    v_pk_fma_f32 v[18:19], v[214:215], v[214:215], v[18:19]
    v_pk_add_f32 v[16:17], v[16:17], v[216:217]
    v_pk_fma_f32 v[18:19], v[216:217], v[216:217], v[18:19]
    v_pk_add_f32 v[16:17], v[16:17], v[218:219]
    v_pk_fma_f32 v[18:19], v[218:219], v[218:219], v[18:19]
    v_pk_add_f32 v[16:17], v[16:17], v[220:221]
    v_pk_fma_f32 v[18:19], v[220:221], v[220:221], v[18:19]
    v_pk_add_f32 v[16:17], v[16:17], v[222:223]
    v_pk_fma_f32 v[18:19], v[222:223], v[222:223], v[18:19]
    v_pk_add_f32 v[16:17], v[16:17], v[224:225]
    v_pk_fma_f32 v[18:19], v[224:225], v[224:225], v[18:19]
    v_pk_add_f32 v[16:17], v[16:17], v[226:227]
    v_pk_fma_f32 v[18:19], v[226:227], v[226:227], v[18:19]
    v_add_f32 v16, v16, v17
    v_add_f32 v18, v18, v19
    s_nop 1
    v_permlane32_swap_b32 v16, v18
    s_nop 1
    v_add_f32 v16, v16, v18
    v_mov_b32 v17, v16
    s_nop 1
    v_permlane16_swap_b32 v16, v17
    s_nop 1
    v_add_f32 v16, v16, v17
    buffer_store_dword v16, v35, s[4:7], s86 offen
    s_lshl_b32 s55, s40, 7
    s_add_u32 s55, s55, s23
    s_lshl2_add_u32 s55, s87, s55
    v_mov_b32 v13, 1
    s_cmp_lg_u32 s19, 0
    s_cbranch_scc1 L_pubslow_88
    s_mov_b64 exec, 1
    s_waitcnt vmcnt(0)
    buffer_store_dword v13, v2, s[4:7], s55 offen offset:1024
L_pubdone_89:
    s_mov_b64 exec, -1
    s_lshl_b32 s40, s37, 2
    s_add_u32 s40, s40, s16
    v_mov_b32 v9, v2
    s_barrier
    v_add_u32 v6, 122880, v9
    ds_read_b128 v[48:51], v6 offset:0
    ds_read_b128 v[52:55], v6 offset:1024
    ds_read_b128 v[56:59], v6 offset:2048
    ds_read_b128 v[60:63], v6 offset:3072
    ds_read_b128 v[176:179], v6 offset:4096
    ds_read_b128 v[180:183], v6 offset:5120
    s_lshl_b32 s50, s40, 7
    s_add_u32 s50, s50, s23
    v_lshrrev_b32 v12, 2, v2
    s_mov_b32 s51, 0x100000
    s_mov_b64 exec, 0xffff
L_poll_90:
    buffer_load_dword v13, v12, s[4:7], s50 offen offset:1024 sc1
    s_sub_u32 s51, s51, 1
    s_cbranch_scc1 L_polld_91
    s_waitcnt vmcnt(0)
    v_cmp_eq_u32 vcc, 0, v13
    s_cbranch_vccnz L_poll_90
L_polld_91:
    s_mov_b64 exec, -1
    s_cmp_lg_u32 s19, 0
    s_cbranch_scc1 L_ool_92
L_back_93:
    s_mul_i32 s56, s40, 40960
    s_add_u32 s56, s56, s31
    s_add_u32 s53, s56, 0
    buffer_load_dwordx4 v[128:131], v2, s[4:7], s53 offen offset:0 sc1
    buffer_load_dwordx4 v[132:135], v2, s[4:7], s53 offen offset:1024 sc1
    buffer_load_dwordx4 v[136:139], v2, s[4:7], s53 offen offset:2048 sc1
    buffer_load_dwordx4 v[140:143], v2, s[4:7], s53 offen offset:3072 sc1
    s_add_u32 s53, s56, 4096
    buffer_load_dwordx4 v[144:147], v2, s[4:7], s53 offen offset:0 sc1
    buffer_load_dwordx4 v[148:151], v2, s[4:7], s53 offen offset:1024 sc1
    buffer_load_dwordx4 v[152:155], v2, s[4:7], s53 offen offset:2048 sc1
    s_mul_i32 s84, s40, 98304
    s_add_u32 s84, s84, s32
    s_mul_i32 s50, s36, 6144
    s_add_u32 s84, s84, s50
    s_add_u32 s85, s84, 4096
    v_lshlrev_b32 v208, 16, v112
    v_and_b32 v209, 0xffff0000, v112
    v_lshlrev_b32 v228, 16, v24
    v_and_b32 v229, 0xffff0000, v24
    v_pk_add_f32 v[208:209], v[208:209], v[228:229]
    v_lshlrev_b32 v210, 16, v113
    v_and_b32 v211, 0xffff0000, v113
    v_lshlrev_b32 v228, 16, v25
    v_and_b32 v229, 0xffff0000, v25
    v_pk_add_f32 v[210:211], v[210:211], v[228:229]
    v_lshlrev_b32 v212, 16, v114
    v_and_b32 v213, 0xffff0000, v114
    v_lshlrev_b32 v228, 16, v26
    v_and_b32 v229, 0xffff0000, v26
    v_pk_add_f32 v[212:213], v[212:213], v[228:229]
    v_lshlrev_b32 v214, 16, v115
    v_and_b32 v215, 0xffff0000, v115
    v_lshlrev_b32 v228, 16, v27
    v_and_b32 v229, 0xffff0000, v27
    v_pk_add_f32 v[214:215], v[214:215], v[228:229]
    v_lshlrev_b32 v216, 16, v116
    v_and_b32 v217, 0xffff0000, v116
    v_lshlrev_b32 v228, 16, v28
    v_and_b32 v229, 0xffff0000, v28
    v_pk_add_f32 v[216:217], v[216:217], v[228:229]
    v_lshlrev_b32 v218, 16, v117
    v_and_b32 v219, 0xffff0000, v117
    v_lshlrev_b32 v228, 16, v29
    v_and_b32 v229, 0xffff0000, v29
    v_pk_add_f32 v[218:219], v[218:219], v[228:229]
    v_lshlrev_b32 v220, 16, v118
    v_and_b32 v221, 0xffff0000, v118
    v_lshlrev_b32 v228, 16, v30
    v_and_b32 v229, 0xffff0000, v30
    v_pk_add_f32 v[220:221], v[220:221], v[228:229]
    v_lshlrev_b32 v222, 16, v119
    v_and_b32 v223, 0xffff0000, v119
    v_lshlrev_b32 v228, 16, v31
    v_and_b32 v229, 0xffff0000, v31
    v_pk_add_f32 v[222:223], v[222:223], v[228:229]
    v_lshlrev_b32 v224, 16, v120
    v_and_b32 v225, 0xffff0000, v120
    v_lshlrev_b32 v228, 16, v32
    v_and_b32 v229, 0xffff0000, v32
    v_pk_add_f32 v[224:225], v[224:225], v[228:229]
    v_lshlrev_b32 v226, 16, v121
    v_and_b32 v227, 0xffff0000, v121
    v_lshlrev_b32 v228, 16, v33
    v_and_b32 v229, 0xffff0000, v33
    v_pk_add_f32 v[226:227], v[226:227], v[228:229]
    s_waitcnt vmcnt(6)
    s_waitcnt lgkmcnt(5)
    v_mfma_f32_32x32x16_bf16 v[64:79], v[48:51], v[128:131], 0
    ds_read_b128 v[48:51], v6 offset:6144
    buffer_load_dwordx4 v[156:159], v2, s[4:7], s53 offen offset:3072 sc1
    s_waitcnt lgkmcnt(5)
    v_mfma_f32_32x32x16_bf16 v[80:95], v[52:55], v[128:131], 0
    ds_read_b128 v[52:55], v6 offset:7168
    s_waitcnt lgkmcnt(5)
    v_mfma_f32_32x32x16_bf16 v[96:111], v[56:59], v[128:131], 0
    ds_read_b128 v[56:59], v6 offset:8192
    s_lshl_b32 s54, s40, 12
    s_add_u32 s54, s54, s33
    buffer_load_dwordx4 v[192:195], v2, s[4:7], s54 offen offset:0 sc1
    s_waitcnt vmcnt(7)
    s_waitcnt lgkmcnt(5)
    v_mfma_f32_32x32x16_bf16 v[64:79], v[60:63], v[132:135], v[64:79]
    ds_read_b128 v[60:63], v6 offset:9216
    s_add_u32 s53, s56, 8192
    buffer_load_dwordx4 v[160:163], v2, s[4:7], s53 offen offset:0 sc1
    s_waitcnt lgkmcnt(5)
    v_mfma_f32_32x32x16_bf16 v[80:95], v[176:179], v[132:135], v[80:95]
    ds_read_b128 v[176:179], v6 offset:10240
    buffer_load_dwordx4 v[164:167], v2, s[4:7], s53 offen offset:1024 sc1
    s_waitcnt lgkmcnt(5)
    v_mfma_f32_32x32x16_bf16 v[96:111], v[180:183], v[132:135], v[96:111]
    ds_read_b128 v[180:183], v6 offset:11264
    s_waitcnt vmcnt(8)
    s_waitcnt lgkmcnt(5)
    v_mfma_f32_32x32x16_bf16 v[64:79], v[48:51], v[136:139], v[64:79]
    ds_read_b128 v[48:51], v6 offset:12288
    buffer_load_dwordx4 v[168:171], v2, s[4:7], s53 offen offset:2048 sc1
    s_waitcnt lgkmcnt(5)
    v_mfma_f32_32x32x16_bf16 v[80:95], v[52:55], v[136:139], v[80:95]
    ds_read_b128 v[52:55], v6 offset:13312
    s_waitcnt lgkmcnt(5)
    v_mfma_f32_32x32x16_bf16 v[96:111], v[56:59], v[136:139], v[96:111]
    ds_read_b128 v[56:59], v6 offset:14336
    buffer_load_dwordx4 v[196:199], v2, s[4:7], s54 offen offset:1024 sc1
    s_waitcnt vmcnt(9)
    s_waitcnt lgkmcnt(5)
    v_mfma_f32_32x32x16_bf16 v[64:79], v[60:63], v[140:143], v[64:79]
    ds_read_b128 v[60:63], v6 offset:15360
    buffer_load_dwordx4 v[172:175], v2, s[4:7], s53 offen offset:3072 sc1
    s_waitcnt lgkmcnt(5)
    v_mfma_f32_32x32x16_bf16 v[80:95], v[176:179], v[140:143], v[80:95]
    ds_read_b128 v[176:179], v6 offset:16384
    s_add_u32 s53, s56, 12288
    buffer_load_dwordx4 v[128:131], v2, s[4:7], s53 offen offset:0 sc1
    s_waitcnt lgkmcnt(5)
    v_mfma_f32_32x32x16_bf16 v[96:111], v[180:183], v[140:143], v[96:111]
    ds_read_b128 v[180:183], v6 offset:17408
    s_waitcnt vmcnt(10)
    s_waitcnt lgkmcnt(5)
    v_mfma_f32_32x32x16_bf16 v[64:79], v[48:51], v[144:147], v[64:79]
    ds_read_b128 v[48:51], v6 offset:18432
    buffer_load_dwordx4 v[132:135], v2, s[4:7], s53 offen offset:1024 sc1
    s_waitcnt lgkmcnt(5)
    v_mfma_f32_32x32x16_bf16 v[80:95], v[52:55], v[144:147], v[80:95]
    ds_read_b128 v[52:55], v6 offset:19456
    s_waitcnt lgkmcnt(5)
    v_mfma_f32_32x32x16_bf16 v[96:111], v[56:59], v[144:147], v[96:111]
    v_add_u32 v6, 0, v9
    ds_read_b128 v[56:59], v6 offset:0
    s_waitcnt vmcnt(10)
    s_waitcnt lgkmcnt(5)
    v_mfma_f32_32x32x16_bf16 v[64:79], v[60:63], v[148:151], v[64:79]
    ds_read_b128 v[60:63], v6 offset:1024
    buffer_load_dwordx4 v[136:139], v2, s[4:7], s53 offen offset:2048 sc1
    s_waitcnt lgkmcnt(5)
    v_mfma_f32_32x32x16_bf16 v[80:95], v[176:179], v[148:151], v[80:95]
    ds_read_b128 v[176:179], v6 offset:2048
    buffer_load_dwordx4 v[140:143], v2, s[4:7], s53 offen offset:3072 sc1
    s_waitcnt lgkmcnt(5)
    v_mfma_f32_32x32x16_bf16 v[96:111], v[180:183], v[148:151], v[96:111]
    ds_read_b128 v[180:183], v6 offset:3072
    s_waitcnt vmcnt(11)
    s_waitcnt lgkmcnt(5)
    v_mfma_f32_32x32x16_bf16 v[64:79], v[48:51], v[152:155], v[64:79]
    ds_read_b128 v[48:51], v6 offset:4096
    s_add_u32 s53, s56, 16384
    buffer_load_dwordx4 v[144:147], v2, s[4:7], s53 offen offset:0 sc1
    s_waitcnt lgkmcnt(5)
    v_mfma_f32_32x32x16_bf16 v[80:95], v[52:55], v[152:155], v[80:95]
    ds_read_b128 v[52:55], v6 offset:5120
    s_waitcnt lgkmcnt(5)
    v_mfma_f32_32x32x16_bf16 v[96:111], v[56:59], v[152:155], v[96:111]
    ds_read_b128 v[56:59], v6 offset:6144
    s_waitcnt vmcnt(11)
    s_waitcnt lgkmcnt(5)
    v_mfma_f32_32x32x16_bf16 v[64:79], v[60:63], v[156:159], v[64:79]
    ds_read_b128 v[60:63], v6 offset:7168
    buffer_load_dwordx4 v[148:151], v2, s[4:7], s53 offen offset:1024 sc1
    s_waitcnt lgkmcnt(5)
    v_mfma_f32_32x32x16_bf16 v[80:95], v[176:179], v[156:159], v[80:95]
    ds_read_b128 v[176:179], v6 offset:8192
    buffer_load_dwordx4 v[152:155], v2, s[4:7], s53 offen offset:2048 sc1
    s_waitcnt lgkmcnt(5)
    v_mfma_f32_32x32x16_bf16 v[96:111], v[180:183], v[156:159], v[96:111]
    ds_read_b128 v[180:183], v6 offset:9216
    s_waitcnt vmcnt(11)
    s_waitcnt lgkmcnt(5)
    v_mfma_f32_32x32x16_bf16 v[64:79], v[48:51], v[160:163], v[64:79]
    ds_read_b128 v[48:51], v6 offset:10240
    buffer_load_dwordx4 v[156:159], v2, s[4:7], s53 offen offset:3072 sc1
    s_waitcnt lgkmcnt(5)
    v_mfma_f32_32x32x16_bf16 v[80:95], v[52:55], v[160:163], v[80:95]
    ds_read_b128 v[52:55], v6 offset:11264
    s_waitcnt lgkmcnt(5)
    v_mfma_f32_32x32x16_bf16 v[96:111], v[56:59], v[160:163], v[96:111]
    ds_read_b128 v[56:59], v6 offset:12288
    s_waitcnt vmcnt(11)
    s_waitcnt lgkmcnt(5)
    v_mfma_f32_32x32x16_bf16 v[64:79], v[60:63], v[164:167], v[64:79]
    ds_read_b128 v[60:63], v6 offset:13312
    s_add_u32 s53, s56, 20480
    buffer_load_dwordx4 v[160:163], v2, s[4:7], s53 offen offset:0 sc1
    s_waitcnt lgkmcnt(5)
    v_mfma_f32_32x32x16_bf16 v[80:95], v[176:179], v[164:167], v[80:95]
    ds_read_b128 v[176:179], v6 offset:14336
    s_waitcnt lgkmcnt(5)
    v_mfma_f32_32x32x16_bf16 v[96:111], v[180:183], v[164:167], v[96:111]
    ds_read_b128 v[180:183], v6 offset:15360
    s_waitcnt vmcnt(11)
    s_waitcnt lgkmcnt(5)
    v_mfma_f32_32x32x16_bf16 v[64:79], v[48:51], v[168:171], v[64:79]
    ds_read_b128 v[48:51], v6 offset:16384
    buffer_load_dwordx4 v[164:167], v2, s[4:7], s53 offen offset:1024 sc1
    s_waitcnt lgkmcnt(5)
    v_mfma_f32_32x32x16_bf16 v[80:95], v[52:55], v[168:171], v[80:95]
    ds_read_b128 v[52:55], v6 offset:17408
    s_waitcnt lgkmcnt(5)
    v_mfma_f32_32x32x16_bf16 v[96:111], v[56:59], v[168:171], v[96:111]
    ds_read_b128 v[56:59], v6 offset:18432
    s_waitcnt vmcnt(10)
    s_waitcnt lgkmcnt(5)
    v_mfma_f32_32x32x16_bf16 v[64:79], v[60:63], v[172:175], v[64:79]
    ds_read_b128 v[60:63], v6 offset:19456
    buffer_load_dwordx4 v[168:171], v2, s[4:7], s53 offen offset:2048 sc1
    s_waitcnt lgkmcnt(5)
    v_mfma_f32_32x32x16_bf16 v[80:95], v[176:179], v[172:175], v[80:95]
    v_add_u32 v6, 20480, v9
    ds_read_b128 v[176:179], v6 offset:0
    s_waitcnt lgkmcnt(5)
    v_mfma_f32_32x32x16_bf16 v[96:111], v[180:183], v[172:175], v[96:111]
    ds_read_b128 v[180:183], v6 offset:1024
    s_waitcnt vmcnt(10)
    s_waitcnt lgkmcnt(5)
    v_mfma_f32_32x32x16_bf16 v[64:79], v[48:51], v[128:131], v[64:79]
    ds_read_b128 v[48:51], v6 offset:2048
    buffer_load_dwordx4 v[172:175], v2, s[4:7], s53 offen offset:3072 sc1
    s_waitcnt lgkmcnt(5)
    v_mfma_f32_32x32x16_bf16 v[80:95], v[52:55], v[128:131], v[80:95]
    ds_read_b128 v[52:55], v6 offset:3072
    s_waitcnt lgkmcnt(5)
    v_mfma_f32_32x32x16_bf16 v[96:111], v[56:59], v[128:131], v[96:111]
    ds_read_b128 v[56:59], v6 offset:4096
    s_waitcnt vmcnt(10)
    s_waitcnt lgkmcnt(5)
    v_mfma_f32_32x32x16_bf16 v[64:79], v[60:63], v[132:135], v[64:79]
    ds_read_b128 v[60:63], v6 offset:5120
    s_add_u32 s53, s56, 24576
    buffer_load_dwordx4 v[128:131], v2, s[4:7], s53 offen offset:0 sc1
    s_waitcnt lgkmcnt(5)
    v_mfma_f32_32x32x16_bf16 v[80:95], v[176:179], v[132:135], v[80:95]
    ds_read_b128 v[176:179], v6 offset:6144
    s_waitcnt lgkmcnt(5)
    v_mfma_f32_32x32x16_bf16 v[96:111], v[180:183], v[132:135], v[96:111]
    ds_read_b128 v[180:183], v6 offset:7168
    s_waitcnt vmcnt(10)
    s_waitcnt lgkmcnt(5)
    v_mfma_f32_32x32x16_bf16 v[64:79], v[48:51], v[136:139], v[64:79]
    ds_read_b128 v[48:51], v6 offset:8192
    buffer_load_dwordx4 v[132:135], v2, s[4:7], s53 offen offset:1024 sc1
    v_add_f32 v192, v192, v196
    s_waitcnt lgkmcnt(5)
    v_mfma_f32_32x32x16_bf16 v[80:95], v[52:55], v[136:139], v[80:95]
    ds_read_b128 v[52:55], v6 offset:9216
    v_add_f32 v193, v193, v197
    v_add_f32 v194, v194, v198
    s_waitcnt lgkmcnt(5)
    v_mfma_f32_32x32x16_bf16 v[96:111], v[56:59], v[136:139], v[96:111]
    ds_read_b128 v[56:59], v6 offset:10240
    v_add_f32 v195, v195, v199
    v_add_f32 v192, v192, v194
    s_waitcnt vmcnt(10)
    s_waitcnt lgkmcnt(5)
    v_mfma_f32_32x32x16_bf16 v[64:79], v[60:63], v[140:143], v[64:79]
    ds_read_b128 v[60:63], v6 offset:11264
    buffer_load_dwordx4 v[136:139], v2, s[4:7], s53 offen offset:2048 sc1
    v_add_f32 v193, v193, v195
    v_add_f32 v192, v192, v193
    s_waitcnt lgkmcnt(5)
    v_mfma_f32_32x32x16_bf16 v[80:95], v[176:179], v[140:143], v[80:95]
    ds_read_b128 v[176:179], v6 offset:12288
    v_mul_f32 v192, 0x3acccccd, v192
    v_mov_b32 v193, v192
    s_waitcnt lgkmcnt(5)
    v_mfma_f32_32x32x16_bf16 v[96:111], v[180:183], v[140:143], v[96:111]
    ds_read_b128 v[180:183], v6 offset:13312
    s_nop 1
    v_permlane32_swap_b32 v192, v193
    s_waitcnt vmcnt(10)
    s_waitcnt lgkmcnt(5)
    v_mfma_f32_32x32x16_bf16 v[64:79], v[48:51], v[144:147], v[64:79]
    ds_read_b128 v[48:51], v6 offset:14336
    buffer_load_dwordx4 v[140:143], v2, s[4:7], s53 offen offset:3072 sc1
    v_cmp_gt_u32 vcc, 32, v1
    v_fma_f32 v193, -v192, v192, v193
    s_waitcnt lgkmcnt(5)
    v_mfma_f32_32x32x16_bf16 v[80:95], v[52:55], v[144:147], v[80:95]
    ds_read_b128 v[52:55], v6 offset:15360
    v_max_f32 v193, 0, v193
    v_add_f32 v194, 0x3727c5ac, v193
    s_waitcnt lgkmcnt(5)
    v_mfma_f32_32x32x16_bf16 v[96:111], v[56:59], v[144:147], v[96:111]
    ds_read_b128 v[56:59], v6 offset:16384
    v_rsq_f32 v16, v194
    v_sub_f32 v196, 0, v192
    s_waitcnt vmcnt(10)
    s_waitcnt lgkmcnt(5)
    v_mfma_f32_32x32x16_bf16 v[64:79], v[60:63], v[148:151], v[64:79]
    ds_read_b128 v[60:63], v6 offset:17408
    s_add_u32 s53, s56, 28672
    buffer_load_dwordx4 v[144:147], v2, s[4:7], s53 offen offset:0 sc1
    v_mov_b32 v18, 0xffff0000
    v_and_b32 v197, 0xffff0000, v196
    s_waitcnt lgkmcnt(5)
    v_mfma_f32_32x32x16_bf16 v[80:95], v[176:179], v[148:151], v[80:95]
    ds_read_b128 v[176:179], v6 offset:18432
    v_sub_f32 v198, v196, v197
    v_lshrrev_b32 v197, 16, v197
    s_waitcnt lgkmcnt(5)
    v_mfma_f32_32x32x16_bf16 v[96:111], v[180:183], v[148:151], v[96:111]
    ds_read_b128 v[180:183], v6 offset:19456
    v_mul_f32 v195, v16, v16
    v_mul_f32 v195, v195, v193
    s_waitcnt vmcnt(10)
    s_waitcnt lgkmcnt(5)
    v_mfma_f32_32x32x16_bf16 v[64:79], v[48:51], v[152:155], v[64:79]
    v_add_u32 v6, 40960, v9
    ds_read_b128 v[48:51], v6 offset:0
    buffer_load_dwordx4 v[148:151], v2, s[4:7], s53 offen offset:1024 sc1
    v_add_f32 v195, 0x3727c5ac, v195
    v_rsq_f32 v195, v195
    s_waitcnt lgkmcnt(5)
    v_mfma_f32_32x32x16_bf16 v[80:95], v[52:55], v[152:155], v[80:95]
    ds_read_b128 v[52:55], v6 offset:1024
    v_and_or_b32 v32, v198, v18, v197
    v_mul_f32 v16, v16, v195
    s_waitcnt lgkmcnt(5)
    v_mfma_f32_32x32x16_bf16 v[96:111], v[56:59], v[152:155], v[96:111]
    ds_read_b128 v[56:59], v6 offset:2048
    v_rcp_f32 v17, v16
    v_mov_b32 v34, v32
    s_waitcnt vmcnt(10)
    s_waitcnt lgkmcnt(5)
    v_mfma_f32_32x32x16_bf16 v[64:79], v[60:63], v[156:159], v[64:79]
    ds_read_b128 v[60:63], v6 offset:3072
    buffer_load_dwordx4 v[152:155], v2, s[4:7], s53 offen offset:2048 sc1
    v_cndmask_b32 v199, v17, 0, vcc
    v_and_b32 v200, 0xffff0000, v199
    s_waitcnt lgkmcnt(5)
    v_mfma_f32_32x32x16_bf16 v[80:95], v[176:179], v[156:159], v[80:95]
    ds_read_b128 v[176:179], v6 offset:4096
    v_sub_f32 v201, v199, v200
    v_or_b32 v33, v200, v197
    s_waitcnt lgkmcnt(5)
    v_mfma_f32_32x32x16_bf16 v[96:111], v[180:183], v[156:159], v[96:111]
    ds_read_b128 v[180:183], v6 offset:5120
    v_and_or_b32 v35, v201, v18, v197
    v_mul_f32 v20, 0xc0135761, v16
    s_waitcnt vmcnt(10)
    s_waitcnt lgkmcnt(5)
    v_mfma_f32_32x32x16_bf16 v[64:79], v[48:51], v[160:163], v[64:79]
    ds_read_b128 v[48:51], v6 offset:6144
    buffer_load_dwordx4 v[156:159], v2, s[4:7], s53 offen offset:3072 sc1
    v_mul_f32 v22, v16, v16
    v_mul_f32 v22, v22, v16
    s_waitcnt lgkmcnt(5)
    v_mfma_f32_32x32x16_bf16 v[80:95], v[52:55], v[160:163], v[80:95]
    ds_read_b128 v[52:55], v6 offset:7168
    v_mul_f32 v22, 0xbdd2d3e8, v22
    v_mov_b32 v24, v17
    s_waitcnt lgkmcnt(5)
    v_mfma_f32_32x32x16_bf16 v[96:111], v[56:59], v[160:163], v[96:111]
    ds_read_b128 v[56:59], v6 offset:8192
    s_waitcnt vmcnt(10)
    s_waitcnt lgkmcnt(5)
    v_mfma_f32_32x32x16_bf16 v[64:79], v[60:63], v[164:167], v[64:79]
    ds_read_b128 v[60:63], v6 offset:9216
    s_add_u32 s53, s56, 32768
    buffer_load_dwordx4 v[160:163], v2, s[4:7], s53 offen offset:0 sc1
    s_waitcnt lgkmcnt(5)
    v_mfma_f32_32x32x16_bf16 v[80:95], v[176:179], v[164:167], v[80:95]
    ds_read_b128 v[176:179], v6 offset:10240
    s_waitcnt lgkmcnt(5)
    v_mfma_f32_32x32x16_bf16 v[96:111], v[180:183], v[164:167], v[96:111]
    ds_read_b128 v[180:183], v6 offset:11264
    s_waitcnt vmcnt(10)
    s_waitcnt lgkmcnt(5)
    v_mfma_f32_32x32x16_bf16 v[64:79], v[48:51], v[168:171], v[64:79]
    ds_read_b128 v[48:51], v6 offset:12288
    buffer_load_dwordx4 v[164:167], v2, s[4:7], s53 offen offset:1024 sc1
    v_mfma_f32_32x32x16_bf16 v[64:79], v[36:39], v[32:35], v[64:79]
    s_waitcnt lgkmcnt(5)
    v_mfma_f32_32x32x16_bf16 v[80:95], v[52:55], v[168:171], v[80:95]
    ds_read_b128 v[52:55], v6 offset:13312
    v_mfma_f32_32x32x16_bf16 v[80:95], v[40:43], v[32:35], v[80:95]
    s_waitcnt lgkmcnt(5)
    v_mfma_f32_32x32x16_bf16 v[96:111], v[56:59], v[168:171], v[96:111]
    ds_read_b128 v[56:59], v6 offset:14336
    v_mfma_f32_32x32x16_bf16 v[96:111], v[44:47], v[32:35], v[96:111]
    s_waitcnt vmcnt(10)
    s_waitcnt lgkmcnt(5)
    v_mfma_f32_32x32x16_bf16 v[64:79], v[60:63], v[172:175], v[64:79]
    ds_read_b128 v[60:63], v6 offset:15360
    buffer_load_dwordx4 v[168:171], v2, s[4:7], s53 offen offset:2048 sc1
    s_waitcnt lgkmcnt(5)
    v_mfma_f32_32x32x16_bf16 v[80:95], v[176:179], v[172:175], v[80:95]
    ds_read_b128 v[176:179], v6 offset:16384
    s_waitcnt lgkmcnt(5)
    v_mfma_f32_32x32x16_bf16 v[96:111], v[180:183], v[172:175], v[96:111]
    ds_read_b128 v[180:183], v6 offset:17408
    s_waitcnt vmcnt(10)
    s_waitcnt lgkmcnt(5)
    v_mfma_f32_32x32x16_bf16 v[64:79], v[48:51], v[128:131], v[64:79]
    ds_read_b128 v[48:51], v6 offset:18432
    buffer_load_dwordx4 v[172:175], v2, s[4:7], s53 offen offset:3072 sc1
    s_waitcnt lgkmcnt(5)
    v_mfma_f32_32x32x16_bf16 v[80:95], v[52:55], v[128:131], v[80:95]
    ds_read_b128 v[52:55], v6 offset:19456
    s_waitcnt lgkmcnt(5)
    v_mfma_f32_32x32x16_bf16 v[96:111], v[56:59], v[128:131], v[96:111]
    s_barrier
    v_add_u32 v6, 61440, v9
    ds_read_b128 v[56:59], v6 offset:0
    s_waitcnt vmcnt(10)
    s_waitcnt lgkmcnt(5)
    v_mfma_f32_32x32x16_bf16 v[64:79], v[60:63], v[132:135], v[64:79]
    ds_read_b128 v[60:63], v6 offset:1024
    s_add_u32 s53, s56, 36864
    buffer_load_dwordx4 v[128:131], v2, s[4:7], s53 offen offset:0 sc1
    s_waitcnt lgkmcnt(5)
    v_mfma_f32_32x32x16_bf16 v[80:95], v[176:179], v[132:135], v[80:95]
    ds_read_b128 v[176:179], v6 offset:2048
    s_waitcnt lgkmcnt(5)
    v_mfma_f32_32x32x16_bf16 v[96:111], v[180:183], v[132:135], v[96:111]
    ds_read_b128 v[180:183], v6 offset:3072
    s_waitcnt vmcnt(10)
    s_waitcnt lgkmcnt(5)
    v_mfma_f32_32x32x16_bf16 v[64:79], v[48:51], v[136:139], v[64:79]
    ds_read_b128 v[48:51], v6 offset:4096
    buffer_load_dwordx4 v[132:135], v2, s[4:7], s53 offen offset:1024 sc1
    s_waitcnt lgkmcnt(5)
    v_mfma_f32_32x32x16_bf16 v[80:95], v[52:55], v[136:139], v[80:95]
    ds_read_b128 v[52:55], v6 offset:5120
    s_waitcnt lgkmcnt(5)
    v_mfma_f32_32x32x16_bf16 v[96:111], v[56:59], v[136:139], v[96:111]
    ds_read_b128 v[56:59], v6 offset:6144
    s_lshl_b32 s50, s36, 11
    s_add_u32 s50, s50, 262144
    v_lshlrev_b32 v12, 3, v1
    buffer_load_dwordx2 v[40:41], v12, s[4:7], s50 offen offset:0
    buffer_load_dwordx2 v[42:43], v12, s[4:7], s50 offen offset:512
    buffer_load_dwordx2 v[44:45], v12, s[4:7], s50 offen offset:1024
    buffer_load_dwordx2 v[46:47], v12, s[4:7], s50 offen offset:1536
    s_waitcnt vmcnt(14)
    s_waitcnt lgkmcnt(5)
    v_mfma_f32_32x32x16_bf16 v[64:79], v[60:63], v[140:143], v[64:79]
    ds_read_b128 v[60:63], v6 offset:7168
    buffer_load_dwordx4 v[136:139], v2, s[4:7], s53 offen offset:2048 sc1
    s_waitcnt lgkmcnt(5)
    v_mfma_f32_32x32x16_bf16 v[80:95], v[176:179], v[140:143], v[80:95]
    ds_read_b128 v[176:179], v6 offset:8192
    s_waitcnt lgkmcnt(5)
    v_mfma_f32_32x32x16_bf16 v[96:111], v[180:183], v[140:143], v[96:111]
    ds_read_b128 v[180:183], v6 offset:9216
    s_waitcnt vmcnt(14)
    s_waitcnt lgkmcnt(5)
    v_mfma_f32_32x32x16_bf16 v[64:79], v[48:51], v[144:147], v[64:79]
    ds_read_b128 v[48:51], v6 offset:10240
    buffer_load_dwordx4 v[140:143], v2, s[4:7], s53 offen offset:3072 sc1
    s_barrier
    s_waitcnt lgkmcnt(5)
    v_mfma_f32_32x32x16_bf16 v[80:95], v[52:55], v[144:147], v[80:95]
    ds_read_b128 v[52:55], v6 offset:11264
    s_waitcnt lgkmcnt(5)
    v_mfma_f32_32x32x16_bf16 v[96:111], v[56:59], v[144:147], v[96:111]
    ds_read_b128 v[56:59], v6 offset:12288
    s_waitcnt vmcnt(14)
    s_waitcnt lgkmcnt(5)
    v_mfma_f32_32x32x16_bf16 v[64:79], v[60:63], v[148:151], v[64:79]
    ds_read_b128 v[60:63], v6 offset:13312
    s_waitcnt lgkmcnt(5)
    v_mfma_f32_32x32x16_bf16 v[80:95], v[176:179], v[148:151], v[80:95]
    ds_read_b128 v[176:179], v6 offset:14336
    s_waitcnt lgkmcnt(5)
    v_mfma_f32_32x32x16_bf16 v[96:111], v[180:183], v[148:151], v[96:111]
    ds_read_b128 v[180:183], v6 offset:15360
    s_waitcnt vmcnt(13)
    s_waitcnt lgkmcnt(5)
    v_mfma_f32_32x32x16_bf16 v[64:79], v[48:51], v[152:155], v[64:79]
    ds_read_b128 v[48:51], v6 offset:16384
    s_waitcnt lgkmcnt(5)
    v_mfma_f32_32x32x16_bf16 v[80:95], v[52:55], v[152:155], v[80:95]
    ds_read_b128 v[52:55], v6 offset:17408
    s_waitcnt lgkmcnt(5)
    v_mfma_f32_32x32x16_bf16 v[96:111], v[56:59], v[152:155], v[96:111]
    ds_read_b128 v[56:59], v6 offset:18432
    s_waitcnt vmcnt(12)
    s_waitcnt lgkmcnt(5)
    v_mfma_f32_32x32x16_bf16 v[64:79], v[60:63], v[156:159], v[64:79]
    ds_read_b128 v[60:63], v6 offset:19456
    s_waitcnt lgkmcnt(5)
    v_mfma_f32_32x32x16_bf16 v[80:95], v[176:179], v[156:159], v[80:95]
    v_add_u32 v6, 81920, v9
    ds_read_b128 v[176:179], v6 offset:0
    s_waitcnt lgkmcnt(5)
    v_mfma_f32_32x32x16_bf16 v[96:111], v[180:183], v[156:159], v[96:111]
    ds_read_b128 v[180:183], v6 offset:1024
    s_waitcnt vmcnt(11)
    s_waitcnt lgkmcnt(5)
    v_mfma_f32_32x32x16_bf16 v[64:79], v[48:51], v[160:163], v[64:79]
    ds_read_b128 v[48:51], v6 offset:2048
    s_waitcnt lgkmcnt(5)
    v_mfma_f32_32x32x16_bf16 v[80:95], v[52:55], v[160:163], v[80:95]
    ds_read_b128 v[52:55], v6 offset:3072
    s_waitcnt lgkmcnt(5)
    v_mfma_f32_32x32x16_bf16 v[96:111], v[56:59], v[160:163], v[96:111]
    ds_read_b128 v[56:59], v6 offset:4096
    s_waitcnt vmcnt(10)
    s_waitcnt lgkmcnt(5)
    v_mfma_f32_32x32x16_bf16 v[64:79], v[60:63], v[164:167], v[64:79]
    ds_read_b128 v[60:63], v6 offset:5120
    s_waitcnt lgkmcnt(5)
    v_mfma_f32_32x32x16_bf16 v[80:95], v[176:179], v[164:167], v[80:95]
    ds_read_b128 v[176:179], v6 offset:6144
    s_waitcnt lgkmcnt(5)
    v_mfma_f32_32x32x16_bf16 v[96:111], v[180:183], v[164:167], v[96:111]
    ds_read_b128 v[180:183], v6 offset:7168
    s_waitcnt vmcnt(9)
    s_waitcnt lgkmcnt(5)
    v_mfma_f32_32x32x16_bf16 v[64:79], v[48:51], v[168:171], v[64:79]
    ds_read_b128 v[48:51], v6 offset:8192
    s_waitcnt lgkmcnt(5)
    v_mfma_f32_32x32x16_bf16 v[80:95], v[52:55], v[168:171], v[80:95]
    ds_read_b128 v[52:55], v6 offset:9216
    s_waitcnt lgkmcnt(5)
    v_mfma_f32_32x32x16_bf16 v[96:111], v[56:59], v[168:171], v[96:111]
    ds_read_b128 v[56:59], v6 offset:10240
    s_waitcnt vmcnt(8)
    s_waitcnt lgkmcnt(5)
    v_mfma_f32_32x32x16_bf16 v[64:79], v[60:63], v[172:175], v[64:79]
    ds_read_b128 v[60:63], v6 offset:11264
    s_waitcnt lgkmcnt(5)
    v_mfma_f32_32x32x16_bf16 v[80:95], v[176:179], v[172:175], v[80:95]
    ds_read_b128 v[176:179], v6 offset:12288
    s_waitcnt lgkmcnt(5)
    v_mfma_f32_32x32x16_bf16 v[96:111], v[180:183], v[172:175], v[96:111]
    ds_read_b128 v[180:183], v6 offset:13312
    s_waitcnt vmcnt(7)
    s_waitcnt lgkmcnt(5)
    v_mfma_f32_32x32x16_bf16 v[64:79], v[48:51], v[128:131], v[64:79]
    ds_read_b128 v[48:51], v6 offset:14336
    s_waitcnt lgkmcnt(5)
    v_mfma_f32_32x32x16_bf16 v[80:95], v[52:55], v[128:131], v[80:95]
    ds_read_b128 v[52:55], v6 offset:15360
    s_waitcnt lgkmcnt(5)
    v_mfma_f32_32x32x16_bf16 v[96:111], v[56:59], v[128:131], v[96:111]
    ds_read_b128 v[56:59], v6 offset:16384
    s_waitcnt vmcnt(6)
    s_waitcnt lgkmcnt(5)
    v_mfma_f32_32x32x16_bf16 v[64:79], v[60:63], v[132:135], v[64:79]
    ds_read_b128 v[60:63], v6 offset:17408
    s_waitcnt lgkmcnt(5)
    v_mfma_f32_32x32x16_bf16 v[80:95], v[176:179], v[132:135], v[80:95]
    ds_read_b128 v[176:179], v6 offset:18432
    s_waitcnt lgkmcnt(5)
    v_mfma_f32_32x32x16_bf16 v[96:111], v[180:183], v[132:135], v[96:111]
    ds_read_b128 v[180:183], v6 offset:19456
    s_waitcnt vmcnt(1)
    s_waitcnt lgkmcnt(5)
    v_mfma_f32_32x32x16_bf16 v[64:79], v[48:51], v[136:139], v[64:79]
    s_waitcnt lgkmcnt(4)
    v_mfma_f32_32x32x16_bf16 v[80:95], v[52:55], v[136:139], v[80:95]
    s_waitcnt lgkmcnt(3)
    v_mfma_f32_32x32x16_bf16 v[96:111], v[56:59], v[136:139], v[96:111]
    s_waitcnt vmcnt(0)
    s_waitcnt lgkmcnt(2)
    v_mfma_f32_32x32x16_bf16 v[64:79], v[60:63], v[140:143], v[64:79]
    s_waitcnt lgkmcnt(1)
    v_mfma_f32_32x32x16_bf16 v[80:95], v[176:179], v[140:143], v[80:95]
    s_waitcnt lgkmcnt(0)
    v_mfma_f32_32x32x16_bf16 v[96:111], v[180:183], v[140:143], v[96:111]
    s_nop 9
    v_pk_mul_f32 v[128:129], v[64:65], v[64:65]
    v_pk_mul_f32 v[130:131], v[66:67], v[66:67]
    v_pk_mul_f32 v[132:133], v[68:69], v[68:69]
    v_pk_mul_f32 v[134:135], v[70:71], v[70:71]
    v_pk_fma_f32 v[128:129], v[128:129], v[22:23], v[20:21] op_sel_hi:[1,0,0]
    v_pk_fma_f32 v[130:131], v[130:131], v[22:23], v[20:21] op_sel_hi:[1,0,0]
    v_pk_fma_f32 v[132:133], v[132:133], v[22:23], v[20:21] op_sel_hi:[1,0,0]
    v_pk_fma_f32 v[134:135], v[134:135], v[22:23], v[20:21] op_sel_hi:[1,0,0]
    v_pk_mul_f32 v[128:129], v[128:129], v[64:65]
    v_pk_mul_f32 v[130:131], v[130:131], v[66:67]
    v_pk_mul_f32 v[132:133], v[132:133], v[68:69]
    v_pk_mul_f32 v[134:135], v[134:135], v[70:71]
    v_exp_f32 v128, v128
    v_exp_f32 v129, v129
    v_exp_f32 v130, v130
    v_exp_f32 v131, v131
    v_exp_f32 v132, v132
    v_exp_f32 v133, v133
    v_exp_f32 v134, v134
    v_exp_f32 v135, v135
    v_pk_fma_f32 v[128:129], v[128:129], v[24:25], v[24:25] op_sel_hi:[1,0,0]
    v_pk_fma_f32 v[130:131], v[130:131], v[24:25], v[24:25] op_sel_hi:[1,0,0]
    v_pk_fma_f32 v[132:133], v[132:133], v[24:25], v[24:25] op_sel_hi:[1,0,0]
    v_pk_fma_f32 v[134:135], v[134:135], v[24:25], v[24:25] op_sel_hi:[1,0,0]
    v_rcp_f32 v128, v128
    v_rcp_f32 v129, v129
    v_rcp_f32 v130, v130
    v_rcp_f32 v131, v131
    v_rcp_f32 v132, v132
    v_rcp_f32 v133, v133
    v_rcp_f32 v134, v134
    v_rcp_f32 v135, v135
    v_pk_mul_f32 v[128:129], v[128:129], v[64:65]
    v_pk_mul_f32 v[130:131], v[130:131], v[66:67]
    v_pk_mul_f32 v[132:133], v[132:133], v[68:69]
    v_pk_mul_f32 v[134:135], v[134:135], v[70:71]
    v_cvt_pk_bf16_f32 v64, v128, v129
    v_cvt_pk_bf16_f32 v65, v130, v131
    v_cvt_pk_bf16_f32 v66, v132, v133
    v_cvt_pk_bf16_f32 v67, v134, v135
    v_pk_mul_f32 v[136:137], v[72:73], v[72:73]
    v_pk_mul_f32 v[138:139], v[74:75], v[74:75]
    v_pk_mul_f32 v[140:141], v[76:77], v[76:77]
    v_pk_mul_f32 v[142:143], v[78:79], v[78:79]
    v_pk_fma_f32 v[136:137], v[136:137], v[22:23], v[20:21] op_sel_hi:[1,0,0]
    v_pk_fma_f32 v[138:139], v[138:139], v[22:23], v[20:21] op_sel_hi:[1,0,0]
    v_pk_fma_f32 v[140:141], v[140:141], v[22:23], v[20:21] op_sel_hi:[1,0,0]
    v_pk_fma_f32 v[142:143], v[142:143], v[22:23], v[20:21] op_sel_hi:[1,0,0]
    v_pk_mul_f32 v[136:137], v[136:137], v[72:73]
    v_pk_mul_f32 v[138:139], v[138:139], v[74:75]
    v_pk_mul_f32 v[140:141], v[140:141], v[76:77]
    v_pk_mul_f32 v[142:143], v[142:143], v[78:79]
    v_exp_f32 v136, v136
    v_exp_f32 v137, v137
    v_exp_f32 v138, v138
    v_exp_f32 v139, v139
    v_exp_f32 v140, v140
    v_exp_f32 v141, v141
    v_exp_f32 v142, v142
    v_exp_f32 v143, v143
    v_pk_fma_f32 v[136:137], v[136:137], v[24:25], v[24:25] op_sel_hi:[1,0,0]
    v_pk_fma_f32 v[138:139], v[138:139], v[24:25], v[24:25] op_sel_hi:[1,0,0]
    v_pk_fma_f32 v[140:141], v[140:141], v[24:25], v[24:25] op_sel_hi:[1,0,0]
    v_pk_fma_f32 v[142:143], v[142:143], v[24:25], v[24:25] op_sel_hi:[1,0,0]
    v_rcp_f32 v136, v136
    v_rcp_f32 v137, v137
    v_rcp_f32 v138, v138
    v_rcp_f32 v139, v139
    v_rcp_f32 v140, v140
    v_rcp_f32 v141, v141
    v_rcp_f32 v142, v142
    v_rcp_f32 v143, v143
    v_pk_mul_f32 v[136:137], v[136:137], v[72:73]
    v_pk_mul_f32 v[138:139], v[138:139], v[74:75]
    v_pk_mul_f32 v[140:141], v[140:141], v[76:77]
    v_pk_mul_f32 v[142:143], v[142:143], v[78:79]
    v_cvt_pk_bf16_f32 v72, v136, v137
    v_cvt_pk_bf16_f32 v73, v138, v139
    v_cvt_pk_bf16_f32 v74, v140, v141
    v_cvt_pk_bf16_f32 v75, v142, v143
    v_pk_mul_f32 v[128:129], v[80:81], v[80:81]
    v_pk_mul_f32 v[130:131], v[82:83], v[82:83]
    v_pk_mul_f32 v[132:133], v[84:85], v[84:85]
    v_pk_mul_f32 v[134:135], v[86:87], v[86:87]
    v_pk_fma_f32 v[128:129], v[128:129], v[22:23], v[20:21] op_sel_hi:[1,0,0]
    v_pk_fma_f32 v[130:131], v[130:131], v[22:23], v[20:21] op_sel_hi:[1,0,0]
    v_pk_fma_f32 v[132:133], v[132:133], v[22:23], v[20:21] op_sel_hi:[1,0,0]
    v_pk_fma_f32 v[134:135], v[134:135], v[22:23], v[20:21] op_sel_hi:[1,0,0]
    v_pk_mul_f32 v[128:129], v[128:129], v[80:81]
    v_pk_mul_f32 v[130:131], v[130:131], v[82:83]
    v_pk_mul_f32 v[132:133], v[132:133], v[84:85]
    v_pk_mul_f32 v[134:135], v[134:135], v[86:87]
    v_exp_f32 v128, v128
    v_exp_f32 v129, v129
    v_exp_f32 v130, v130
    v_exp_f32 v131, v131
    v_exp_f32 v132, v132
    v_exp_f32 v133, v133
    v_exp_f32 v134, v134
    v_exp_f32 v135, v135
    v_pk_fma_f32 v[128:129], v[128:129], v[24:25], v[24:25] op_sel_hi:[1,0,0]
    v_pk_fma_f32 v[130:131], v[130:131], v[24:25], v[24:25] op_sel_hi:[1,0,0]
    v_pk_fma_f32 v[132:133], v[132:133], v[24:25], v[24:25] op_sel_hi:[1,0,0]
    v_pk_fma_f32 v[134:135], v[134:135], v[24:25], v[24:25] op_sel_hi:[1,0,0]
    v_rcp_f32 v128, v128
    v_rcp_f32 v129, v129
    v_rcp_f32 v130, v130
    v_rcp_f32 v131, v131
    v_rcp_f32 v132, v132
    v_rcp_f32 v133, v133
    v_rcp_f32 v134, v134
    v_rcp_f32 v135, v135
    v_pk_mul_f32 v[128:129], v[128:129], v[80:81]
    v_pk_mul_f32 v[130:131], v[130:131], v[82:83]
    v_pk_mul_f32 v[132:133], v[132:133], v[84:85]
    v_pk_mul_f32 v[134:135], v[134:135], v[86:87]
    v_cvt_pk_bf16_f32 v80, v128, v129
    v_cvt_pk_bf16_f32 v81, v130, v131
    v_cvt_pk_bf16_f32 v82, v132, v133
    v_cvt_pk_bf16_f32 v83, v134, v135
    v_pk_mul_f32 v[136:137], v[88:89], v[88:89]
    v_pk_mul_f32 v[138:139], v[90:91], v[90:91]
    v_pk_mul_f32 v[140:141], v[92:93], v[92:93]
    v_pk_mul_f32 v[142:143], v[94:95], v[94:95]
    v_pk_fma_f32 v[136:137], v[136:137], v[22:23], v[20:21] op_sel_hi:[1,0,0]
    v_pk_fma_f32 v[138:139], v[138:139], v[22:23], v[20:21] op_sel_hi:[1,0,0]
    v_pk_fma_f32 v[140:141], v[140:141], v[22:23], v[20:21] op_sel_hi:[1,0,0]
    v_pk_fma_f32 v[142:143], v[142:143], v[22:23], v[20:21] op_sel_hi:[1,0,0]
    v_pk_mul_f32 v[136:137], v[136:137], v[88:89]
    v_pk_mul_f32 v[138:139], v[138:139], v[90:91]
    v_pk_mul_f32 v[140:141], v[140:141], v[92:93]
    v_pk_mul_f32 v[142:143], v[142:143], v[94:95]
    v_exp_f32 v136, v136
    v_exp_f32 v137, v137
    v_exp_f32 v138, v138
    v_exp_f32 v139, v139
    v_exp_f32 v140, v140
    v_exp_f32 v141, v141
    v_exp_f32 v142, v142
    v_exp_f32 v143, v143
    v_pk_fma_f32 v[136:137], v[136:137], v[24:25], v[24:25] op_sel_hi:[1,0,0]
    v_pk_fma_f32 v[138:139], v[138:139], v[24:25], v[24:25] op_sel_hi:[1,0,0]
    v_pk_fma_f32 v[140:141], v[140:141], v[24:25], v[24:25] op_sel_hi:[1,0,0]
    v_pk_fma_f32 v[142:143], v[142:143], v[24:25], v[24:25] op_sel_hi:[1,0,0]
    v_rcp_f32 v136, v136
    v_rcp_f32 v137, v137
    v_rcp_f32 v138, v138
    v_rcp_f32 v139, v139
    v_rcp_f32 v140, v140
    v_rcp_f32 v141, v141
    v_rcp_f32 v142, v142
    v_rcp_f32 v143, v143
    v_pk_mul_f32 v[136:137], v[136:137], v[88:89]
    v_pk_mul_f32 v[138:139], v[138:139], v[90:91]
    v_pk_mul_f32 v[140:141], v[140:141], v[92:93]
    v_pk_mul_f32 v[142:143], v[142:143], v[94:95]
    v_cvt_pk_bf16_f32 v88, v136, v137
    v_cvt_pk_bf16_f32 v89, v138, v139
    v_cvt_pk_bf16_f32 v90, v140, v141
    v_cvt_pk_bf16_f32 v91, v142, v143
    buffer_store_dwordx4 v[64:67], v2, s[4:7], s84 offen offset:0
    buffer_store_dwordx4 v[72:75], v2, s[4:7], s84 offen offset:1024
    buffer_store_dwordx4 v[80:83], v2, s[4:7], s84 offen offset:2048
    buffer_store_dwordx4 v[88:91], v2, s[4:7], s84 offen offset:3072
    v_pk_mul_f32 v[128:129], v[96:97], v[96:97]
    v_pk_mul_f32 v[130:131], v[98:99], v[98:99]
    v_pk_mul_f32 v[132:133], v[100:101], v[100:101]
    v_pk_mul_f32 v[134:135], v[102:103], v[102:103]
    v_pk_fma_f32 v[128:129], v[128:129], v[22:23], v[20:21] op_sel_hi:[1,0,0]
    v_pk_fma_f32 v[130:131], v[130:131], v[22:23], v[20:21] op_sel_hi:[1,0,0]
    v_pk_fma_f32 v[132:133], v[132:133], v[22:23], v[20:21] op_sel_hi:[1,0,0]
    v_pk_fma_f32 v[134:135], v[134:135], v[22:23], v[20:21] op_sel_hi:[1,0,0]
    v_pk_mul_f32 v[128:129], v[128:129], v[96:97]
    v_pk_mul_f32 v[130:131], v[130:131], v[98:99]
    v_pk_mul_f32 v[132:133], v[132:133], v[100:101]
    v_pk_mul_f32 v[134:135], v[134:135], v[102:103]
    v_exp_f32 v128, v128
    v_exp_f32 v129, v129
    v_exp_f32 v130, v130
    v_exp_f32 v131, v131
    v_exp_f32 v132, v132
    v_exp_f32 v133, v133
    v_exp_f32 v134, v134
    v_exp_f32 v135, v135
    v_pk_fma_f32 v[128:129], v[128:129], v[24:25], v[24:25] op_sel_hi:[1,0,0]
    v_pk_fma_f32 v[130:131], v[130:131], v[24:25], v[24:25] op_sel_hi:[1,0,0]
    v_pk_fma_f32 v[132:133], v[132:133], v[24:25], v[24:25] op_sel_hi:[1,0,0]
    v_pk_fma_f32 v[134:135], v[134:135], v[24:25], v[24:25] op_sel_hi:[1,0,0]
    v_rcp_f32 v128, v128
    v_rcp_f32 v129, v129
    v_rcp_f32 v130, v130
    v_rcp_f32 v131, v131
    v_rcp_f32 v132, v132
    v_rcp_f32 v133, v133
    v_rcp_f32 v134, v134
    v_rcp_f32 v135, v135
    v_pk_mul_f32 v[128:129], v[128:129], v[96:97]
    v_pk_mul_f32 v[130:131], v[130:131], v[98:99]
    v_pk_mul_f32 v[132:133], v[132:133], v[100:101]
    v_pk_mul_f32 v[134:135], v[134:135], v[102:103]
    v_cvt_pk_bf16_f32 v96, v128, v129
    v_cvt_pk_bf16_f32 v97, v130, v131
    v_cvt_pk_bf16_f32 v98, v132, v133
    v_cvt_pk_bf16_f32 v99, v134, v135
    buffer_store_dwordx4 v[96:99], v2, s[4:7], s85 offen offset:0
    v_pk_mul_f32 v[136:137], v[104:105], v[104:105]
    v_pk_mul_f32 v[138:139], v[106:107], v[106:107]
    v_pk_mul_f32 v[140:141], v[108:109], v[108:109]
    v_pk_mul_f32 v[142:143], v[110:111], v[110:111]
    v_pk_fma_f32 v[136:137], v[136:137], v[22:23], v[20:21] op_sel_hi:[1,0,0]
    v_pk_fma_f32 v[138:139], v[138:139], v[22:23], v[20:21] op_sel_hi:[1,0,0]
    v_pk_fma_f32 v[140:141], v[140:141], v[22:23], v[20:21] op_sel_hi:[1,0,0]
    v_pk_fma_f32 v[142:143], v[142:143], v[22:23], v[20:21] op_sel_hi:[1,0,0]
    v_pk_mul_f32 v[136:137], v[136:137], v[104:105]
    v_pk_mul_f32 v[138:139], v[138:139], v[106:107]
    v_pk_mul_f32 v[140:141], v[140:141], v[108:109]
    v_pk_mul_f32 v[142:143], v[142:143], v[110:111]
    v_exp_f32 v136, v136
    v_exp_f32 v137, v137
    v_exp_f32 v138, v138
    v_exp_f32 v139, v139
    v_exp_f32 v140, v140
    v_exp_f32 v141, v141
    v_exp_f32 v142, v142
    v_exp_f32 v143, v143
    v_pk_fma_f32 v[136:137], v[136:137], v[24:25], v[24:25] op_sel_hi:[1,0,0]
    v_pk_fma_f32 v[138:139], v[138:139], v[24:25], v[24:25] op_sel_hi:[1,0,0]
    v_pk_fma_f32 v[140:141], v[140:141], v[24:25], v[24:25] op_sel_hi:[1,0,0]
    v_pk_fma_f32 v[142:143], v[142:143], v[24:25], v[24:25] op_sel_hi:[1,0,0]
    v_rcp_f32 v136, v136
    v_rcp_f32 v137, v137
    v_rcp_f32 v138, v138
    v_rcp_f32 v139, v139
    v_rcp_f32 v140, v140
    v_rcp_f32 v141, v141
    v_rcp_f32 v142, v142
    v_rcp_f32 v143, v143
    v_pk_mul_f32 v[136:137], v[136:137], v[104:105]
    v_pk_mul_f32 v[138:139], v[138:139], v[106:107]
    v_pk_mul_f32 v[140:141], v[140:141], v[108:109]
    v_pk_mul_f32 v[142:143], v[142:143], v[110:111]
    v_cvt_pk_bf16_f32 v104, v136, v137
    v_cvt_pk_bf16_f32 v105, v138, v139
    v_cvt_pk_bf16_f32 v106, v140, v141
    v_cvt_pk_bf16_f32 v107, v142, v143
    buffer_store_dwordx4 v[104:107], v2, s[4:7], s85 offen offset:1024
    s_lshl_b32 s55, s40, 7
    s_add_u32 s55, s55, s23
    s_lshl2_add_u32 s55, s36, s55
    v_mov_b32 v13, 1
    s_cmp_lg_u32 s19, 0
    s_cbranch_scc1 L_pubslow_94
    s_mov_b64 exec, 1
    s_waitcnt vmcnt(0)
    buffer_store_dword v13, v2, s[4:7], s55 offen offset:2048
L_pubdone_95:
    s_mov_b64 exec, -1
    s_lshl_b32 s40, s35, 1
    s_add_u32 s40, s40, s39
    v_and_b32 v12, 15, v1
    s_lshl_b32 s50, s38, 4
    v_lshrrev_b32 v13, 4, v1
    v_add_u32 v12, s50, v12
    v_lshlrev_b32 v22, 4, v12
    v_lshl_add_u32 v10, v13, 9, v22
    v_lshl_add_u32 v22, v5, 9, v22
    s_mul_i32 s50, s38, 10240
    v_add_u32 v9, s50, v2
    v_xor_b32 v11, 256, v10
    s_barrier
    v_add_u32 v6, 102400, v9
    ds_read_b128 v[48:51], v6 offset:0
    ds_read_b128 v[52:55], v6 offset:1024
    ds_read_b128 v[56:59], v6 offset:2048
    ds_read_b128 v[60:63], v6 offset:3072
    ds_read_b128 v[112:115], v6 offset:4096
    ds_read_b128 v[116:119], v6 offset:5120
    ds_read_b128 v[120:123], v6 offset:6144
    ds_read_b128 v[124:127], v6 offset:7168
    ds_read_b128 v[192:195], v6 offset:8192
    ds_read_b128 v[196:199], v6 offset:9216
    s_mul_i32 s56, s40, 98304
    s_add_u32 s56, s56, s32
    s_lshl_b32 s50, s38, 12
    s_add_u32 s56, s56, s50
    s_lshl_b32 s50, s40, 7
    s_add_u32 s50, s50, s23
    v_lshrrev_b32 v12, 2, v2
    s_mov_b32 s51, 0x100000
    s_mov_b64 exec, 0xffff
L_poll_96:
    buffer_load_dword v13, v12, s[4:7], s50 offen offset:2048 sc1
    s_sub_u32 s51, s51, 1
    s_cbranch_scc1 L_polld_97
    s_waitcnt vmcnt(0)
    v_cmp_eq_u32 vcc, 0, v13
    s_cbranch_vccnz L_poll_96
L_polld_97:
    s_mov_b64 exec, -1
    s_cmp_lg_u32 s19, 0
    s_cbranch_scc1 L_ool_98
L_back_99:
    s_add_u32 s53, s56, 0
    buffer_load_dwordx4 v[64:67], v10, s[4:7], s53 offen offset:0 sc1
    buffer_load_dwordx4 v[68:71], v11, s[4:7], s53 offen offset:0 sc1
    buffer_load_dwordx4 v[72:75], v10, s[4:7], s53 offen offset:2048 sc1
    buffer_load_dwordx4 v[76:79], v11, s[4:7], s53 offen offset:2048 sc1
    s_add_u32 s53, s56, 8192
    buffer_load_dwordx4 v[80:83], v10, s[4:7], s53 offen offset:0 sc1
    buffer_load_dwordx4 v[84:87], v11, s[4:7], s53 offen offset:0 sc1
    buffer_load_dwordx4 v[88:91], v10, s[4:7], s53 offen offset:2048 sc1
    buffer_load_dwordx4 v[92:95], v11, s[4:7], s53 offen offset:2048 sc1
    s_mul_i32 s50, s16, 5120
    s_add_u32 s50, s50, 143360
    v_add_u32 v20, s50, v2
    s_xor_b32 s50, s16, 2
    s_mul_i32 s50, s50, 5120
    s_add_u32 s50, s50, 143360
    v_add_u32 v21, s50, v2
    v_bfe_u32 v12, v1, 4, 1
    v_lshlrev_b32 v13, 30, v12
    v_add_u32 v35, v13, v22
    v_lshl_add_u32 v22, v12, 3, v22
    s_mul_i32 s84, s40, 40960
    s_add_u32 s84, s84, s27
    s_mul_i32 s86, s40, 4096
    s_add_u32 s86, s86, s26
    s_mul_i32 s50, s34, 5120
    s_add_u32 s84, s84, s50
    s_add_u32 s85, s84, 4096
    s_lshl1_add_u32 s87, s34, s38
    s_lshr_b32 s50, s34, 2
    s_lshl_b32 s50, s50, 10
    s_add_u32 s86, s86, s50
    s_and_b32 s50, s34, 3
    s_lshl2_add_u32 s86, s50, s86
    v_and_b32 v12, 15, v1
    s_lshl_b32 s50, s38, 4
    v_add_u32 v12, s50, v12
    v_mul_u32_u24 v12, 1280, v12
    v_lshrrev_b32 v13, 4, v1
    v_lshl_add_u32 v23, v13, 4, v12
    v_lshl_add_u32 v34, v13, 3, v12
    s_lshl3_add_u32 s88, s17, s40
    s_mul_i32 s88, s88, 40960
    s_mul_i32 s50, s34, 160
    s_add_u32 s88, s88, s50
    s_waitcnt vmcnt(7) lgkmcnt(9)
    v_mfma_f32_16x16x32_bf16 v[208:211], v[48:51], v[64:67], v[208:211]
    s_waitcnt vmcnt(6)
    v_mfma_f32_16x16x32_bf16 v[228:231], v[48:51], v[68:71], 0
    v_add_u32 v6, 122880, v9
    ds_read_b128 v[48:51], v6 offset:0
    s_waitcnt lgkmcnt(9)
    v_mfma_f32_16x16x32_bf16 v[212:215], v[52:55], v[64:67], v[212:215]
    s_add_u32 s53, s56, 16384
    buffer_load_dwordx4 v[96:99], v10, s[4:7], s53 offen offset:0 sc1
    v_mfma_f32_16x16x32_bf16 v[232:235], v[52:55], v[68:71], 0
    ds_read_b128 v[52:55], v6 offset:1024
    s_waitcnt lgkmcnt(9)
    v_mfma_f32_16x16x32_bf16 v[216:219], v[56:59], v[64:67], v[216:219]
    v_mfma_f32_16x16x32_bf16 v[236:239], v[56:59], v[68:71], 0
    ds_read_b128 v[56:59], v6 offset:2048
    s_waitcnt lgkmcnt(9)
    v_mfma_f32_16x16x32_bf16 v[220:223], v[60:63], v[64:67], v[220:223]
    buffer_load_dwordx4 v[100:103], v11, s[4:7], s53 offen offset:0 sc1
    v_mfma_f32_16x16x32_bf16 v[240:243], v[60:63], v[68:71], 0
    ds_read_b128 v[60:63], v6 offset:3072
    s_waitcnt lgkmcnt(9)
    v_mfma_f32_16x16x32_bf16 v[224:227], v[112:115], v[64:67], v[224:227]
    v_mfma_f32_16x16x32_bf16 v[244:247], v[112:115], v[68:71], 0
    ds_read_b128 v[112:115], v6 offset:4096
    s_waitcnt vmcnt(7) lgkmcnt(9)
    v_mfma_f32_16x16x32_bf16 v[208:211], v[116:119], v[72:75], v[208:211]
    s_waitcnt vmcnt(6)
    v_mfma_f32_16x16x32_bf16 v[228:231], v[116:119], v[76:79], v[228:231]
    ds_read_b128 v[116:119], v6 offset:5120
    s_waitcnt lgkmcnt(9)
    v_mfma_f32_16x16x32_bf16 v[212:215], v[120:123], v[72:75], v[212:215]
    buffer_load_dwordx4 v[104:107], v10, s[4:7], s53 offen offset:2048 sc1
    v_mfma_f32_16x16x32_bf16 v[232:235], v[120:123], v[76:79], v[232:235]
    ds_read_b128 v[120:123], v6 offset:6144
    s_waitcnt lgkmcnt(9)
    v_mfma_f32_16x16x32_bf16 v[216:219], v[124:127], v[72:75], v[216:219]
    buffer_load_dwordx4 v[108:111], v11, s[4:7], s53 offen offset:2048 sc1
    v_mfma_f32_16x16x32_bf16 v[236:239], v[124:127], v[76:79], v[236:239]
    ds_read_b128 v[124:127], v6 offset:7168
    s_waitcnt lgkmcnt(9)
    v_mfma_f32_16x16x32_bf16 v[220:223], v[192:195], v[72:75], v[220:223]
    s_add_u32 s53, s56, 24576
    buffer_load_dwordx4 v[64:67], v10, s[4:7], s53 offen offset:0 sc1
    v_mfma_f32_16x16x32_bf16 v[240:243], v[192:195], v[76:79], v[240:243]
    ds_read_b128 v[192:195], v6 offset:8192
    s_waitcnt lgkmcnt(9)
    v_mfma_f32_16x16x32_bf16 v[224:227], v[196:199], v[72:75], v[224:227]
    v_mfma_f32_16x16x32_bf16 v[244:247], v[196:199], v[76:79], v[244:247]
    ds_read_b128 v[196:199], v6 offset:9216
    s_waitcnt vmcnt(8) lgkmcnt(9)
    v_mfma_f32_16x16x32_bf16 v[208:211], v[48:51], v[80:83], v[208:211]
    s_waitcnt vmcnt(7)
    v_mfma_f32_16x16x32_bf16 v[228:231], v[48:51], v[84:87], v[228:231]
    v_add_u32 v6, 0, v9
    ds_read_b128 v[48:51], v6 offset:0
    s_waitcnt lgkmcnt(9)
    v_mfma_f32_16x16x32_bf16 v[212:215], v[52:55], v[80:83], v[212:215]
    buffer_load_dwordx4 v[68:71], v11, s[4:7], s53 offen offset:0 sc1
    v_mfma_f32_16x16x32_bf16 v[232:235], v[52:55], v[84:87], v[232:235]
    ds_read_b128 v[52:55], v6 offset:1024
    s_waitcnt lgkmcnt(9)
    v_mfma_f32_16x16x32_bf16 v[216:219], v[56:59], v[80:83], v[216:219]
    v_mfma_f32_16x16x32_bf16 v[236:239], v[56:59], v[84:87], v[236:239]
    ds_read_b128 v[56:59], v6 offset:2048
    s_waitcnt lgkmcnt(9)
    v_mfma_f32_16x16x32_bf16 v[220:223], v[60:63], v[80:83], v[220:223]
    buffer_load_dwordx4 v[72:75], v10, s[4:7], s53 offen offset:2048 sc1
    v_mfma_f32_16x16x32_bf16 v[240:243], v[60:63], v[84:87], v[240:243]
    ds_read_b128 v[60:63], v6 offset:3072
    s_waitcnt lgkmcnt(9)
    v_mfma_f32_16x16x32_bf16 v[224:227], v[112:115], v[80:83], v[224:227]
    v_mfma_f32_16x16x32_bf16 v[244:247], v[112:115], v[84:87], v[244:247]
    ds_read_b128 v[112:115], v6 offset:4096
    s_waitcnt vmcnt(8) lgkmcnt(9)
    v_mfma_f32_16x16x32_bf16 v[208:211], v[116:119], v[88:91], v[208:211]
    s_waitcnt vmcnt(7)
    v_mfma_f32_16x16x32_bf16 v[228:231], v[116:119], v[92:95], v[228:231]
    ds_read_b128 v[116:119], v6 offset:5120
    s_waitcnt lgkmcnt(9)
    v_mfma_f32_16x16x32_bf16 v[212:215], v[120:123], v[88:91], v[212:215]
    buffer_load_dwordx4 v[76:79], v11, s[4:7], s53 offen offset:2048 sc1
    v_mfma_f32_16x16x32_bf16 v[232:235], v[120:123], v[92:95], v[232:235]
    ds_read_b128 v[120:123], v6 offset:6144
    s_waitcnt lgkmcnt(9)
    v_mfma_f32_16x16x32_bf16 v[216:219], v[124:127], v[88:91], v[216:219]
    s_add_u32 s53, s56, 32768
    buffer_load_dwordx4 v[80:83], v10, s[4:7], s53 offen offset:0 sc1
    v_mfma_f32_16x16x32_bf16 v[236:239], v[124:127], v[92:95], v[236:239]
    ds_read_b128 v[124:127], v6 offset:7168
    s_waitcnt lgkmcnt(9)
    v_mfma_f32_16x16x32_bf16 v[220:223], v[192:195], v[88:91], v[220:223]
    buffer_load_dwordx4 v[84:87], v11, s[4:7], s53 offen offset:0 sc1
    v_mfma_f32_16x16x32_bf16 v[240:243], v[192:195], v[92:95], v[240:243]
    ds_read_b128 v[192:195], v6 offset:8192
    s_waitcnt lgkmcnt(9)
    v_mfma_f32_16x16x32_bf16 v[224:227], v[196:199], v[88:91], v[224:227]
    v_mfma_f32_16x16x32_bf16 v[244:247], v[196:199], v[92:95], v[244:247]
    ds_read_b128 v[196:199], v6 offset:9216
    s_waitcnt vmcnt(9) lgkmcnt(9)
    v_mfma_f32_16x16x32_bf16 v[208:211], v[48:51], v[96:99], v[208:211]
    s_waitcnt vmcnt(8)
    v_mfma_f32_16x16x32_bf16 v[228:231], v[48:51], v[100:103], v[228:231]
    s_barrier
    v_add_u32 v6, 20480, v9
    ds_read_b128 v[48:51], v6 offset:0
    s_waitcnt lgkmcnt(9)
    v_mfma_f32_16x16x32_bf16 v[212:215], v[52:55], v[96:99], v[212:215]
    buffer_load_dwordx4 v[88:91], v10, s[4:7], s53 offen offset:2048 sc1
    v_mfma_f32_16x16x32_bf16 v[232:235], v[52:55], v[100:103], v[232:235]
    ds_read_b128 v[52:55], v6 offset:1024
    s_waitcnt lgkmcnt(9)
    v_mfma_f32_16x16x32_bf16 v[216:219], v[56:59], v[96:99], v[216:219]
    v_mfma_f32_16x16x32_bf16 v[236:239], v[56:59], v[100:103], v[236:239]
    ds_read_b128 v[56:59], v6 offset:2048
    s_waitcnt lgkmcnt(9)
    v_mfma_f32_16x16x32_bf16 v[220:223], v[60:63], v[96:99], v[220:223]
    buffer_load_dwordx4 v[92:95], v11, s[4:7], s53 offen offset:2048 sc1
    v_mfma_f32_16x16x32_bf16 v[240:243], v[60:63], v[100:103], v[240:243]
    ds_read_b128 v[60:63], v6 offset:3072
    s_waitcnt lgkmcnt(9)
    v_mfma_f32_16x16x32_bf16 v[224:227], v[112:115], v[96:99], v[224:227]
    v_mfma_f32_16x16x32_bf16 v[244:247], v[112:115], v[100:103], v[244:247]
    ds_read_b128 v[112:115], v6 offset:4096
    s_waitcnt vmcnt(9) lgkmcnt(9)
    v_mfma_f32_16x16x32_bf16 v[208:211], v[116:119], v[104:107], v[208:211]
    s_waitcnt vmcnt(8)
    v_mfma_f32_16x16x32_bf16 v[228:231], v[116:119], v[108:111], v[228:231]
    ds_read_b128 v[116:119], v6 offset:5120
    s_waitcnt lgkmcnt(9)
    v_mfma_f32_16x16x32_bf16 v[212:215], v[120:123], v[104:107], v[212:215]
    s_add_u32 s53, s56, 40960
    buffer_load_dwordx4 v[96:99], v10, s[4:7], s53 offen offset:0 sc1
    v_mfma_f32_16x16x32_bf16 v[232:235], v[120:123], v[108:111], v[232:235]
    ds_read_b128 v[120:123], v6 offset:6144
    s_waitcnt lgkmcnt(9)
    v_mfma_f32_16x16x32_bf16 v[216:219], v[124:127], v[104:107], v[216:219]
    buffer_load_dwordx4 v[100:103], v11, s[4:7], s53 offen offset:0 sc1
    v_mfma_f32_16x16x32_bf16 v[236:239], v[124:127], v[108:111], v[236:239]
    ds_read_b128 v[124:127], v6 offset:7168
    s_waitcnt lgkmcnt(9)
    v_mfma_f32_16x16x32_bf16 v[220:223], v[192:195], v[104:107], v[220:223]
    v_mfma_f32_16x16x32_bf16 v[240:243], v[192:195], v[108:111], v[240:243]
    ds_read_b128 v[192:195], v6 offset:8192
    s_waitcnt lgkmcnt(9)
    v_mfma_f32_16x16x32_bf16 v[224:227], v[196:199], v[104:107], v[224:227]
    v_mfma_f32_16x16x32_bf16 v[244:247], v[196:199], v[108:111], v[244:247]
    ds_read_b128 v[196:199], v6 offset:9216
    s_waitcnt vmcnt(9) lgkmcnt(9)
    v_mfma_f32_16x16x32_bf16 v[208:211], v[48:51], v[64:67], v[208:211]
    s_waitcnt vmcnt(8)
    v_mfma_f32_16x16x32_bf16 v[228:231], v[48:51], v[68:71], v[228:231]
    v_add_u32 v6, 40960, v9
    ds_read_b128 v[48:51], v6 offset:0
    s_waitcnt lgkmcnt(9)
    v_mfma_f32_16x16x32_bf16 v[212:215], v[52:55], v[64:67], v[212:215]
    buffer_load_dwordx4 v[104:107], v10, s[4:7], s53 offen offset:2048 sc1
    v_mfma_f32_16x16x32_bf16 v[232:235], v[52:55], v[68:71], v[232:235]
    ds_read_b128 v[52:55], v6 offset:1024
    s_waitcnt lgkmcnt(9)
    v_mfma_f32_16x16x32_bf16 v[216:219], v[56:59], v[64:67], v[216:219]
    v_mfma_f32_16x16x32_bf16 v[236:239], v[56:59], v[68:71], v[236:239]
    ds_read_b128 v[56:59], v6 offset:2048
    s_waitcnt lgkmcnt(9)
    v_mfma_f32_16x16x32_bf16 v[220:223], v[60:63], v[64:67], v[220:223]
    buffer_load_dwordx4 v[108:111], v11, s[4:7], s53 offen offset:2048 sc1
    v_mfma_f32_16x16x32_bf16 v[240:243], v[60:63], v[68:71], v[240:243]
    ds_read_b128 v[60:63], v6 offset:3072
    s_waitcnt lgkmcnt(9)
    v_mfma_f32_16x16x32_bf16 v[224:227], v[112:115], v[64:67], v[224:227]
    v_mfma_f32_16x16x32_bf16 v[244:247], v[112:115], v[68:71], v[244:247]
    ds_read_b128 v[112:115], v6 offset:4096
    s_waitcnt vmcnt(9) lgkmcnt(9)
    v_mfma_f32_16x16x32_bf16 v[208:211], v[116:119], v[72:75], v[208:211]
    s_waitcnt vmcnt(8)
    v_mfma_f32_16x16x32_bf16 v[228:231], v[116:119], v[76:79], v[228:231]
    ds_read_b128 v[116:119], v6 offset:5120
    s_waitcnt lgkmcnt(9)
    v_mfma_f32_16x16x32_bf16 v[212:215], v[120:123], v[72:75], v[212:215]
    s_add_u32 s53, s56, 49152
    buffer_load_dwordx4 v[64:67], v10, s[4:7], s53 offen offset:0 sc1
    v_mfma_f32_16x16x32_bf16 v[232:235], v[120:123], v[76:79], v[232:235]
    ds_read_b128 v[120:123], v6 offset:6144
    s_waitcnt lgkmcnt(9)
    v_mfma_f32_16x16x32_bf16 v[216:219], v[124:127], v[72:75], v[216:219]
    buffer_load_dwordx4 v[68:71], v11, s[4:7], s53 offen offset:0 sc1
    v_mfma_f32_16x16x32_bf16 v[236:239], v[124:127], v[76:79], v[236:239]
    ds_read_b128 v[124:127], v6 offset:7168
    s_waitcnt lgkmcnt(9)
    v_mfma_f32_16x16x32_bf16 v[220:223], v[192:195], v[72:75], v[220:223]
    v_mfma_f32_16x16x32_bf16 v[240:243], v[192:195], v[76:79], v[240:243]
    ds_read_b128 v[192:195], v6 offset:8192
    s_waitcnt lgkmcnt(9)
    v_mfma_f32_16x16x32_bf16 v[224:227], v[196:199], v[72:75], v[224:227]
    v_mfma_f32_16x16x32_bf16 v[244:247], v[196:199], v[76:79], v[244:247]
    ds_read_b128 v[196:199], v6 offset:9216
    s_waitcnt vmcnt(9) lgkmcnt(9)
    v_mfma_f32_16x16x32_bf16 v[208:211], v[48:51], v[80:83], v[208:211]
    s_waitcnt vmcnt(8)
    v_mfma_f32_16x16x32_bf16 v[228:231], v[48:51], v[84:87], v[228:231]
    s_barrier
    v_add_u32 v6, 61440, v9
    ds_read_b128 v[48:51], v6 offset:0
    s_waitcnt lgkmcnt(9)
    v_mfma_f32_16x16x32_bf16 v[212:215], v[52:55], v[80:83], v[212:215]
    buffer_load_dwordx4 v[72:75], v10, s[4:7], s53 offen offset:2048 sc1
    v_mfma_f32_16x16x32_bf16 v[232:235], v[52:55], v[84:87], v[232:235]
    ds_read_b128 v[52:55], v6 offset:1024
    s_waitcnt lgkmcnt(9)
    v_mfma_f32_16x16x32_bf16 v[216:219], v[56:59], v[80:83], v[216:219]
    v_mfma_f32_16x16x32_bf16 v[236:239], v[56:59], v[84:87], v[236:239]
    ds_read_b128 v[56:59], v6 offset:2048
    s_waitcnt lgkmcnt(9)
    v_mfma_f32_16x16x32_bf16 v[220:223], v[60:63], v[80:83], v[220:223]
    buffer_load_dwordx4 v[76:79], v11, s[4:7], s53 offen offset:2048 sc1
    v_mfma_f32_16x16x32_bf16 v[240:243], v[60:63], v[84:87], v[240:243]
    ds_read_b128 v[60:63], v6 offset:3072
    s_waitcnt lgkmcnt(9)
    v_mfma_f32_16x16x32_bf16 v[224:227], v[112:115], v[80:83], v[224:227]
    v_mfma_f32_16x16x32_bf16 v[244:247], v[112:115], v[84:87], v[244:247]
    ds_read_b128 v[112:115], v6 offset:4096
    s_waitcnt vmcnt(9) lgkmcnt(9)
    v_mfma_f32_16x16x32_bf16 v[208:211], v[116:119], v[88:91], v[208:211]
    s_waitcnt vmcnt(8)
    v_mfma_f32_16x16x32_bf16 v[228:231], v[116:119], v[92:95], v[228:231]
    ds_read_b128 v[116:119], v6 offset:5120
    s_waitcnt lgkmcnt(9)
    v_mfma_f32_16x16x32_bf16 v[212:215], v[120:123], v[88:91], v[212:215]
    s_add_u32 s53, s56, 57344
    buffer_load_dwordx4 v[80:83], v10, s[4:7], s53 offen offset:0 sc1
    v_mfma_f32_16x16x32_bf16 v[232:235], v[120:123], v[92:95], v[232:235]
    ds_read_b128 v[120:123], v6 offset:6144
    s_waitcnt lgkmcnt(9)
    v_mfma_f32_16x16x32_bf16 v[216:219], v[124:127], v[88:91], v[216:219]
    buffer_load_dwordx4 v[84:87], v11, s[4:7], s53 offen offset:0 sc1
    v_mfma_f32_16x16x32_bf16 v[236:239], v[124:127], v[92:95], v[236:239]
    ds_read_b128 v[124:127], v6 offset:7168
    s_waitcnt lgkmcnt(9)
    v_mfma_f32_16x16x32_bf16 v[220:223], v[192:195], v[88:91], v[220:223]
    v_mfma_f32_16x16x32_bf16 v[240:243], v[192:195], v[92:95], v[240:243]
    ds_read_b128 v[192:195], v6 offset:8192
    s_waitcnt lgkmcnt(9)
    v_mfma_f32_16x16x32_bf16 v[224:227], v[196:199], v[88:91], v[224:227]
    v_mfma_f32_16x16x32_bf16 v[244:247], v[196:199], v[92:95], v[244:247]
    ds_read_b128 v[196:199], v6 offset:9216
    s_waitcnt vmcnt(9) lgkmcnt(9)
    v_mfma_f32_16x16x32_bf16 v[208:211], v[48:51], v[96:99], v[208:211]
    s_waitcnt vmcnt(8)
    v_mfma_f32_16x16x32_bf16 v[228:231], v[48:51], v[100:103], v[228:231]
    v_add_u32 v6, 81920, v9
    ds_read_b128 v[48:51], v6 offset:0
    s_waitcnt lgkmcnt(9)
    v_mfma_f32_16x16x32_bf16 v[212:215], v[52:55], v[96:99], v[212:215]
    buffer_load_dwordx4 v[88:91], v10, s[4:7], s53 offen offset:2048 sc1
    v_mfma_f32_16x16x32_bf16 v[232:235], v[52:55], v[100:103], v[232:235]
    ds_read_b128 v[52:55], v6 offset:1024
    s_waitcnt lgkmcnt(9)
    v_mfma_f32_16x16x32_bf16 v[216:219], v[56:59], v[96:99], v[216:219]
    v_mfma_f32_16x16x32_bf16 v[236:239], v[56:59], v[100:103], v[236:239]
    ds_read_b128 v[56:59], v6 offset:2048
    s_waitcnt lgkmcnt(9)
    v_mfma_f32_16x16x32_bf16 v[220:223], v[60:63], v[96:99], v[220:223]
    buffer_load_dwordx4 v[92:95], v11, s[4:7], s53 offen offset:2048 sc1
    v_mfma_f32_16x16x32_bf16 v[240:243], v[60:63], v[100:103], v[240:243]
    ds_read_b128 v[60:63], v6 offset:3072
    s_waitcnt lgkmcnt(9)
    v_mfma_f32_16x16x32_bf16 v[224:227], v[112:115], v[96:99], v[224:227]
    v_mfma_f32_16x16x32_bf16 v[244:247], v[112:115], v[100:103], v[244:247]
    ds_read_b128 v[112:115], v6 offset:4096
    s_waitcnt vmcnt(9) lgkmcnt(9)
    v_mfma_f32_16x16x32_bf16 v[208:211], v[116:119], v[104:107], v[208:211]
    s_waitcnt vmcnt(8)
    v_mfma_f32_16x16x32_bf16 v[228:231], v[116:119], v[108:111], v[228:231]
    ds_read_b128 v[116:119], v6 offset:5120
    s_waitcnt lgkmcnt(9)
    v_mfma_f32_16x16x32_bf16 v[212:215], v[120:123], v[104:107], v[212:215]
    s_add_u32 s53, s56, 65536
    buffer_load_dwordx4 v[96:99], v10, s[4:7], s53 offen offset:0 sc1
    v_mfma_f32_16x16x32_bf16 v[232:235], v[120:123], v[108:111], v[232:235]
    ds_read_b128 v[120:123], v6 offset:6144
    s_waitcnt lgkmcnt(9)
    v_mfma_f32_16x16x32_bf16 v[216:219], v[124:127], v[104:107], v[216:219]
    buffer_load_dwordx4 v[100:103], v11, s[4:7], s53 offen offset:0 sc1
    v_mfma_f32_16x16x32_bf16 v[236:239], v[124:127], v[108:111], v[236:239]
    ds_read_b128 v[124:127], v6 offset:7168
    s_waitcnt lgkmcnt(9)
    v_mfma_f32_16x16x32_bf16 v[220:223], v[192:195], v[104:107], v[220:223]
    v_mfma_f32_16x16x32_bf16 v[240:243], v[192:195], v[108:111], v[240:243]
    ds_read_b128 v[192:195], v6 offset:8192
    s_waitcnt lgkmcnt(9)
    v_mfma_f32_16x16x32_bf16 v[224:227], v[196:199], v[104:107], v[224:227]
    v_mfma_f32_16x16x32_bf16 v[244:247], v[196:199], v[108:111], v[244:247]
    ds_read_b128 v[196:199], v6 offset:9216
    s_waitcnt vmcnt(9) lgkmcnt(9)
    v_mfma_f32_16x16x32_bf16 v[208:211], v[48:51], v[64:67], v[208:211]
    s_waitcnt vmcnt(8)
    v_mfma_f32_16x16x32_bf16 v[228:231], v[48:51], v[68:71], v[228:231]
    s_barrier
    v_add_u32 v6, 102400, v9
    ds_read_b128 v[48:51], v6 offset:0
    s_waitcnt lgkmcnt(9)
    v_mfma_f32_16x16x32_bf16 v[212:215], v[52:55], v[64:67], v[212:215]
    buffer_load_dwordx4 v[104:107], v10, s[4:7], s53 offen offset:2048 sc1
    v_mfma_f32_16x16x32_bf16 v[232:235], v[52:55], v[68:71], v[232:235]
    ds_read_b128 v[52:55], v6 offset:1024
    s_waitcnt lgkmcnt(9)
    v_mfma_f32_16x16x32_bf16 v[216:219], v[56:59], v[64:67], v[216:219]
    v_mfma_f32_16x16x32_bf16 v[236:239], v[56:59], v[68:71], v[236:239]
    ds_read_b128 v[56:59], v6 offset:2048
    s_waitcnt lgkmcnt(9)
    v_mfma_f32_16x16x32_bf16 v[220:223], v[60:63], v[64:67], v[220:223]
    buffer_load_dwordx4 v[108:111], v11, s[4:7], s53 offen offset:2048 sc1
    v_mfma_f32_16x16x32_bf16 v[240:243], v[60:63], v[68:71], v[240:243]
    ds_read_b128 v[60:63], v6 offset:3072
    s_waitcnt lgkmcnt(9)
    v_mfma_f32_16x16x32_bf16 v[224:227], v[112:115], v[64:67], v[224:227]
    v_mfma_f32_16x16x32_bf16 v[244:247], v[112:115], v[68:71], v[244:247]
    ds_read_b128 v[112:115], v6 offset:4096
    s_waitcnt vmcnt(9) lgkmcnt(9)
    v_mfma_f32_16x16x32_bf16 v[208:211], v[116:119], v[72:75], v[208:211]
    s_waitcnt vmcnt(8)
    v_mfma_f32_16x16x32_bf16 v[228:231], v[116:119], v[76:79], v[228:231]
    ds_read_b128 v[116:119], v6 offset:5120
    s_waitcnt lgkmcnt(9)
    v_mfma_f32_16x16x32_bf16 v[212:215], v[120:123], v[72:75], v[212:215]
    s_add_u32 s53, s56, 73728
    buffer_load_dwordx4 v[64:67], v10, s[4:7], s53 offen offset:0 sc1
    v_mfma_f32_16x16x32_bf16 v[232:235], v[120:123], v[76:79], v[232:235]
    ds_read_b128 v[120:123], v6 offset:6144
    s_waitcnt lgkmcnt(9)
    v_mfma_f32_16x16x32_bf16 v[216:219], v[124:127], v[72:75], v[216:219]
    buffer_load_dwordx4 v[68:71], v11, s[4:7], s53 offen offset:0 sc1
    v_mfma_f32_16x16x32_bf16 v[236:239], v[124:127], v[76:79], v[236:239]
    ds_read_b128 v[124:127], v6 offset:7168
    s_waitcnt lgkmcnt(9)
    v_mfma_f32_16x16x32_bf16 v[220:223], v[192:195], v[72:75], v[220:223]
    v_mfma_f32_16x16x32_bf16 v[240:243], v[192:195], v[76:79], v[240:243]
    ds_read_b128 v[192:195], v6 offset:8192
    s_waitcnt lgkmcnt(9)
    v_mfma_f32_16x16x32_bf16 v[224:227], v[196:199], v[72:75], v[224:227]
    v_mfma_f32_16x16x32_bf16 v[244:247], v[196:199], v[76:79], v[244:247]
    ds_read_b128 v[196:199], v6 offset:9216
    s_waitcnt vmcnt(9) lgkmcnt(9)
    v_mfma_f32_16x16x32_bf16 v[208:211], v[48:51], v[80:83], v[208:211]
    s_waitcnt vmcnt(8)
    v_mfma_f32_16x16x32_bf16 v[228:231], v[48:51], v[84:87], v[228:231]
    v_add_u32 v6, 122880, v9
    ds_read_b128 v[48:51], v6 offset:0
    s_waitcnt lgkmcnt(9)
    v_mfma_f32_16x16x32_bf16 v[212:215], v[52:55], v[80:83], v[212:215]
    buffer_load_dwordx4 v[72:75], v10, s[4:7], s53 offen offset:2048 sc1
    v_mfma_f32_16x16x32_bf16 v[232:235], v[52:55], v[84:87], v[232:235]
    ds_read_b128 v[52:55], v6 offset:1024
    s_waitcnt lgkmcnt(9)
    v_mfma_f32_16x16x32_bf16 v[216:219], v[56:59], v[80:83], v[216:219]
    v_mfma_f32_16x16x32_bf16 v[236:239], v[56:59], v[84:87], v[236:239]
    ds_read_b128 v[56:59], v6 offset:2048
    s_waitcnt lgkmcnt(9)
    v_mfma_f32_16x16x32_bf16 v[220:223], v[60:63], v[80:83], v[220:223]
    buffer_load_dwordx4 v[76:79], v11, s[4:7], s53 offen offset:2048 sc1
    v_mfma_f32_16x16x32_bf16 v[240:243], v[60:63], v[84:87], v[240:243]
    ds_read_b128 v[60:63], v6 offset:3072
    s_waitcnt lgkmcnt(9)
    v_mfma_f32_16x16x32_bf16 v[224:227], v[112:115], v[80:83], v[224:227]
    v_mfma_f32_16x16x32_bf16 v[244:247], v[112:115], v[84:87], v[244:247]
    ds_read_b128 v[112:115], v6 offset:4096
    s_waitcnt vmcnt(9) lgkmcnt(9)
    v_mfma_f32_16x16x32_bf16 v[208:211], v[116:119], v[88:91], v[208:211]
    s_waitcnt vmcnt(8)
    v_mfma_f32_16x16x32_bf16 v[228:231], v[116:119], v[92:95], v[228:231]
    ds_read_b128 v[116:119], v6 offset:5120
    s_waitcnt lgkmcnt(9)
    v_mfma_f32_16x16x32_bf16 v[212:215], v[120:123], v[88:91], v[212:215]
    s_add_u32 s53, s56, 81920
    buffer_load_dwordx4 v[80:83], v10, s[4:7], s53 offen offset:0 sc1
    v_mfma_f32_16x16x32_bf16 v[232:235], v[120:123], v[92:95], v[232:235]
    ds_read_b128 v[120:123], v6 offset:6144
    s_waitcnt lgkmcnt(9)
    v_mfma_f32_16x16x32_bf16 v[216:219], v[124:127], v[88:91], v[216:219]
    buffer_load_dwordx4 v[84:87], v11, s[4:7], s53 offen offset:0 sc1
    v_mfma_f32_16x16x32_bf16 v[236:239], v[124:127], v[92:95], v[236:239]
    ds_read_b128 v[124:127], v6 offset:7168
    s_waitcnt lgkmcnt(9)
    v_mfma_f32_16x16x32_bf16 v[220:223], v[192:195], v[88:91], v[220:223]
    v_mfma_f32_16x16x32_bf16 v[240:243], v[192:195], v[92:95], v[240:243]
    ds_read_b128 v[192:195], v6 offset:8192
    s_waitcnt lgkmcnt(9)
    v_mfma_f32_16x16x32_bf16 v[224:227], v[196:199], v[88:91], v[224:227]
    v_mfma_f32_16x16x32_bf16 v[244:247], v[196:199], v[92:95], v[244:247]
    ds_read_b128 v[196:199], v6 offset:9216
    s_waitcnt vmcnt(9) lgkmcnt(9)
    v_mfma_f32_16x16x32_bf16 v[208:211], v[48:51], v[96:99], v[208:211]
    s_waitcnt vmcnt(8)
    v_mfma_f32_16x16x32_bf16 v[228:231], v[48:51], v[100:103], v[228:231]
    s_barrier
    v_add_u32 v6, 0, v9
    ds_read_b128 v[48:51], v6 offset:0
    s_waitcnt lgkmcnt(9)
    v_mfma_f32_16x16x32_bf16 v[212:215], v[52:55], v[96:99], v[212:215]
    buffer_load_dwordx4 v[88:91], v10, s[4:7], s53 offen offset:2048 sc1
    v_mfma_f32_16x16x32_bf16 v[232:235], v[52:55], v[100:103], v[232:235]
    ds_read_b128 v[52:55], v6 offset:1024
    s_waitcnt lgkmcnt(9)
    v_mfma_f32_16x16x32_bf16 v[216:219], v[56:59], v[96:99], v[216:219]
    v_mfma_f32_16x16x32_bf16 v[236:239], v[56:59], v[100:103], v[236:239]
    ds_read_b128 v[56:59], v6 offset:2048
    s_waitcnt lgkmcnt(9)
    v_mfma_f32_16x16x32_bf16 v[220:223], v[60:63], v[96:99], v[220:223]
    buffer_load_dwordx4 v[92:95], v11, s[4:7], s53 offen offset:2048 sc1
    v_mfma_f32_16x16x32_bf16 v[240:243], v[60:63], v[100:103], v[240:243]
    ds_read_b128 v[60:63], v6 offset:3072
    s_waitcnt lgkmcnt(9)
    v_mfma_f32_16x16x32_bf16 v[224:227], v[112:115], v[96:99], v[224:227]
    v_mfma_f32_16x16x32_bf16 v[244:247], v[112:115], v[100:103], v[244:247]
    ds_read_b128 v[112:115], v6 offset:4096
    s_waitcnt vmcnt(9) lgkmcnt(9)
    v_mfma_f32_16x16x32_bf16 v[208:211], v[116:119], v[104:107], v[208:211]
    s_waitcnt vmcnt(8)
    v_mfma_f32_16x16x32_bf16 v[228:231], v[116:119], v[108:111], v[228:231]
    ds_read_b128 v[116:119], v6 offset:5120
    s_waitcnt lgkmcnt(9)
    v_mfma_f32_16x16x32_bf16 v[212:215], v[120:123], v[104:107], v[212:215]
    s_add_u32 s53, s56, 90112
    buffer_load_dwordx4 v[96:99], v10, s[4:7], s53 offen offset:0 sc1
    v_mfma_f32_16x16x32_bf16 v[232:235], v[120:123], v[108:111], v[232:235]
    ds_read_b128 v[120:123], v6 offset:6144
    s_waitcnt lgkmcnt(9)
    v_mfma_f32_16x16x32_bf16 v[216:219], v[124:127], v[104:107], v[216:219]
    buffer_load_dwordx4 v[100:103], v11, s[4:7], s53 offen offset:0 sc1
    v_mfma_f32_16x16x32_bf16 v[236:239], v[124:127], v[108:111], v[236:239]
    ds_read_b128 v[124:127], v6 offset:7168
    s_waitcnt lgkmcnt(9)
    v_mfma_f32_16x16x32_bf16 v[220:223], v[192:195], v[104:107], v[220:223]
    v_mfma_f32_16x16x32_bf16 v[240:243], v[192:195], v[108:111], v[240:243]
    ds_read_b128 v[192:195], v6 offset:8192
    s_waitcnt lgkmcnt(9)
    v_mfma_f32_16x16x32_bf16 v[224:227], v[196:199], v[104:107], v[224:227]
    v_mfma_f32_16x16x32_bf16 v[244:247], v[196:199], v[108:111], v[244:247]
    ds_read_b128 v[196:199], v6 offset:9216
    s_waitcnt vmcnt(9) lgkmcnt(9)
    v_mfma_f32_16x16x32_bf16 v[208:211], v[48:51], v[64:67], v[208:211]
    s_waitcnt vmcnt(8)
    v_mfma_f32_16x16x32_bf16 v[228:231], v[48:51], v[68:71], v[228:231]
    v_add_u32 v6, 20480, v9
    ds_read_b128 v[48:51], v6 offset:0
    s_waitcnt lgkmcnt(9)
    v_mfma_f32_16x16x32_bf16 v[212:215], v[52:55], v[64:67], v[212:215]
    buffer_load_dwordx4 v[104:107], v10, s[4:7], s53 offen offset:2048 sc1
    v_mfma_f32_16x16x32_bf16 v[232:235], v[52:55], v[68:71], v[232:235]
    ds_read_b128 v[52:55], v6 offset:1024
    s_waitcnt lgkmcnt(9)
    v_mfma_f32_16x16x32_bf16 v[216:219], v[56:59], v[64:67], v[216:219]
    v_mfma_f32_16x16x32_bf16 v[236:239], v[56:59], v[68:71], v[236:239]
    ds_read_b128 v[56:59], v6 offset:2048
    s_waitcnt lgkmcnt(9)
    v_mfma_f32_16x16x32_bf16 v[220:223], v[60:63], v[64:67], v[220:223]
    buffer_load_dwordx4 v[108:111], v11, s[4:7], s53 offen offset:2048 sc1
    s_barrier
    v_mfma_f32_16x16x32_bf16 v[240:243], v[60:63], v[68:71], v[240:243]
    ds_read_b128 v[60:63], v6 offset:3072
    s_waitcnt lgkmcnt(9)
    v_mfma_f32_16x16x32_bf16 v[224:227], v[112:115], v[64:67], v[224:227]
    v_mfma_f32_16x16x32_bf16 v[244:247], v[112:115], v[68:71], v[244:247]
    ds_read_b128 v[112:115], v6 offset:4096
    s_waitcnt vmcnt(9) lgkmcnt(9)
    v_mfma_f32_16x16x32_bf16 v[208:211], v[116:119], v[72:75], v[208:211]
    s_waitcnt vmcnt(8)
    v_mfma_f32_16x16x32_bf16 v[228:231], v[116:119], v[76:79], v[228:231]
    ds_read_b128 v[116:119], v6 offset:5120
    s_waitcnt lgkmcnt(9)
    v_mfma_f32_16x16x32_bf16 v[212:215], v[120:123], v[72:75], v[212:215]
    v_mfma_f32_16x16x32_bf16 v[232:235], v[120:123], v[76:79], v[232:235]
    ds_read_b128 v[120:123], v6 offset:6144
    s_waitcnt lgkmcnt(9)
    v_mfma_f32_16x16x32_bf16 v[216:219], v[124:127], v[72:75], v[216:219]
    v_mfma_f32_16x16x32_bf16 v[236:239], v[124:127], v[76:79], v[236:239]
    ds_read_b128 v[124:127], v6 offset:7168
    s_waitcnt lgkmcnt(9)
    v_mfma_f32_16x16x32_bf16 v[220:223], v[192:195], v[72:75], v[220:223]
    v_mfma_f32_16x16x32_bf16 v[240:243], v[192:195], v[76:79], v[240:243]
    ds_read_b128 v[192:195], v6 offset:8192
    s_waitcnt lgkmcnt(9)
    v_mfma_f32_16x16x32_bf16 v[224:227], v[196:199], v[72:75], v[224:227]
    v_mfma_f32_16x16x32_bf16 v[244:247], v[196:199], v[76:79], v[244:247]
    ds_read_b128 v[196:199], v6 offset:9216
    s_waitcnt vmcnt(7) lgkmcnt(9)
    v_mfma_f32_16x16x32_bf16 v[208:211], v[48:51], v[80:83], v[208:211]
    s_waitcnt vmcnt(6)
    v_mfma_f32_16x16x32_bf16 v[228:231], v[48:51], v[84:87], v[228:231]
    v_add_u32 v6, 40960, v9
    ds_read_b128 v[48:51], v6 offset:0
    s_waitcnt lgkmcnt(9)
    v_mfma_f32_16x16x32_bf16 v[212:215], v[52:55], v[80:83], v[212:215]
    v_mfma_f32_16x16x32_bf16 v[232:235], v[52:55], v[84:87], v[232:235]
    ds_read_b128 v[52:55], v6 offset:1024
    s_waitcnt lgkmcnt(9)
    v_mfma_f32_16x16x32_bf16 v[216:219], v[56:59], v[80:83], v[216:219]
    v_mfma_f32_16x16x32_bf16 v[236:239], v[56:59], v[84:87], v[236:239]
    ds_read_b128 v[56:59], v6 offset:2048
    s_waitcnt lgkmcnt(9)
    v_mfma_f32_16x16x32_bf16 v[220:223], v[60:63], v[80:83], v[220:223]
    v_mfma_f32_16x16x32_bf16 v[240:243], v[60:63], v[84:87], v[240:243]
    ds_read_b128 v[60:63], v6 offset:3072
    s_waitcnt lgkmcnt(9)
    v_mfma_f32_16x16x32_bf16 v[224:227], v[112:115], v[80:83], v[224:227]
    v_mfma_f32_16x16x32_bf16 v[244:247], v[112:115], v[84:87], v[244:247]
    ds_read_b128 v[112:115], v6 offset:4096
    s_waitcnt vmcnt(5) lgkmcnt(9)
    v_mfma_f32_16x16x32_bf16 v[208:211], v[116:119], v[88:91], v[208:211]
    s_waitcnt vmcnt(4)
    v_mfma_f32_16x16x32_bf16 v[228:231], v[116:119], v[92:95], v[228:231]
    ds_read_b128 v[116:119], v6 offset:5120
    s_waitcnt lgkmcnt(9)
    v_mfma_f32_16x16x32_bf16 v[212:215], v[120:123], v[88:91], v[212:215]
    v_mfma_f32_16x16x32_bf16 v[232:235], v[120:123], v[92:95], v[232:235]
    ds_read_b128 v[120:123], v6 offset:6144
    s_waitcnt lgkmcnt(9)
    v_mfma_f32_16x16x32_bf16 v[216:219], v[124:127], v[88:91], v[216:219]
    v_mfma_f32_16x16x32_bf16 v[236:239], v[124:127], v[92:95], v[236:239]
    ds_read_b128 v[124:127], v6 offset:7168
    s_waitcnt lgkmcnt(9)
    v_mfma_f32_16x16x32_bf16 v[220:223], v[192:195], v[88:91], v[220:223]
    v_mfma_f32_16x16x32_bf16 v[240:243], v[192:195], v[92:95], v[240:243]
    ds_read_b128 v[192:195], v6 offset:8192
    s_waitcnt lgkmcnt(9)
    v_mfma_f32_16x16x32_bf16 v[224:227], v[196:199], v[88:91], v[224:227]
    v_mfma_f32_16x16x32_bf16 v[244:247], v[196:199], v[92:95], v[244:247]
    ds_read_b128 v[196:199], v6 offset:9216
    s_waitcnt vmcnt(2) lgkmcnt(9)
    v_mfma_f32_16x16x32_bf16 v[228:231], v[48:51], v[100:103], v[228:231]
    s_waitcnt lgkmcnt(8)
    v_mfma_f32_16x16x32_bf16 v[232:235], v[52:55], v[100:103], v[232:235]
    s_waitcnt lgkmcnt(7)
    v_mfma_f32_16x16x32_bf16 v[236:239], v[56:59], v[100:103], v[236:239]
    s_waitcnt lgkmcnt(6)
    v_mfma_f32_16x16x32_bf16 v[240:243], v[60:63], v[100:103], v[240:243]
    s_waitcnt lgkmcnt(5)
    v_mfma_f32_16x16x32_bf16 v[244:247], v[112:115], v[100:103], v[244:247]
    s_waitcnt vmcnt(0) lgkmcnt(4)
    v_mfma_f32_16x16x32_bf16 v[228:231], v[116:119], v[108:111], v[228:231]
    s_waitcnt lgkmcnt(3)
    v_mfma_f32_16x16x32_bf16 v[232:235], v[120:123], v[108:111], v[232:235]
    s_waitcnt lgkmcnt(2)
    v_mfma_f32_16x16x32_bf16 v[236:239], v[124:127], v[108:111], v[236:239]
    s_waitcnt lgkmcnt(1)
    v_mfma_f32_16x16x32_bf16 v[240:243], v[192:195], v[108:111], v[240:243]
    s_waitcnt lgkmcnt(0)
    v_mfma_f32_16x16x32_bf16 v[244:247], v[196:199], v[108:111], v[244:247]
    v_mfma_f32_16x16x32_bf16 v[208:211], v[48:51], v[96:99], v[208:211]
    v_mfma_f32_16x16x32_bf16 v[212:215], v[52:55], v[96:99], v[212:215]
    v_mfma_f32_16x16x32_bf16 v[216:219], v[56:59], v[96:99], v[216:219]
    v_mfma_f32_16x16x32_bf16 v[220:223], v[60:63], v[96:99], v[220:223]
    ds_write_b128 v20, v[228:231] offset:0
    v_mfma_f32_16x16x32_bf16 v[224:227], v[112:115], v[96:99], v[224:227]
    ds_write_b128 v20, v[232:235] offset:1024
    v_mfma_f32_16x16x32_bf16 v[208:211], v[116:119], v[104:107], v[208:211]
    ds_write_b128 v20, v[236:239] offset:2048
    v_mfma_f32_16x16x32_bf16 v[212:215], v[120:123], v[104:107], v[212:215]
    ds_write_b128 v20, v[240:243] offset:3072
    v_mfma_f32_16x16x32_bf16 v[216:219], v[124:127], v[104:107], v[216:219]
    ds_write_b128 v20, v[244:247] offset:4096
    v_mfma_f32_16x16x32_bf16 v[220:223], v[192:195], v[104:107], v[220:223]
    v_mfma_f32_16x16x32_bf16 v[224:227], v[196:199], v[104:107], v[224:227]
    s_waitcnt lgkmcnt(0)
    s_barrier
    ds_read_b128 v[228:231], v21 offset:0
    ds_read_b128 v[232:235], v21 offset:1024
    ds_read_b128 v[236:239], v21 offset:2048
    ds_read_b128 v[240:243], v21 offset:3072
    ds_read_b128 v[244:247], v21 offset:4096
    v_mov_b32 v16, 0
    v_mov_b32 v17, 0
    v_mov_b32 v18, 0
    v_mov_b32 v19, 0
    s_waitcnt lgkmcnt(3)
    v_pk_add_f32 v[208:209], v[208:209], v[228:229]
    v_pk_add_f32 v[210:211], v[210:211], v[230:231]
    v_pk_add_f32 v[212:213], v[212:213], v[232:233]
    v_pk_add_f32 v[214:215], v[214:215], v[234:235]
    v_cvt_pk_bf16_f32 v112, v208, v209
    v_cvt_pk_bf16_f32 v113, v210, v211
    v_cvt_pk_bf16_f32 v114, v212, v213
    v_cvt_pk_bf16_f32 v115, v214, v215
    s_cmp_lg_u32 s25, 0
    s_cbranch_scc1 L_fin_100
    buffer_store_dwordx4 v[112:115], v10, s[4:7], s84 offen
    s_waitcnt lgkmcnt(1)
    v_pk_add_f32 v[216:217], v[216:217], v[236:237]
    v_pk_add_f32 v[218:219], v[218:219], v[238:239]
    v_pk_add_f32 v[220:221], v[220:221], v[240:241]
    v_pk_add_f32 v[222:223], v[222:223], v[242:243]
    v_cvt_pk_bf16_f32 v116, v216, v217
    v_cvt_pk_bf16_f32 v117, v218, v219
    v_cvt_pk_bf16_f32 v118, v220, v221
    v_cvt_pk_bf16_f32 v119, v222, v223
    buffer_store_dwordx4 v[116:119], v10, s[4:7], s84 offen offset:2048
    s_waitcnt lgkmcnt(0)
    v_pk_add_f32 v[224:225], v[224:225], v[244:245]
    v_pk_add_f32 v[226:227], v[226:227], v[246:247]
    v_cvt_pk_bf16_f32 v120, v224, v225
    v_cvt_pk_bf16_f32 v121, v226, v227
    buffer_store_dwordx2 v[120:121], v22, s[4:7], s85 offen
    v_pk_add_f32 v[16:17], v[16:17], v[208:209]
    v_pk_fma_f32 v[18:19], v[208:209], v[208:209], v[18:19]
    v_pk_add_f32 v[16:17], v[16:17], v[210:211]
    v_pk_fma_f32 v[18:19], v[210:211], v[210:211], v[18:19]
    v_pk_add_f32 v[16:17], v[16:17], v[212:213]
    v_pk_fma_f32 v[18:19], v[212:213], v[212:213], v[18:19]
    v_pk_add_f32 v[16:17], v[16:17], v[214:215]
    v_pk_fma_f32 v[18:19], v[214:215], v[214:215], v[18:19]
    v_pk_add_f32 v[16:17], v[16:17], v[216:217]
    v_pk_fma_f32 v[18:19], v[216:217], v[216:217], v[18:19]
    v_pk_add_f32 v[16:17], v[16:17], v[218:219]
    v_pk_fma_f32 v[18:19], v[218:219], v[218:219], v[18:19]
    v_pk_add_f32 v[16:17], v[16:17], v[220:221]
    v_pk_fma_f32 v[18:19], v[220:221], v[220:221], v[18:19]
    v_pk_add_f32 v[16:17], v[16:17], v[222:223]
    v_pk_fma_f32 v[18:19], v[222:223], v[222:223], v[18:19]
    v_pk_add_f32 v[16:17], v[16:17], v[224:225]
    v_pk_fma_f32 v[18:19], v[224:225], v[224:225], v[18:19]
    v_pk_add_f32 v[16:17], v[16:17], v[226:227]
    v_pk_fma_f32 v[18:19], v[226:227], v[226:227], v[18:19]
    v_add_f32 v16, v16, v17
    v_add_f32 v18, v18, v19
    s_nop 1
    v_permlane32_swap_b32 v16, v18
    s_nop 1
    v_add_f32 v16, v16, v18
    v_mov_b32 v17, v16
    s_nop 1
    v_permlane16_swap_b32 v16, v17
    s_nop 1
    v_add_f32 v16, v16, v17
    buffer_store_dword v16, v35, s[4:7], s86 offen
    s_lshl_b32 s55, s40, 7
    s_add_u32 s55, s55, s23
    s_lshl2_add_u32 s55, s87, s55
    v_mov_b32 v13, 1
    s_cmp_lg_u32 s19, 0
    s_cbranch_scc1 L_pubslow_101
    s_mov_b64 exec, 1
    s_waitcnt vmcnt(0)
    buffer_store_dword v13, v2, s[4:7], s55 offen offset:3072
L_pubdone_102:
    s_mov_b64 exec, -1
L_qkv_phase:
    s_lshl_b32 s40, s37, 2
    s_add_u32 s40, s40, s16
    v_mov_b32 v9, v2
    v_and_b32 v12, 31, v1
    v_subrev_u32 v13, 24, v12
    v_min_u32 v12, v12, v13
    v_lshlrev_b32 v12, 4, v12
    v_mul_u32_u24 v10, 384, v5
    v_add_u32 v10, v10, v12
    s_barrier
    v_add_u32 v6, 61440, v9
    ds_read_b128 v[48:51], v6 offset:0
    ds_read_b128 v[52:55], v6 offset:1024
    ds_read_b128 v[56:59], v6 offset:2048
    v_add_u32 v7, 61440, v10
    ds_read_b128 v[60:63], v7 offset:15360
    ds_read_b128 v[176:179], v6 offset:3072
    ds_read_b128 v[180:183], v6 offset:4096
    ds_read_b128 v[184:187], v6 offset:5120
    ds_read_b128 v[188:191], v7 offset:16128
    s_lshl_b32 s50, s40, 7
    s_add_u32 s50, s50, s23
    v_lshrrev_b32 v12, 2, v2
    s_mov_b32 s51, 0x100000
    s_mov_b64 exec, 0xffff
L_poll_103:
    buffer_load_dword v13, v12, s[4:7], s50 offen offset:3072 sc1
    s_sub_u32 s51, s51, 1
    s_cbranch_scc1 L_polld_104
    s_waitcnt vmcnt(0)
    v_cmp_eq_u32 vcc, 0, v13
    s_cbranch_vccnz L_poll_103
L_polld_104:
    s_mov_b64 exec, -1
    s_cmp_lg_u32 s19, 0
    s_cbranch_scc1 L_ool_105
L_back_106:
    s_mul_i32 s56, s40, 40960
    s_add_u32 s56, s56, s27
    s_add_u32 s53, s56, 0
    buffer_load_dwordx4 v[128:131], v2, s[4:7], s53 offen offset:0 sc1
    buffer_load_dwordx4 v[132:135], v2, s[4:7], s53 offen offset:1024 sc1
    buffer_load_dwordx4 v[136:139], v2, s[4:7], s53 offen offset:2048 sc1
    buffer_load_dwordx4 v[140:143], v2, s[4:7], s53 offen offset:3072 sc1
    s_add_u32 s53, s56, 4096
    buffer_load_dwordx4 v[144:147], v2, s[4:7], s53 offen offset:0 sc1
    buffer_load_dwordx4 v[148:151], v2, s[4:7], s53 offen offset:1024 sc1
    buffer_load_dwordx4 v[152:155], v2, s[4:7], s53 offen offset:2048 sc1
    s_mul_i32 s84, s40, 2560
    s_add_u32 s84, s84, s21
    s_mul_i32 s57, s36, 6
    s_add_u32 s57, s57, 0
    s_lshr_b32 s58, s57, 1
    s_add_u32 s58, s58, 32
    s_and_b32 s59, s57, 31
    s_cmp_lt_u32 s57, 32
    s_cselect_b32 s58, s58, s59
    s_mov_b32 s86, 163840
    s_cselect_b32 s88, 256, s86
    s_cselect_b32 s86, 1024, s86
    s_cselect_b32 s59, 0x3ea52b5c, 1.0
    v_mov_b32 v20, s59
    s_mul_i32 s58, s58, 163840
    s_add_u32 s58, s58, s84
    s_cmp_ge_u32 s57, 64
    s_cselect_b32 s85, 1024, 0
    s_cselect_b32 s87, 256, 0
    s_add_u32 s85, s85, s58
    s_add_u32 s87, s87, s58
    s_add_u32 s86, s86, s85
    v_mul_lo_u32 v26, s88, v5
    v_add_u32 v26, v26, v4
    s_mul_i32 s57, s36, 6
    s_add_u32 s57, s57, 2
    s_lshr_b32 s58, s57, 1
    s_add_u32 s58, s58, 32
    s_and_b32 s59, s57, 31
    s_cmp_lt_u32 s57, 32
    s_cselect_b32 s58, s58, s59
    s_mov_b32 s90, 163840
    s_cselect_b32 s92, 256, s90
    s_cselect_b32 s90, 1024, s90
    s_cselect_b32 s59, 0x3ea52b5c, 1.0
    v_mov_b32 v22, s59
    s_mul_i32 s58, s58, 163840
    s_add_u32 s58, s58, s84
    s_cmp_ge_u32 s57, 64
    s_cselect_b32 s89, 1024, 0
    s_cselect_b32 s91, 256, 0
    s_add_u32 s89, s89, s58
    s_add_u32 s91, s91, s58
    s_add_u32 s90, s90, s89
    v_mul_lo_u32 v27, s92, v5
    v_add_u32 v27, v27, v4
    s_mul_i32 s57, s36, 6
    s_add_u32 s57, s57, 4
    s_lshr_b32 s58, s57, 1
    s_add_u32 s58, s58, 32
    s_and_b32 s59, s57, 31
    s_cmp_lt_u32 s57, 32
    s_cselect_b32 s58, s58, s59
    s_mov_b32 s94, 163840
    s_cselect_b32 s96, 256, s94
    s_cselect_b32 s94, 1024, s94
    s_cselect_b32 s59, 0x3ea52b5c, 1.0
    v_mov_b32 v24, s59
    s_mul_i32 s58, s58, 163840
    s_add_u32 s58, s58, s84
    s_cmp_ge_u32 s57, 64
    s_cselect_b32 s93, 1024, 0
    s_cselect_b32 s95, 256, 0
    s_add_u32 s93, s93, s58
    s_add_u32 s95, s95, s58
    s_add_u32 s94, s94, s93
    v_mul_lo_u32 v28, s96, v5
    v_add_u32 v28, v28, v4
    s_waitcnt vmcnt(6)
    s_waitcnt lgkmcnt(7)
    v_mfma_f32_32x32x16_bf16 v[64:79], v[48:51], v[128:131], 0
    ds_read_b128 v[48:51], v6 offset:6144
    buffer_load_dwordx4 v[156:159], v2, s[4:7], s53 offen offset:3072 sc1
    s_waitcnt lgkmcnt(7)
    v_mfma_f32_32x32x16_bf16 v[80:95], v[52:55], v[128:131], 0
    ds_read_b128 v[52:55], v6 offset:7168
    s_waitcnt lgkmcnt(7)
    v_mfma_f32_32x32x16_bf16 v[96:111], v[56:59], v[128:131], 0
    ds_read_b128 v[56:59], v6 offset:8192
    s_lshl_b32 s54, s40, 12
    s_add_u32 s54, s54, s26
    buffer_load_dwordx4 v[192:195], v2, s[4:7], s54 offen offset:0 sc1
    s_waitcnt lgkmcnt(7)
    v_mfma_f32_32x32x16_bf16 v[112:127], v[60:63], v[128:131], 0
    ds_read_b128 v[60:63], v7 offset:16896
    s_waitcnt vmcnt(7)
    s_waitcnt lgkmcnt(7)
    v_mfma_f32_32x32x16_bf16 v[64:79], v[176:179], v[132:135], v[64:79]
    ds_read_b128 v[176:179], v6 offset:9216
    s_add_u32 s53, s56, 8192
    buffer_load_dwordx4 v[160:163], v2, s[4:7], s53 offen offset:0 sc1
    s_waitcnt lgkmcnt(7)
    v_mfma_f32_32x32x16_bf16 v[80:95], v[180:183], v[132:135], v[80:95]
    ds_read_b128 v[180:183], v6 offset:10240
    buffer_load_dwordx4 v[164:167], v2, s[4:7], s53 offen offset:1024 sc1
    s_waitcnt lgkmcnt(7)
    v_mfma_f32_32x32x16_bf16 v[96:111], v[184:187], v[132:135], v[96:111]
    ds_read_b128 v[184:187], v6 offset:11264
    s_waitcnt lgkmcnt(7)
    v_mfma_f32_32x32x16_bf16 v[112:127], v[188:191], v[132:135], v[112:127]
    ds_read_b128 v[188:191], v7 offset:17664
    s_waitcnt vmcnt(8)
    s_waitcnt lgkmcnt(7)
    v_mfma_f32_32x32x16_bf16 v[64:79], v[48:51], v[136:139], v[64:79]
    ds_read_b128 v[48:51], v6 offset:12288
    buffer_load_dwordx4 v[168:171], v2, s[4:7], s53 offen offset:2048 sc1
    s_waitcnt lgkmcnt(7)
    v_mfma_f32_32x32x16_bf16 v[80:95], v[52:55], v[136:139], v[80:95]
    ds_read_b128 v[52:55], v6 offset:13312
    s_waitcnt lgkmcnt(7)
    v_mfma_f32_32x32x16_bf16 v[96:111], v[56:59], v[136:139], v[96:111]
    ds_read_b128 v[56:59], v6 offset:14336
    buffer_load_dwordx4 v[196:199], v2, s[4:7], s54 offen offset:1024 sc1
    s_waitcnt lgkmcnt(7)
    v_mfma_f32_32x32x16_bf16 v[112:127], v[60:63], v[136:139], v[112:127]
    ds_read_b128 v[60:63], v7 offset:18432
    s_waitcnt vmcnt(9)
    s_waitcnt lgkmcnt(7)
    v_mfma_f32_32x32x16_bf16 v[64:79], v[176:179], v[140:143], v[64:79]
    v_add_u32 v6, 81920, v9
    ds_read_b128 v[176:179], v6 offset:0
    buffer_load_dwordx4 v[172:175], v2, s[4:7], s53 offen offset:3072 sc1
    s_waitcnt lgkmcnt(7)
    v_mfma_f32_32x32x16_bf16 v[80:95], v[180:183], v[140:143], v[80:95]
    ds_read_b128 v[180:183], v6 offset:1024
    s_add_u32 s53, s56, 12288
    buffer_load_dwordx4 v[128:131], v2, s[4:7], s53 offen offset:0 sc1
    s_waitcnt lgkmcnt(7)
    v_mfma_f32_32x32x16_bf16 v[96:111], v[184:187], v[140:143], v[96:111]
    ds_read_b128 v[184:187], v6 offset:2048
    s_waitcnt lgkmcnt(7)
    v_mfma_f32_32x32x16_bf16 v[112:127], v[188:191], v[140:143], v[112:127]
    v_add_u32 v7, 81920, v10
    ds_read_b128 v[188:191], v7 offset:15360
    s_waitcnt vmcnt(10)
    s_waitcnt lgkmcnt(7)
    v_mfma_f32_32x32x16_bf16 v[64:79], v[48:51], v[144:147], v[64:79]
    ds_read_b128 v[48:51], v6 offset:3072
    buffer_load_dwordx4 v[132:135], v2, s[4:7], s53 offen offset:1024 sc1
    s_waitcnt lgkmcnt(7)
    v_mfma_f32_32x32x16_bf16 v[80:95], v[52:55], v[144:147], v[80:95]
    ds_read_b128 v[52:55], v6 offset:4096
    s_waitcnt lgkmcnt(7)
    v_mfma_f32_32x32x16_bf16 v[96:111], v[56:59], v[144:147], v[96:111]
    ds_read_b128 v[56:59], v6 offset:5120
    s_waitcnt lgkmcnt(7)
    v_mfma_f32_32x32x16_bf16 v[112:127], v[60:63], v[144:147], v[112:127]
    ds_read_b128 v[60:63], v7 offset:16128
    s_waitcnt vmcnt(10)
    s_waitcnt lgkmcnt(7)
    v_mfma_f32_32x32x16_bf16 v[64:79], v[176:179], v[148:151], v[64:79]
    ds_read_b128 v[176:179], v6 offset:6144
    buffer_load_dwordx4 v[136:139], v2, s[4:7], s53 offen offset:2048 sc1
    s_waitcnt lgkmcnt(7)
    v_mfma_f32_32x32x16_bf16 v[80:95], v[180:183], v[148:151], v[80:95]
    ds_read_b128 v[180:183], v6 offset:7168
    buffer_load_dwordx4 v[140:143], v2, s[4:7], s53 offen offset:3072 sc1
    s_waitcnt lgkmcnt(7)
    v_mfma_f32_32x32x16_bf16 v[96:111], v[184:187], v[148:151], v[96:111]
    ds_read_b128 v[184:187], v6 offset:8192
    s_waitcnt lgkmcnt(7)
    v_mfma_f32_32x32x16_bf16 v[112:127], v[188:191], v[148:151], v[112:127]
    ds_read_b128 v[188:191], v7 offset:16896
    s_waitcnt vmcnt(11)
    s_waitcnt lgkmcnt(7)
    v_mfma_f32_32x32x16_bf16 v[64:79], v[48:51], v[152:155], v[64:79]
    ds_read_b128 v[48:51], v6 offset:9216
    s_add_u32 s53, s56, 16384
    buffer_load_dwordx4 v[144:147], v2, s[4:7], s53 offen offset:0 sc1
    s_waitcnt lgkmcnt(7)
    v_mfma_f32_32x32x16_bf16 v[80:95], v[52:55], v[152:155], v[80:95]
    ds_read_b128 v[52:55], v6 offset:10240
    s_waitcnt lgkmcnt(7)
    v_mfma_f32_32x32x16_bf16 v[96:111], v[56:59], v[152:155], v[96:111]
    ds_read_b128 v[56:59], v6 offset:11264
    s_waitcnt lgkmcnt(7)
    v_mfma_f32_32x32x16_bf16 v[112:127], v[60:63], v[152:155], v[112:127]
    ds_read_b128 v[60:63], v7 offset:17664
    s_waitcnt vmcnt(11)
    s_waitcnt lgkmcnt(7)
    v_mfma_f32_32x32x16_bf16 v[64:79], v[176:179], v[156:159], v[64:79]
    ds_read_b128 v[176:179], v6 offset:12288
    buffer_load_dwordx4 v[148:151], v2, s[4:7], s53 offen offset:1024 sc1
    s_waitcnt lgkmcnt(7)
    v_mfma_f32_32x32x16_bf16 v[80:95], v[180:183], v[156:159], v[80:95]
    ds_read_b128 v[180:183], v6 offset:13312
    buffer_load_dwordx4 v[152:155], v2, s[4:7], s53 offen offset:2048 sc1
    s_waitcnt lgkmcnt(7)
    v_mfma_f32_32x32x16_bf16 v[96:111], v[184:187], v[156:159], v[96:111]
    ds_read_b128 v[184:187], v6 offset:14336
    s_waitcnt lgkmcnt(7)
    v_mfma_f32_32x32x16_bf16 v[112:127], v[188:191], v[156:159], v[112:127]
    ds_read_b128 v[188:191], v7 offset:18432
    s_waitcnt vmcnt(11)
    s_waitcnt lgkmcnt(7)
    v_mfma_f32_32x32x16_bf16 v[64:79], v[48:51], v[160:163], v[64:79]
    v_add_u32 v6, 102400, v9
    ds_read_b128 v[48:51], v6 offset:0
    buffer_load_dwordx4 v[156:159], v2, s[4:7], s53 offen offset:3072 sc1
    s_waitcnt lgkmcnt(7)
    v_mfma_f32_32x32x16_bf16 v[80:95], v[52:55], v[160:163], v[80:95]
    ds_read_b128 v[52:55], v6 offset:1024
    s_waitcnt lgkmcnt(7)
    v_mfma_f32_32x32x16_bf16 v[96:111], v[56:59], v[160:163], v[96:111]
    ds_read_b128 v[56:59], v6 offset:2048
    s_waitcnt lgkmcnt(7)
    v_mfma_f32_32x32x16_bf16 v[112:127], v[60:63], v[160:163], v[112:127]
    v_add_u32 v7, 102400, v10
    ds_read_b128 v[60:63], v7 offset:15360
    s_waitcnt vmcnt(11)
    s_waitcnt lgkmcnt(7)
    v_mfma_f32_32x32x16_bf16 v[64:79], v[176:179], v[164:167], v[64:79]
    ds_read_b128 v[176:179], v6 offset:3072
    s_barrier
    s_waitcnt lgkmcnt(7)
    v_mfma_f32_32x32x16_bf16 v[80:95], v[180:183], v[164:167], v[80:95]
    ds_read_b128 v[180:183], v6 offset:4096
    s_waitcnt lgkmcnt(7)
    v_mfma_f32_32x32x16_bf16 v[96:111], v[184:187], v[164:167], v[96:111]
    ds_read_b128 v[184:187], v6 offset:5120
    s_waitcnt lgkmcnt(7)
    v_mfma_f32_32x32x16_bf16 v[112:127], v[188:191], v[164:167], v[112:127]
    ds_read_b128 v[188:191], v7 offset:16128
    s_waitcnt vmcnt(10)
    s_waitcnt lgkmcnt(7)
    v_mfma_f32_32x32x16_bf16 v[64:79], v[48:51], v[168:171], v[64:79]
    ds_read_b128 v[48:51], v6 offset:6144
    s_waitcnt lgkmcnt(7)
    v_mfma_f32_32x32x16_bf16 v[80:95], v[52:55], v[168:171], v[80:95]
    ds_read_b128 v[52:55], v6 offset:7168
    s_waitcnt lgkmcnt(7)
    v_mfma_f32_32x32x16_bf16 v[96:111], v[56:59], v[168:171], v[96:111]
    ds_read_b128 v[56:59], v6 offset:8192
    s_waitcnt lgkmcnt(7)
    v_mfma_f32_32x32x16_bf16 v[112:127], v[60:63], v[168:171], v[112:127]
    ds_read_b128 v[60:63], v7 offset:16896
    s_waitcnt vmcnt(8)
    s_waitcnt lgkmcnt(7)
    v_mfma_f32_32x32x16_bf16 v[64:79], v[176:179], v[172:175], v[64:79]
    ds_read_b128 v[176:179], v6 offset:9216
    s_waitcnt lgkmcnt(7)
    v_mfma_f32_32x32x16_bf16 v[80:95], v[180:183], v[172:175], v[80:95]
    ds_read_b128 v[180:183], v6 offset:10240
    s_waitcnt lgkmcnt(7)
    v_mfma_f32_32x32x16_bf16 v[96:111], v[184:187], v[172:175], v[96:111]
    ds_read_b128 v[184:187], v6 offset:11264
    s_waitcnt lgkmcnt(7)
    v_mfma_f32_32x32x16_bf16 v[112:127], v[188:191], v[172:175], v[112:127]
    ds_read_b128 v[188:191], v7 offset:17664
    s_waitcnt vmcnt(7)
    s_waitcnt lgkmcnt(7)
    v_mfma_f32_32x32x16_bf16 v[64:79], v[48:51], v[128:131], v[64:79]
    ds_read_b128 v[48:51], v6 offset:12288
    s_waitcnt lgkmcnt(7)
    v_mfma_f32_32x32x16_bf16 v[80:95], v[52:55], v[128:131], v[80:95]
    ds_read_b128 v[52:55], v6 offset:13312
    s_waitcnt lgkmcnt(7)
    v_mfma_f32_32x32x16_bf16 v[96:111], v[56:59], v[128:131], v[96:111]
    ds_read_b128 v[56:59], v6 offset:14336
    s_waitcnt lgkmcnt(7)
    v_mfma_f32_32x32x16_bf16 v[112:127], v[60:63], v[128:131], v[112:127]
    ds_read_b128 v[60:63], v7 offset:18432
    s_waitcnt vmcnt(6)
    s_waitcnt lgkmcnt(7)
    v_mfma_f32_32x32x16_bf16 v[64:79], v[176:179], v[132:135], v[64:79]
    v_add_u32 v6, 122880, v9
    ds_read_b128 v[176:179], v6 offset:0
    s_waitcnt lgkmcnt(7)
    v_mfma_f32_32x32x16_bf16 v[80:95], v[180:183], v[132:135], v[80:95]
    ds_read_b128 v[180:183], v6 offset:1024
    s_waitcnt lgkmcnt(7)
    v_mfma_f32_32x32x16_bf16 v[96:111], v[184:187], v[132:135], v[96:111]
    ds_read_b128 v[184:187], v6 offset:2048
    s_waitcnt lgkmcnt(7)
    v_mfma_f32_32x32x16_bf16 v[112:127], v[188:191], v[132:135], v[112:127]
    v_add_u32 v7, 122880, v10
    ds_read_b128 v[188:191], v7 offset:15360
    s_waitcnt vmcnt(5)
    s_waitcnt lgkmcnt(7)
    v_mfma_f32_32x32x16_bf16 v[64:79], v[48:51], v[136:139], v[64:79]
    ds_read_b128 v[48:51], v6 offset:3072
    v_add_f32 v192, v192, v196
    s_waitcnt lgkmcnt(7)
    v_mfma_f32_32x32x16_bf16 v[80:95], v[52:55], v[136:139], v[80:95]
    ds_read_b128 v[52:55], v6 offset:4096
    v_add_f32 v193, v193, v197
    v_add_f32 v194, v194, v198
    s_waitcnt lgkmcnt(7)
    v_mfma_f32_32x32x16_bf16 v[96:111], v[56:59], v[136:139], v[96:111]
    ds_read_b128 v[56:59], v6 offset:5120
    v_add_f32 v195, v195, v199
    v_add_f32 v192, v192, v194
    s_waitcnt lgkmcnt(7)
    v_mfma_f32_32x32x16_bf16 v[112:127], v[60:63], v[136:139], v[112:127]
    ds_read_b128 v[60:63], v7 offset:16128
    v_add_f32 v193, v193, v195
    v_add_f32 v192, v192, v193
    s_waitcnt vmcnt(4)
    s_waitcnt lgkmcnt(7)
    v_mfma_f32_32x32x16_bf16 v[64:79], v[176:179], v[140:143], v[64:79]
    ds_read_b128 v[176:179], v6 offset:6144
    v_mul_f32 v192, 0x3acccccd, v192
    v_mov_b32 v193, v192
    s_waitcnt lgkmcnt(7)
    v_mfma_f32_32x32x16_bf16 v[80:95], v[180:183], v[140:143], v[80:95]
    ds_read_b128 v[180:183], v6 offset:7168
    s_nop 1
    v_permlane32_swap_b32 v192, v193
    s_waitcnt lgkmcnt(7)
    v_mfma_f32_32x32x16_bf16 v[96:111], v[184:187], v[140:143], v[96:111]
    ds_read_b128 v[184:187], v6 offset:8192
    v_cmp_gt_u32 vcc, 32, v1
    v_fma_f32 v193, -v192, v192, v193
    s_waitcnt lgkmcnt(7)
    v_mfma_f32_32x32x16_bf16 v[112:127], v[188:191], v[140:143], v[112:127]
    ds_read_b128 v[188:191], v7 offset:16896
    v_max_f32 v193, 0, v193
    v_add_f32 v194, 0x3727c5ac, v193
    s_waitcnt vmcnt(3)
    s_waitcnt lgkmcnt(7)
    v_mfma_f32_32x32x16_bf16 v[64:79], v[48:51], v[144:147], v[64:79]
    ds_read_b128 v[48:51], v6 offset:9216
    v_rsq_f32 v16, v194
    v_sub_f32 v196, 0, v192
    s_waitcnt lgkmcnt(7)
    v_mfma_f32_32x32x16_bf16 v[80:95], v[52:55], v[144:147], v[80:95]
    ds_read_b128 v[52:55], v6 offset:10240
    v_mov_b32 v18, 0xffff0000
    v_and_b32 v197, 0xffff0000, v196
    s_waitcnt lgkmcnt(7)
    v_mfma_f32_32x32x16_bf16 v[96:111], v[56:59], v[144:147], v[96:111]
    ds_read_b128 v[56:59], v6 offset:11264
    v_sub_f32 v198, v196, v197
    v_lshrrev_b32 v197, 16, v197
    s_waitcnt lgkmcnt(7)
    v_mfma_f32_32x32x16_bf16 v[112:127], v[60:63], v[144:147], v[112:127]
    ds_read_b128 v[60:63], v7 offset:17664
    v_and_or_b32 v38, v198, v18, v197
    v_mov_b32 v39, v197
    s_waitcnt vmcnt(2)
    s_waitcnt lgkmcnt(7)
    v_mfma_f32_32x32x16_bf16 v[64:79], v[176:179], v[148:151], v[64:79]
    ds_read_b128 v[176:179], v6 offset:12288
    s_add_u32 s53, s56, 20480
    buffer_load_dwordx4 v[160:163], v2, s[4:7], s53 offen offset:0 sc1
    v_mul_f32 v20, v20, v16
    v_mul_f32 v22, v22, v16
    s_waitcnt lgkmcnt(7)
    v_mfma_f32_32x32x16_bf16 v[80:95], v[180:183], v[148:151], v[80:95]
    ds_read_b128 v[180:183], v6 offset:13312
    buffer_load_dwordx4 v[164:167], v2, s[4:7], s53 offen offset:1024 sc1
    v_mul_f32 v24, v24, v16
    s_waitcnt lgkmcnt(7)
    v_mfma_f32_32x32x16_bf16 v[96:111], v[184:187], v[148:151], v[96:111]
    ds_read_b128 v[184:187], v6 offset:14336
    s_waitcnt lgkmcnt(7)
    v_mfma_f32_32x32x16_bf16 v[112:127], v[188:191], v[148:151], v[112:127]
    ds_read_b128 v[188:191], v7 offset:18432
    s_waitcnt vmcnt(3)
    s_waitcnt lgkmcnt(7)
    v_mfma_f32_32x32x16_bf16 v[64:79], v[48:51], v[152:155], v[64:79]
    s_barrier
    v_add_u32 v6, 0, v9
    ds_read_b128 v[48:51], v6 offset:0
    buffer_load_dwordx4 v[168:171], v2, s[4:7], s53 offen offset:2048 sc1
    s_waitcnt lgkmcnt(7)
    v_mfma_f32_32x32x16_bf16 v[80:95], v[52:55], v[152:155], v[80:95]
    ds_read_b128 v[52:55], v6 offset:1024
    buffer_load_dwordx4 v[172:175], v2, s[4:7], s53 offen offset:3072 sc1
    s_waitcnt lgkmcnt(7)
    v_mfma_f32_32x32x16_bf16 v[96:111], v[56:59], v[152:155], v[96:111]
    ds_read_b128 v[56:59], v6 offset:2048
    s_waitcnt lgkmcnt(7)
    v_mfma_f32_32x32x16_bf16 v[112:127], v[60:63], v[152:155], v[112:127]
    v_add_u32 v7, 0, v10
    ds_read_b128 v[60:63], v7 offset:15360
    s_waitcnt vmcnt(4)
    s_waitcnt lgkmcnt(7)
    v_mfma_f32_32x32x16_bf16 v[64:79], v[176:179], v[156:159], v[64:79]
    ds_read_b128 v[176:179], v6 offset:3072
    s_add_u32 s53, s56, 24576
    buffer_load_dwordx4 v[128:131], v2, s[4:7], s53 offen offset:0 sc1
    v_mfma_f32_32x32x8_bf16 v[64:79], v[40:41], v[38:39], v[64:79]
    s_waitcnt lgkmcnt(7)
    v_mfma_f32_32x32x16_bf16 v[80:95], v[180:183], v[156:159], v[80:95]
    ds_read_b128 v[180:183], v6 offset:4096
    buffer_load_dwordx4 v[132:135], v2, s[4:7], s53 offen offset:1024 sc1
    v_mfma_f32_32x32x8_bf16 v[80:95], v[42:43], v[38:39], v[80:95]
    s_waitcnt lgkmcnt(7)
    v_mfma_f32_32x32x16_bf16 v[96:111], v[184:187], v[156:159], v[96:111]
    ds_read_b128 v[184:187], v6 offset:5120
    v_mfma_f32_32x32x8_bf16 v[96:111], v[44:45], v[38:39], v[96:111]
    s_waitcnt lgkmcnt(7)
    v_mfma_f32_32x32x16_bf16 v[112:127], v[188:191], v[156:159], v[112:127]
    ds_read_b128 v[188:191], v7 offset:16128
    v_mfma_f32_32x32x8_bf16 v[112:127], v[46:47], v[38:39], v[112:127]
    s_waitcnt vmcnt(5)
    s_waitcnt lgkmcnt(7)
    v_mfma_f32_32x32x16_bf16 v[64:79], v[48:51], v[160:163], v[64:79]
    ds_read_b128 v[48:51], v6 offset:6144
    buffer_load_dwordx4 v[136:139], v2, s[4:7], s53 offen offset:2048 sc1
    s_waitcnt lgkmcnt(7)
    v_mfma_f32_32x32x16_bf16 v[80:95], v[52:55], v[160:163], v[80:95]
    ds_read_b128 v[52:55], v6 offset:7168
    buffer_load_dwordx4 v[140:143], v2, s[4:7], s53 offen offset:3072 sc1
    s_waitcnt lgkmcnt(7)
    v_mfma_f32_32x32x16_bf16 v[96:111], v[56:59], v[160:163], v[96:111]
    ds_read_b128 v[56:59], v6 offset:8192
    s_waitcnt lgkmcnt(7)
    v_mfma_f32_32x32x16_bf16 v[112:127], v[60:63], v[160:163], v[112:127]
    ds_read_b128 v[60:63], v7 offset:16896
    s_waitcnt vmcnt(6)
    s_waitcnt lgkmcnt(7)
    v_mfma_f32_32x32x16_bf16 v[64:79], v[176:179], v[164:167], v[64:79]
    ds_read_b128 v[176:179], v6 offset:9216
    s_add_u32 s53, s56, 28672
    buffer_load_dwordx4 v[144:147], v2, s[4:7], s53 offen offset:0 sc1
    s_waitcnt lgkmcnt(7)
    v_mfma_f32_32x32x16_bf16 v[80:95], v[180:183], v[164:167], v[80:95]
    ds_read_b128 v[180:183], v6 offset:10240
    buffer_load_dwordx4 v[148:151], v2, s[4:7], s53 offen offset:1024 sc1
    s_waitcnt lgkmcnt(7)
    v_mfma_f32_32x32x16_bf16 v[96:111], v[184:187], v[164:167], v[96:111]
    ds_read_b128 v[184:187], v6 offset:11264
    s_waitcnt lgkmcnt(7)
    v_mfma_f32_32x32x16_bf16 v[112:127], v[188:191], v[164:167], v[112:127]
    ds_read_b128 v[188:191], v7 offset:17664
    s_waitcnt vmcnt(7)
    s_waitcnt lgkmcnt(7)
    v_mfma_f32_32x32x16_bf16 v[64:79], v[48:51], v[168:171], v[64:79]
    ds_read_b128 v[48:51], v6 offset:12288
    buffer_load_dwordx4 v[152:155], v2, s[4:7], s53 offen offset:2048 sc1
    s_waitcnt lgkmcnt(7)
    v_mfma_f32_32x32x16_bf16 v[80:95], v[52:55], v[168:171], v[80:95]
    ds_read_b128 v[52:55], v6 offset:13312
    buffer_load_dwordx4 v[156:159], v2, s[4:7], s53 offen offset:3072 sc1
    s_waitcnt lgkmcnt(7)
    v_mfma_f32_32x32x16_bf16 v[96:111], v[56:59], v[168:171], v[96:111]
    ds_read_b128 v[56:59], v6 offset:14336
    s_waitcnt lgkmcnt(7)
    v_mfma_f32_32x32x16_bf16 v[112:127], v[60:63], v[168:171], v[112:127]
    ds_read_b128 v[60:63], v7 offset:18432
    s_waitcnt vmcnt(8)
    s_waitcnt lgkmcnt(7)
    v_mfma_f32_32x32x16_bf16 v[64:79], v[176:179], v[172:175], v[64:79]
    s_barrier
    v_add_u32 v6, 20480, v9
    ds_read_b128 v[176:179], v6 offset:0
    s_add_u32 s53, s56, 32768
    buffer_load_dwordx4 v[160:163], v2, s[4:7], s53 offen offset:0 sc1
    s_waitcnt lgkmcnt(7)
    v_mfma_f32_32x32x16_bf16 v[80:95], v[180:183], v[172:175], v[80:95]
    ds_read_b128 v[180:183], v6 offset:1024
    buffer_load_dwordx4 v[164:167], v2, s[4:7], s53 offen offset:1024 sc1
    s_waitcnt lgkmcnt(7)
    v_mfma_f32_32x32x16_bf16 v[96:111], v[184:187], v[172:175], v[96:111]
    ds_read_b128 v[184:187], v6 offset:2048
    s_waitcnt lgkmcnt(7)
    v_mfma_f32_32x32x16_bf16 v[112:127], v[188:191], v[172:175], v[112:127]
    v_add_u32 v7, 20480, v10
    ds_read_b128 v[188:191], v7 offset:15360
    s_waitcnt vmcnt(9)
    s_waitcnt lgkmcnt(7)
    v_mfma_f32_32x32x16_bf16 v[64:79], v[48:51], v[128:131], v[64:79]
    ds_read_b128 v[48:51], v6 offset:3072
    buffer_load_dwordx4 v[168:171], v2, s[4:7], s53 offen offset:2048 sc1
    s_waitcnt lgkmcnt(7)
    v_mfma_f32_32x32x16_bf16 v[80:95], v[52:55], v[128:131], v[80:95]
    ds_read_b128 v[52:55], v6 offset:4096
    buffer_load_dwordx4 v[172:175], v2, s[4:7], s53 offen offset:3072 sc1
    s_waitcnt lgkmcnt(7)
    v_mfma_f32_32x32x16_bf16 v[96:111], v[56:59], v[128:131], v[96:111]
    ds_read_b128 v[56:59], v6 offset:5120
    s_waitcnt lgkmcnt(7)
    v_mfma_f32_32x32x16_bf16 v[112:127], v[60:63], v[128:131], v[112:127]
    ds_read_b128 v[60:63], v7 offset:16128
    s_waitcnt vmcnt(10)
    s_waitcnt lgkmcnt(7)
    v_mfma_f32_32x32x16_bf16 v[64:79], v[176:179], v[132:135], v[64:79]
    ds_read_b128 v[176:179], v6 offset:6144
    s_add_u32 s53, s56, 36864
    buffer_load_dwordx4 v[128:131], v2, s[4:7], s53 offen offset:0 sc1
    s_waitcnt lgkmcnt(7)
    v_mfma_f32_32x32x16_bf16 v[80:95], v[180:183], v[132:135], v[80:95]
    ds_read_b128 v[180:183], v6 offset:7168
    s_waitcnt lgkmcnt(7)
    v_mfma_f32_32x32x16_bf16 v[96:111], v[184:187], v[132:135], v[96:111]
    ds_read_b128 v[184:187], v6 offset:8192
    s_waitcnt lgkmcnt(7)
    v_mfma_f32_32x32x16_bf16 v[112:127], v[188:191], v[132:135], v[112:127]
    ds_read_b128 v[188:191], v7 offset:16896
    s_waitcnt vmcnt(10)
    s_waitcnt lgkmcnt(7)
    v_mfma_f32_32x32x16_bf16 v[64:79], v[48:51], v[136:139], v[64:79]
    ds_read_b128 v[48:51], v6 offset:9216
    buffer_load_dwordx4 v[132:135], v2, s[4:7], s53 offen offset:1024 sc1
    s_waitcnt lgkmcnt(7)
    v_mfma_f32_32x32x16_bf16 v[80:95], v[52:55], v[136:139], v[80:95]
    ds_read_b128 v[52:55], v6 offset:10240
    s_waitcnt lgkmcnt(7)
    v_mfma_f32_32x32x16_bf16 v[96:111], v[56:59], v[136:139], v[96:111]
    ds_read_b128 v[56:59], v6 offset:11264
    s_waitcnt lgkmcnt(7)
    v_mfma_f32_32x32x16_bf16 v[112:127], v[60:63], v[136:139], v[112:127]
    ds_read_b128 v[60:63], v7 offset:17664
    s_waitcnt vmcnt(10)
    s_waitcnt lgkmcnt(7)
    v_mfma_f32_32x32x16_bf16 v[64:79], v[176:179], v[140:143], v[64:79]
    ds_read_b128 v[176:179], v6 offset:12288
    buffer_load_dwordx4 v[136:139], v2, s[4:7], s53 offen offset:2048 sc1
    s_waitcnt lgkmcnt(7)
    v_mfma_f32_32x32x16_bf16 v[80:95], v[180:183], v[140:143], v[80:95]
    ds_read_b128 v[180:183], v6 offset:13312
    s_waitcnt lgkmcnt(7)
    v_mfma_f32_32x32x16_bf16 v[96:111], v[184:187], v[140:143], v[96:111]
    ds_read_b128 v[184:187], v6 offset:14336
    s_waitcnt lgkmcnt(7)
    v_mfma_f32_32x32x16_bf16 v[112:127], v[188:191], v[140:143], v[112:127]
    ds_read_b128 v[188:191], v7 offset:18432
    s_waitcnt vmcnt(10)
    s_waitcnt lgkmcnt(7)
    v_mfma_f32_32x32x16_bf16 v[64:79], v[48:51], v[144:147], v[64:79]
    v_add_u32 v6, 40960, v9
    ds_read_b128 v[48:51], v6 offset:0
    buffer_load_dwordx4 v[140:143], v2, s[4:7], s53 offen offset:3072 sc1
    s_waitcnt lgkmcnt(7)
    v_mfma_f32_32x32x16_bf16 v[80:95], v[52:55], v[144:147], v[80:95]
    ds_read_b128 v[52:55], v6 offset:1024
    s_waitcnt lgkmcnt(7)
    v_mfma_f32_32x32x16_bf16 v[96:111], v[56:59], v[144:147], v[96:111]
    ds_read_b128 v[56:59], v6 offset:2048
    s_waitcnt lgkmcnt(7)
    v_mfma_f32_32x32x16_bf16 v[112:127], v[60:63], v[144:147], v[112:127]
    v_add_u32 v7, 40960, v10
    ds_read_b128 v[60:63], v7 offset:15360
    s_waitcnt vmcnt(10)
    s_waitcnt lgkmcnt(7)
    v_mfma_f32_32x32x16_bf16 v[64:79], v[176:179], v[148:151], v[64:79]
    ds_read_b128 v[176:179], v6 offset:3072
    s_waitcnt lgkmcnt(7)
    v_mfma_f32_32x32x16_bf16 v[80:95], v[180:183], v[148:151], v[80:95]
    ds_read_b128 v[180:183], v6 offset:4096
    s_waitcnt lgkmcnt(7)
    v_mfma_f32_32x32x16_bf16 v[96:111], v[184:187], v[148:151], v[96:111]
    ds_read_b128 v[184:187], v6 offset:5120
    s_waitcnt lgkmcnt(7)
    v_mfma_f32_32x32x16_bf16 v[112:127], v[188:191], v[148:151], v[112:127]
    ds_read_b128 v[188:191], v7 offset:16128
    s_waitcnt vmcnt(9)
    s_waitcnt lgkmcnt(7)
    v_mfma_f32_32x32x16_bf16 v[64:79], v[48:51], v[152:155], v[64:79]
    ds_read_b128 v[48:51], v6 offset:6144
    s_waitcnt lgkmcnt(7)
    v_mfma_f32_32x32x16_bf16 v[80:95], v[52:55], v[152:155], v[80:95]
    ds_read_b128 v[52:55], v6 offset:9216
    s_waitcnt lgkmcnt(7)
    v_mfma_f32_32x32x16_bf16 v[96:111], v[56:59], v[152:155], v[96:111]
    ds_read_b128 v[56:59], v6 offset:12288
    s_waitcnt lgkmcnt(7)
    v_mfma_f32_32x32x16_bf16 v[112:127], v[60:63], v[152:155], v[112:127]
    v_add_u32 v6, 61440, v9
    ds_read_b128 v[60:63], v6 offset:0
    s_waitcnt vmcnt(8)
    s_waitcnt lgkmcnt(7)
    v_mfma_f32_32x32x16_bf16 v[64:79], v[176:179], v[156:159], v[64:79]
    ds_read_b128 v[176:179], v6 offset:3072
    s_waitcnt lgkmcnt(7)
    v_mfma_f32_32x32x16_bf16 v[80:95], v[180:183], v[156:159], v[80:95]
    ds_read_b128 v[180:183], v6 offset:6144
    s_waitcnt lgkmcnt(7)
    v_mfma_f32_32x32x16_bf16 v[96:111], v[184:187], v[156:159], v[96:111]
    ds_read_b128 v[184:187], v6 offset:9216
    s_waitcnt lgkmcnt(7)
    v_mfma_f32_32x32x16_bf16 v[112:127], v[188:191], v[156:159], v[112:127]
    ds_read_b128 v[188:191], v6 offset:12288
    s_waitcnt vmcnt(7)
    s_waitcnt lgkmcnt(7)
    v_mfma_f32_32x32x16_bf16 v[64:79], v[48:51], v[160:163], v[64:79]
    v_add_u32 v6, 40960, v9
    ds_read_b128 v[48:51], v6 offset:7168
    s_waitcnt vmcnt(6)
    s_waitcnt lgkmcnt(7)
    v_mfma_f32_32x32x16_bf16 v[64:79], v[52:55], v[164:167], v[64:79]
    ds_read_b128 v[52:55], v6 offset:10240
    s_waitcnt vmcnt(5)
    s_waitcnt lgkmcnt(7)
    v_mfma_f32_32x32x16_bf16 v[64:79], v[56:59], v[168:171], v[64:79]
    ds_read_b128 v[56:59], v6 offset:13312
    s_waitcnt vmcnt(4)
    s_waitcnt lgkmcnt(7)
    v_mfma_f32_32x32x16_bf16 v[64:79], v[60:63], v[172:175], v[64:79]
    v_add_u32 v6, 61440, v9
    ds_read_b128 v[60:63], v6 offset:1024
    s_waitcnt vmcnt(3)
    s_waitcnt lgkmcnt(7)
    v_mfma_f32_32x32x16_bf16 v[64:79], v[176:179], v[128:131], v[64:79]
    ds_read_b128 v[176:179], v6 offset:4096
    s_waitcnt vmcnt(2)
    s_waitcnt lgkmcnt(7)
    v_mfma_f32_32x32x16_bf16 v[64:79], v[180:183], v[132:135], v[64:79]
    ds_read_b128 v[180:183], v6 offset:7168
    s_waitcnt vmcnt(1)
    s_waitcnt lgkmcnt(7)
    v_mfma_f32_32x32x16_bf16 v[64:79], v[184:187], v[136:139], v[64:79]
    ds_read_b128 v[184:187], v6 offset:10240
    s_waitcnt vmcnt(0)
    s_waitcnt lgkmcnt(7)
    v_mfma_f32_32x32x16_bf16 v[64:79], v[188:191], v[140:143], v[64:79]
    ds_read_b128 v[188:191], v6 offset:13312
    s_waitcnt lgkmcnt(7)
    v_mfma_f32_32x32x16_bf16 v[80:95], v[48:51], v[160:163], v[80:95]
    v_add_u32 v6, 40960, v9
    ds_read_b128 v[48:51], v6 offset:8192
    s_waitcnt lgkmcnt(7)
    v_mfma_f32_32x32x16_bf16 v[80:95], v[52:55], v[164:167], v[80:95]
    ds_read_b128 v[52:55], v6 offset:11264
    s_waitcnt lgkmcnt(7)
    v_mfma_f32_32x32x16_bf16 v[80:95], v[56:59], v[168:171], v[80:95]
    ds_read_b128 v[56:59], v6 offset:14336
    s_waitcnt lgkmcnt(7)
    v_mfma_f32_32x32x16_bf16 v[80:95], v[60:63], v[172:175], v[80:95]
    v_add_u32 v6, 61440, v9
    ds_read_b128 v[60:63], v6 offset:2048
    v_mul_f32 v64, v64, v20
    v_mul_f32 v65, v65, v20
    v_cvt_pk_bf16_f32 v64, v64, v65
    s_waitcnt lgkmcnt(7)
    v_mfma_f32_32x32x16_bf16 v[80:95], v[176:179], v[128:131], v[80:95]
    ds_read_b128 v[176:179], v6 offset:5120
    v_mul_f32 v66, v66, v20
    v_mul_f32 v67, v67, v20
    v_cvt_pk_bf16_f32 v65, v66, v67
    s_waitcnt lgkmcnt(7)
    v_mfma_f32_32x32x16_bf16 v[80:95], v[180:183], v[132:135], v[80:95]
    ds_read_b128 v[180:183], v6 offset:8192
    v_mul_f32 v68, v68, v20
    v_mul_f32 v69, v69, v20
    v_cvt_pk_bf16_f32 v66, v68, v69
    s_waitcnt lgkmcnt(7)
    v_mfma_f32_32x32x16_bf16 v[80:95], v[184:187], v[136:139], v[80:95]
    ds_read_b128 v[184:187], v6 offset:11264
    v_mul_f32 v70, v70, v20
    v_mul_f32 v71, v71, v20
    v_cvt_pk_bf16_f32 v67, v70, v71
    s_waitcnt lgkmcnt(7)
    v_mfma_f32_32x32x16_bf16 v[80:95], v[188:191], v[140:143], v[80:95]
    ds_read_b128 v[188:191], v6 offset:14336
    buffer_store_dwordx4 v[64:67], v3, s[4:7], s85 offen sc0 sc1
    v_mul_f32 v72, v72, v20
    v_mul_f32 v73, v73, v20
    s_waitcnt lgkmcnt(7)
    v_mfma_f32_32x32x16_bf16 v[96:111], v[48:51], v[160:163], v[96:111]
    ds_read_b128 v[48:51], v7 offset:16896
    v_cvt_pk_bf16_f32 v72, v72, v73
    v_mul_f32 v74, v74, v20
    v_mul_f32 v75, v75, v20
    s_waitcnt lgkmcnt(7)
    v_mfma_f32_32x32x16_bf16 v[96:111], v[52:55], v[164:167], v[96:111]
    ds_read_b128 v[52:55], v7 offset:17664
    v_cvt_pk_bf16_f32 v73, v74, v75
    v_mul_f32 v76, v76, v20
    v_mul_f32 v77, v77, v20
    s_waitcnt lgkmcnt(7)
    v_mfma_f32_32x32x16_bf16 v[96:111], v[56:59], v[168:171], v[96:111]
    ds_read_b128 v[56:59], v7 offset:18432
    v_cvt_pk_bf16_f32 v74, v76, v77
    v_mul_f32 v78, v78, v20
    v_mul_f32 v79, v79, v20
    s_waitcnt lgkmcnt(7)
    v_mfma_f32_32x32x16_bf16 v[96:111], v[60:63], v[172:175], v[96:111]
    v_add_u32 v7, 61440, v10
    ds_read_b128 v[60:63], v7 offset:15360
    v_cvt_pk_bf16_f32 v75, v78, v79
    buffer_store_dwordx4 v[72:75], v3, s[4:7], s86 offen sc0 sc1
    v_mul_f32 v80, v80, v22
    s_waitcnt lgkmcnt(7)
    v_mfma_f32_32x32x16_bf16 v[96:111], v[176:179], v[128:131], v[96:111]
    ds_read_b128 v[176:179], v7 offset:16128
    v_mul_f32 v81, v81, v22
    v_cvt_pk_bf16_f32 v80, v80, v81
    v_mul_f32 v82, v82, v22
    s_waitcnt lgkmcnt(7)
    v_mfma_f32_32x32x16_bf16 v[96:111], v[180:183], v[132:135], v[96:111]
    ds_read_b128 v[180:183], v7 offset:16896
    v_mul_f32 v83, v83, v22
    v_cvt_pk_bf16_f32 v81, v82, v83
    v_mul_f32 v84, v84, v22
    s_waitcnt lgkmcnt(7)
    v_mfma_f32_32x32x16_bf16 v[96:111], v[184:187], v[136:139], v[96:111]
    ds_read_b128 v[184:187], v7 offset:17664
    v_mul_f32 v85, v85, v22
    v_cvt_pk_bf16_f32 v82, v84, v85
    v_mul_f32 v86, v86, v22
    s_waitcnt lgkmcnt(7)
    v_mfma_f32_32x32x16_bf16 v[96:111], v[188:191], v[140:143], v[96:111]
    ds_read_b128 v[188:191], v7 offset:18432
    v_mul_f32 v87, v87, v22
    v_cvt_pk_bf16_f32 v83, v86, v87
    buffer_store_dwordx4 v[80:83], v3, s[4:7], s89 offen sc0 sc1
    s_waitcnt lgkmcnt(7)
    v_mfma_f32_32x32x16_bf16 v[112:127], v[48:51], v[160:163], v[112:127]
    v_mul_f32 v88, v88, v22
    v_mul_f32 v89, v89, v22
    v_cvt_pk_bf16_f32 v88, v88, v89
    s_waitcnt lgkmcnt(6)
    v_mfma_f32_32x32x16_bf16 v[112:127], v[52:55], v[164:167], v[112:127]
    v_mul_f32 v90, v90, v22
    v_mul_f32 v91, v91, v22
    v_cvt_pk_bf16_f32 v89, v90, v91
    s_waitcnt lgkmcnt(5)
    v_mfma_f32_32x32x16_bf16 v[112:127], v[56:59], v[168:171], v[112:127]
    v_mul_f32 v92, v92, v22
    v_mul_f32 v93, v93, v22
    v_cvt_pk_bf16_f32 v90, v92, v93
    s_waitcnt lgkmcnt(4)
    v_mfma_f32_32x32x16_bf16 v[112:127], v[60:63], v[172:175], v[112:127]
    v_mul_f32 v94, v94, v22
    v_mul_f32 v95, v95, v22
    v_cvt_pk_bf16_f32 v91, v94, v95
    s_waitcnt lgkmcnt(3)
    v_mfma_f32_32x32x16_bf16 v[112:127], v[176:179], v[128:131], v[112:127]
    buffer_store_dwordx4 v[88:91], v3, s[4:7], s90 offen sc0 sc1
    v_mul_f32 v96, v96, v24
    v_mul_f32 v97, v97, v24
    s_waitcnt lgkmcnt(2)
    v_mfma_f32_32x32x16_bf16 v[112:127], v[180:183], v[132:135], v[112:127]
    v_cvt_pk_bf16_f32 v96, v96, v97
    v_mul_f32 v98, v98, v24
    v_mul_f32 v99, v99, v24
    s_waitcnt lgkmcnt(1)
    v_mfma_f32_32x32x16_bf16 v[112:127], v[184:187], v[136:139], v[112:127]
    v_cvt_pk_bf16_f32 v97, v98, v99
    v_mul_f32 v100, v100, v24
    v_mul_f32 v101, v101, v24
    s_waitcnt lgkmcnt(0)
    v_mfma_f32_32x32x16_bf16 v[112:127], v[188:191], v[140:143], v[112:127]
    v_cvt_pk_bf16_f32 v98, v100, v101
    v_mul_f32 v102, v102, v24
    v_mul_f32 v103, v103, v24
    v_cvt_pk_bf16_f32 v99, v102, v103
    buffer_store_dwordx4 v[96:99], v3, s[4:7], s93 offen sc0 sc1
    v_mul_f32 v104, v104, v24
    v_mul_f32 v105, v105, v24
    v_cvt_pk_bf16_f32 v104, v104, v105
    v_mul_f32 v106, v106, v24
    v_mul_f32 v107, v107, v24
    v_cvt_pk_bf16_f32 v105, v106, v107
    v_mul_f32 v108, v108, v24
    v_mul_f32 v109, v109, v24
    v_cvt_pk_bf16_f32 v106, v108, v109
    v_mul_f32 v110, v110, v24
    v_mul_f32 v111, v111, v24
    v_cvt_pk_bf16_f32 v107, v110, v111
    buffer_store_dwordx4 v[104:107], v3, s[4:7], s94 offen sc0 sc1
    v_pk_mul_f32 v[112:113], v[112:113], v[20:21] op_sel_hi:[1,0]
    v_pk_mul_f32 v[114:115], v[114:115], v[20:21] op_sel_hi:[1,0]
    v_cvt_pk_bf16_f32 v112, v112, v113
    v_cvt_pk_bf16_f32 v113, v114, v115
    buffer_store_dwordx2 v[112:113], v26, s[4:7], s87 offen sc0 sc1
    v_pk_mul_f32 v[116:117], v[116:117], v[22:23] op_sel_hi:[1,0]
    v_pk_mul_f32 v[118:119], v[118:119], v[22:23] op_sel_hi:[1,0]
    v_cvt_pk_bf16_f32 v116, v116, v117
    v_cvt_pk_bf16_f32 v117, v118, v119
    buffer_store_dwordx2 v[116:117], v27, s[4:7], s91 offen sc0 sc1
    v_pk_mul_f32 v[120:121], v[120:121], v[24:25] op_sel_hi:[1,0]
    v_pk_mul_f32 v[122:123], v[122:123], v[24:25] op_sel_hi:[1,0]
    v_cvt_pk_bf16_f32 v120, v120, v121
    v_cvt_pk_bf16_f32 v121, v122, v123
    buffer_store_dwordx2 v[120:121], v28, s[4:7], s95 offen sc0 sc1
    s_lshl3_add_u32 s51, s17, s40
    s_lshr_b32 s24, s51, 2
    s_lshl_b32 s24, s24, 7
    s_and_b32 s50, s51, 3
    s_lshl2_add_u32 s24, s50, s24
    s_lshl_b32 s50, s36, 11
    s_add_u32 s24, s24, s50
    s_add_u32 s24, s24, 98304
    s_lshl_b32 s29, s40, 7
    s_lshl2_add_u32 s29, s36, s29
    s_add_u32 s29, s29, s23
    s_add_u32 s29, s29, 7168
L_next:
    s_mov_b32 s25, 1
    s_branch L_layer
L_done:
L_end:
    s_endpgm
L_fin_100:
    buffer_store_dwordx4 v[112:115], v23, s[8:11], s88 offen
    s_waitcnt lgkmcnt(1)
    v_pk_add_f32 v[216:217], v[216:217], v[236:237]
    v_pk_add_f32 v[218:219], v[218:219], v[238:239]
    v_pk_add_f32 v[220:221], v[220:221], v[240:241]
    v_pk_add_f32 v[222:223], v[222:223], v[242:243]
    v_cvt_pk_bf16_f32 v116, v216, v217
    v_cvt_pk_bf16_f32 v117, v218, v219
    v_cvt_pk_bf16_f32 v118, v220, v221
    v_cvt_pk_bf16_f32 v119, v222, v223
    buffer_store_dwordx4 v[116:119], v23, s[8:11], s88 offen offset:64
    s_waitcnt lgkmcnt(0)
    v_pk_add_f32 v[224:225], v[224:225], v[244:245]
    v_pk_add_f32 v[226:227], v[226:227], v[246:247]
    v_cvt_pk_bf16_f32 v120, v224, v225
    v_cvt_pk_bf16_f32 v121, v226, v227
    buffer_store_dwordx2 v[120:121], v34, s[8:11], s88 offen offset:128
    s_branch L_done
L_att_fallback:
    s_waitcnt vmcnt(0) lgkmcnt(0)
    s_mul_i32 s57, s18, 163840
    s_add_u32 s57, s57, s20
    v_cmp_gt_u32 vcc, 32, v1
    v_mov_b32 v12, 0
    s_nop 0
    v_cndmask_b32 v20, v12, v20, vcc
    v_cndmask_b32 v21, v12, v21, vcc
    v_lshlrev_b32 v7, 30, v5
    v_add_u32 v7, v7, v101
    v_mov_b32 v22, 0xff800000
    s_mov_b32 s58, s57
    s_mov_b32 s59, 64
L_fb_max:
    buffer_load_dwordx4 v[24:27], v100, s[4:7], s58 offen
    buffer_load_dwordx2 v[28:29], v7, s[4:7], s58 offen
    s_waitcnt vmcnt(0)
    v_mfma_f32_32x32x16_bf16 v[52:67], v[24:27], v[16:19], 0
    v_mfma_f32_32x32x8_bf16 v[52:67], v[28:29], v[20:21], v[52:67]
    s_nop 15
    v_max3_f32 v22, v22, v52, v53
    v_max3_f32 v22, v22, v54, v55
    v_max3_f32 v22, v22, v56, v57
    v_max3_f32 v22, v22, v58, v59
    v_max3_f32 v22, v22, v60, v61
    v_max3_f32 v22, v22, v62, v63
    v_max3_f32 v22, v22, v64, v65
    v_max3_f32 v22, v22, v66, v67
    s_add_u32 s58, s58, 2560
    s_sub_u32 s59, s59, 1
    s_cmp_lg_u32 s59, 0
    s_cbranch_scc1 L_fb_max
    v_mov_b32 v12, v22
    s_nop 1
    v_permlane32_swap_b32 v22, v12
    s_nop 1
    v_max_f32 v22, v22, v12
    v_sub_f32 v12, 0, v22
    v_and_b32 v13, 0xffff0000, v12
    v_sub_f32 v12, v12, v13
    v_and_b32 v14, 0xffff0000, v12
    v_sub_f32 v12, v12, v14
    v_lshrrev_b32 v13, 16, v13
    v_cmp_gt_u32 vcc, 32, v1
    v_or_b32 v13, v13, v14
    v_lshrrev_b32 v12, 16, v12
    v_cndmask_b32 v20, v13, v20, vcc
    v_cndmask_b32 v21, v12, v21, vcc
    s_mul_i32 s58, s16, 2560
    s_add_u32 s58, s58, 142848
    v_mad_u32_u24 v8, s58, v107, v102
    v_mad_u32_u24 v9, s58, v107, v103
    v_mad_u32_u24 v10, s58, v107, v104
    v_mad_u32_u24 v11, s58, v107, v105
    v_add_u32 v6, s58, v2
    v_lshlrev_b32 v68, 3, v1
    v_add_u32 v69, s58, v68
    s_mov_b32 s58, s57
    s_mov_b32 s59, 64
    v_mov_b32 v84, 0
    v_mov_b32 v85, 0
    v_mov_b32 v86, 0
    v_mov_b32 v87, 0
    v_mov_b32 v88, 0
    v_mov_b32 v89, 0
    v_mov_b32 v90, 0
    v_mov_b32 v91, 0
    v_mov_b32 v92, 0
    v_mov_b32 v93, 0
    v_mov_b32 v94, 0
    v_mov_b32 v95, 0
    v_mov_b32 v96, 0
    v_mov_b32 v97, 0
    v_mov_b32 v98, 0
    v_mov_b32 v99, 0
L_fb_pv:
    buffer_load_dwordx4 v[24:27], v100, s[4:7], s58 offen
    buffer_load_dwordx2 v[28:29], v7, s[4:7], s58 offen
    buffer_load_dwordx4 v[32:35], v2, s[4:7], s58 offen offset:1024
    buffer_load_dwordx2 v[36:37], v68, s[4:7], s58 offen offset:2048
    v_cmp_gt_u32 vcc, 32, v1
    v_mov_b32 v12, 0x3f803f80
    s_waitcnt vmcnt(0)
    v_cndmask_b32 v28, v12, v28, vcc
    v_cndmask_b32 v29, v12, v29, vcc
    ds_write_b128 v6, v[32:35] offset:1024
    ds_write_b64 v69, v[36:37] offset:2048
    v_mfma_f32_32x32x16_bf16 v[52:67], v[24:27], v[16:19], 0
    v_mfma_f32_32x32x8_bf16 v[52:67], v[28:29], v[20:21], v[52:67]
    s_waitcnt lgkmcnt(0)
    ds_read_b64_tr_b16 v[32:33], v8
    ds_read_b64_tr_b16 v[34:35], v9
    ds_read_b64_tr_b16 v[36:37], v10
    ds_read_b64_tr_b16 v[38:39], v11
    s_nop 12
    v_exp_f32 v52, v52
    v_exp_f32 v53, v53
    v_exp_f32 v54, v54
    v_exp_f32 v55, v55
    v_exp_f32 v56, v56
    v_exp_f32 v57, v57
    v_exp_f32 v58, v58
    v_exp_f32 v59, v59
    v_exp_f32 v60, v60
    v_exp_f32 v61, v61
    v_exp_f32 v62, v62
    v_exp_f32 v63, v63
    v_exp_f32 v64, v64
    v_exp_f32 v65, v65
    v_exp_f32 v66, v66
    v_exp_f32 v67, v67
    s_nop 0
    v_cvt_pk_bf16_f32 v44, v52, v53
    v_cvt_pk_bf16_f32 v45, v54, v55
    v_cvt_pk_bf16_f32 v46, v56, v57
    v_cvt_pk_bf16_f32 v47, v58, v59
    v_cvt_pk_bf16_f32 v48, v60, v61
    v_cvt_pk_bf16_f32 v49, v62, v63
    v_cvt_pk_bf16_f32 v50, v64, v65
    v_cvt_pk_bf16_f32 v51, v66, v67
    s_waitcnt lgkmcnt(0)
    s_nop 1
    v_mfma_f32_32x32x16_bf16 v[84:99], v[32:35], v[44:47], v[84:99]
    v_mfma_f32_32x32x16_bf16 v[84:99], v[36:39], v[48:51], v[84:99]
    s_add_u32 s58, s58, 2560
    s_sub_u32 s59, s59, 1
    s_cmp_lg_u32 s59, 0
    s_cbranch_scc1 L_fb_pv
    s_nop 15
    s_branch L_att_fin
L_ool_11:
    s_lshl_b32 s54, s54, 3
    s_mov_b32 s55, 0x100000
L_kp_14:
    s_waitcnt vmcnt(0)
    v_and_b32 v252, v252, v253
    v_cmp_ne_u32 s[52:53], 0, v252
    s_cmp_eq_u64 s[52:53], -1
    s_cselect_b32 s29, 1, 0
    s_lshr_b64 s[52:53], s[52:53], s54
    s_and_b32 s52, s52, 0xff
    s_cmp_eq_u32 s52, 0xff
    s_cbranch_scc1 L_kc_13
    s_sub_u32 s55, s55, 1
    s_cbranch_scc1 L_kc_13
    buffer_load_dword v252, v108, s[4:7], s95 offen sc1
    buffer_load_dword v253, v108, s[4:7], s97 offen sc1
    s_branch L_kp_14
L_kc_13:
    s_branch L_back_12
L_ool_15:
    buffer_load_dword v252, v108, s[4:7], s95 offen sc1
    buffer_load_dword v253, v108, s[4:7], s97 offen sc1
    s_branch L_back_16
L_ool_17:
    s_lshl_b32 s54, s54, 3
    s_mov_b32 s55, 0x100000
L_kp_20:
    s_waitcnt vmcnt(0)
    v_and_b32 v252, v252, v253
    v_cmp_ne_u32 s[52:53], 0, v252
    s_cmp_eq_u64 s[52:53], -1
    s_cselect_b32 s29, 1, 0
    s_lshr_b64 s[52:53], s[52:53], s54
    s_and_b32 s52, s52, 0xff
    s_cmp_eq_u32 s52, 0xff
    s_cbranch_scc1 L_kc_19
    s_sub_u32 s55, s55, 1
    s_cbranch_scc1 L_kc_19
    buffer_load_dword v252, v108, s[4:7], s95 offen sc1
    buffer_load_dword v253, v108, s[4:7], s97 offen sc1
    s_branch L_kp_20
L_kc_19:
    s_branch L_back_18
L_ool_21:
    s_cmp_eq_u32 s28, 2
    s_cbranch_scc1 L_e2_23
    s_add_u32 s51, s86, s85
    buffer_load_dwordx4 v[208:211], v168, s[8:11], s86 offen
    buffer_load_dwordx4 v[212:215], v168, s[8:11], s51 offen
    s_add_u32 s86, s86, s84
    s_branch L_ee_24
L_e2_23:
    s_add_u32 s51, s86, s85
    buffer_load_dwordx2 v[208:209], v168, s[8:11], s86 offen
    buffer_load_dwordx2 v[210:211], v168, s[8:11], s51 offen
    s_add_u32 s86, s86, s84
    s_add_u32 s51, s86, s85
    buffer_load_dwordx2 v[212:213], v168, s[8:11], s86 offen
    buffer_load_dwordx2 v[214:215], v168, s[8:11], s51 offen
    s_add_u32 s86, s86, s84
L_ee_24:
    s_branch L_back_22
L_ool_25:
    s_cmp_eq_u32 s28, 2
    s_cbranch_scc1 L_e2_27
    s_add_u32 s51, s86, s85
    buffer_load_dwordx4 v[216:219], v168, s[8:11], s86 offen
    buffer_load_dwordx4 v[220:223], v168, s[8:11], s51 offen
    s_add_u32 s86, s86, s84
    s_branch L_ee_28
L_e2_27:
    s_add_u32 s51, s86, s85
    buffer_load_dwordx2 v[216:217], v168, s[8:11], s86 offen
    buffer_load_dwordx2 v[218:219], v168, s[8:11], s51 offen
    s_add_u32 s86, s86, s84
    s_add_u32 s51, s86, s85
    buffer_load_dwordx2 v[220:221], v168, s[8:11], s86 offen
    buffer_load_dwordx2 v[222:223], v168, s[8:11], s51 offen
    s_add_u32 s86, s86, s84
L_ee_28:
    s_branch L_back_26
L_ool_29:
    s_add_u32 s51, s86, s85
    buffer_load_dwordx2 v[224:225], v168, s[8:11], s86 offen
    buffer_load_dwordx2 v[226:227], v168, s[8:11], s51 offen
    s_add_u32 s86, s86, s84
    s_add_u32 s51, s86, s85
    buffer_load_dwordx2 v[228:229], v168, s[8:11], s86 offen
    buffer_load_dwordx2 v[230:231], v168, s[8:11], s51 offen
    s_add_u32 s86, s86, s84
    s_branch L_back_30
L_ool_31:
    s_add_u32 s51, s86, s85
    buffer_load_dwordx2 v[232:233], v168, s[8:11], s86 offen
    buffer_load_dwordx2 v[234:235], v168, s[8:11], s51 offen
    s_add_u32 s86, s86, s84
    s_add_u32 s51, s86, s85
    buffer_load_dwordx2 v[236:237], v168, s[8:11], s86 offen
    buffer_load_dwordx2 v[238:239], v168, s[8:11], s51 offen
    s_add_u32 s86, s86, s84
    s_branch L_back_32
L_ool_33:
    buffer_load_dword v252, v108, s[4:7], s95 offen sc1
    buffer_load_dword v253, v108, s[4:7], s97 offen sc1
    s_branch L_back_34
L_ool_35:
    s_add_u32 s51, s86, s85
    buffer_load_dwordx2 v[240:241], v168, s[8:11], s86 offen
    buffer_load_dwordx2 v[242:243], v168, s[8:11], s51 offen
    s_add_u32 s86, s86, s84
    s_add_u32 s51, s86, s85
    buffer_load_dwordx2 v[244:245], v168, s[8:11], s86 offen
    buffer_load_dwordx2 v[246:247], v168, s[8:11], s51 offen
    s_add_u32 s86, s86, s84
    s_branch L_back_36
L_ool_37:
    s_lshl_b32 s54, s54, 3
    s_mov_b32 s55, 0x100000
L_kp_40:
    s_waitcnt vmcnt(0)
    v_and_b32 v252, v252, v253
    v_cmp_ne_u32 s[52:53], 0, v252
    s_cmp_eq_u64 s[52:53], -1
    s_cselect_b32 s29, 1, 0
    s_lshr_b64 s[52:53], s[52:53], s54
    s_and_b32 s52, s52, 0xff
    s_cmp_eq_u32 s52, 0xff
    s_cbranch_scc1 L_kc_39
    s_sub_u32 s55, s55, 1
    s_cbranch_scc1 L_kc_39
    buffer_load_dword v252, v108, s[4:7], s95 offen sc1
    buffer_load_dword v253, v108, s[4:7], s97 offen sc1
    s_branch L_kp_40
L_kc_39:
    s_branch L_back_38
L_ool_41:
    s_cmp_eq_u32 s28, 2
    s_cbranch_scc1 L_e2_43
    s_waitcnt vmcnt(0)
    ds_write_b64 v171, v[208:209] offset:0
    ds_write_b64 v171, v[212:213] offset:512
    ds_write_b64 v171, v[210:211] offset:1024
    ds_write_b64 v171, v[214:215] offset:1536
    ds_write_b64 v171, v[216:217] offset:2048
    ds_write_b64 v171, v[220:221] offset:2560
    ds_write_b64 v171, v[218:219] offset:3072
    ds_write_b64 v171, v[222:223] offset:3584
    s_branch L_ee_44
L_e2_43:
    s_waitcnt vmcnt(0)
    ds_write_b64 v171, v[208:209] offset:0
    ds_write_b64 v171, v[210:211] offset:512
    ds_write_b64 v171, v[212:213] offset:1024
    ds_write_b64 v171, v[214:215] offset:1536
    ds_write_b64 v171, v[216:217] offset:2048
    ds_write_b64 v171, v[218:219] offset:2560
    ds_write_b64 v171, v[220:221] offset:3072
    ds_write_b64 v171, v[222:223] offset:3584
L_ee_44:
    s_branch L_back_42
L_ool_45:
    ds_read_b64_tr_b16 v[208:209], v171 offset:0
    ds_read_b64_tr_b16 v[210:211], v171 offset:512
    ds_read_b64_tr_b16 v[212:213], v171 offset:1024
    ds_read_b64_tr_b16 v[214:215], v171 offset:1536
    ds_read_b64_tr_b16 v[216:217], v171 offset:2048
    ds_read_b64_tr_b16 v[218:219], v171 offset:2560
    ds_read_b64_tr_b16 v[220:221], v171 offset:3072
    ds_read_b64_tr_b16 v[222:223], v171 offset:3584
    s_cmp_eq_u32 s28, 1
    s_cbranch_scc1 L_st_47
    ds_write_b64 v171, v[224:225] offset:4096
    ds_write_b64 v171, v[226:227] offset:4608
    ds_write_b64 v171, v[228:229] offset:5120
    ds_write_b64 v171, v[230:231] offset:5632
    ds_write_b64 v171, v[232:233] offset:6144
    ds_write_b64 v171, v[234:235] offset:6656
L_st_47:
    s_branch L_back_46
L_ool_48:
    buffer_store_dwordx4 v[208:211], v169, s[4:7], s87 offen sc0 sc1
    s_add_u32 s87, s87, s94
    buffer_store_dwordx4 v[212:215], v169, s[4:7], s87 offen sc0 sc1
    s_add_u32 s87, s87, s88
    buffer_store_dwordx4 v[216:219], v169, s[4:7], s87 offen sc0 sc1
    s_add_u32 s87, s87, s94
    buffer_store_dwordx4 v[220:223], v169, s[4:7], s87 offen sc0 sc1
    s_add_u32 s87, s87, s88
    s_cmp_eq_u32 s28, 1
    s_cbranch_scc1 L_st_50
    ds_write_b64 v171, v[236:237] offset:0
    ds_write_b64 v171, v[238:239] offset:512
    ds_write_b64 v171, v[240:241] offset:1024
    ds_write_b64 v171, v[242:243] offset:1536
    ds_write_b64 v171, v[244:245] offset:2048
    ds_write_b64 v171, v[246:247] offset:2560
    ds_read_b64_tr_b16 v[224:225], v171 offset:4096
    ds_read_b64_tr_b16 v[226:227], v171 offset:4608
    ds_read_b64_tr_b16 v[228:229], v171 offset:5120
    ds_read_b64_tr_b16 v[230:231], v171 offset:5632
    ds_read_b64_tr_b16 v[232:233], v171 offset:6144
    ds_read_b64_tr_b16 v[234:235], v171 offset:6656
L_st_50:
    s_branch L_back_49
L_ool_51:
    ds_read_b64_tr_b16 v[236:237], v171 offset:0
    ds_read_b64_tr_b16 v[238:239], v171 offset:512
    ds_read_b64_tr_b16 v[240:241], v171 offset:1024
    ds_read_b64_tr_b16 v[242:243], v171 offset:1536
    ds_read_b64_tr_b16 v[244:245], v171 offset:2048
    ds_read_b64_tr_b16 v[246:247], v171 offset:2560
    buffer_store_dwordx4 v[224:227], v169, s[4:7], s87 offen sc0 sc1
    s_add_u32 s87, s87, s94
    buffer_store_dwordx4 v[228:231], v169, s[4:7], s87 offen sc0 sc1
    s_add_u32 s87, s87, s88
    buffer_store_dwordx4 v[232:235], v169, s[4:7], s87 offen sc0 sc1
    s_add_u32 s87, s87, s94
    v_mfma_f32_32x32x16_bf16 v[176:191], v[172:175], v[208:211], 0
    v_mfma_f32_32x32x16_bf16 v[176:191], v[172:175], v[212:215], v[176:191]
    v_mfma_f32_32x32x16_bf16 v[176:191], v[172:175], v[216:219], v[176:191]
    s_branch L_back_52
L_ool_53:
    buffer_store_dwordx4 v[236:239], v169, s[4:7], s87 offen sc0 sc1
    s_add_u32 s87, s87, s88
    buffer_store_dwordx4 v[240:243], v169, s[4:7], s87 offen sc0 sc1
    s_add_u32 s87, s87, s94
    buffer_store_dwordx4 v[244:247], v169, s[4:7], s87 offen sc0 sc1
    s_add_u32 s87, s87, s88
    v_mfma_f32_32x32x16_bf16 v[176:191], v[172:175], v[220:223], v[176:191]
    v_mfma_f32_32x32x16_bf16 v[176:191], v[172:175], v[224:227], v[176:191]
    v_mfma_f32_32x32x16_bf16 v[176:191], v[172:175], v[228:231], v[176:191]
    s_branch L_back_54
L_ool_55:
    v_mfma_f32_32x32x16_bf16 v[176:191], v[172:175], v[232:235], v[176:191]
    v_mfma_f32_32x32x16_bf16 v[176:191], v[172:175], v[236:239], v[176:191]
    v_mfma_f32_32x32x16_bf16 v[176:191], v[172:175], v[240:243], v[176:191]
    v_mfma_f32_32x32x16_bf16 v[176:191], v[172:175], v[244:247], v[176:191]
    s_branch L_back_56
L_ool_57:
    buffer_load_dword v252, v108, s[4:7], s95 offen sc1
    buffer_load_dword v253, v108, s[4:7], s97 offen sc1
    s_branch L_back_58
L_ool_59:
    s_cmp_ge_u32 s42, 2
    s_cselect_b32 s50, -1, 0
    v_and_b32 v177, 0xffff0000, v176
    v_sub_f32 v179, v176, v177
    v_lshrrev_b32 v178, 16, v177
    v_or_b32 v178, v178, v177
    v_lshrrev_b32 v179, 16, v179
    v_and_b32 v170, s50, v170
    v_lshl_or_b32 v179, v170, 16, v179
    v_lshlrev_b32 v176, 30, v5
    v_add_u32 v176, v176, v2
    buffer_store_dwordx2 v[178:179], v176, s[4:7], s89 offen sc0 sc1
    s_branch L_back_60
L_ool_61:
    s_lshl_b32 s50, s2, 2
    s_add_u32 s50, s50, 0
    s_mov_b64 exec, 1
    buffer_store_dword v106, v2, s[4:7], s50 offen sc0 sc1
    s_mov_b64 exec, -1
    s_branch L_back_62
L_ool_63:
    s_lshl_b32 s54, s54, 3
    s_mov_b32 s55, 0x100000
L_kp_66:
    s_waitcnt vmcnt(0)
    v_and_b32 v252, v252, v253
    v_cmp_ne_u32 s[52:53], 0, v252
    s_cmp_eq_u64 s[52:53], -1
    s_cselect_b32 s29, 1, 0
    s_lshr_b64 s[52:53], s[52:53], s54
    s_and_b32 s52, s52, 0xff
    s_cmp_eq_u32 s52, 0xff
    s_cbranch_scc1 L_kc_65
    s_sub_u32 s55, s55, 1
    s_cbranch_scc1 L_kc_65
    buffer_load_dword v252, v108, s[4:7], s95 offen sc1
    buffer_load_dword v253, v108, s[4:7], s97 offen sc1
    s_branch L_kp_66
L_kc_65:
    s_branch L_back_64
L_ool_67:
    s_mov_b32 s51, 0x100000
L_pp_70:
    buffer_load_dwordx4 v[252:255], v2, s[4:7], 0 offen sc1
    s_sub_u32 s51, s51, 1
    s_cbranch_scc1 L_pd_69
    s_waitcnt vmcnt(0)
    v_and_b32 v252, v252, v253
    v_and_b32 v254, v254, v255
    v_and_b32 v252, v252, v254
    v_cmp_eq_u32 vcc, 0, v252
    s_cbranch_vccnz L_pp_70
L_pd_69:
    s_branch L_back_68
L_ool_71:
    buffer_load_dword v252, v108, s[4:7], s95 offen sc1
    buffer_load_dword v253, v108, s[4:7], s97 offen sc1
    s_branch L_back_72
L_ool_73:
    s_lshl_b32 s54, s54, 3
    s_mov_b32 s55, 0x100000
L_kp_76:
    s_waitcnt vmcnt(0)
    v_and_b32 v252, v252, v253
    v_cmp_ne_u32 s[52:53], 0, v252
    s_cmp_eq_u64 s[52:53], -1
    s_cselect_b32 s29, 1, 0
    s_lshr_b64 s[52:53], s[52:53], s54
    s_and_b32 s52, s52, 0xff
    s_cmp_eq_u32 s52, 0xff
    s_cbranch_scc1 L_kc_75
    s_sub_u32 s55, s55, 1
    s_cbranch_scc1 L_kc_75
    buffer_load_dword v252, v108, s[4:7], s95 offen sc1
    buffer_load_dword v253, v108, s[4:7], s97 offen sc1
    s_branch L_kp_76
L_kc_75:
    s_branch L_back_74
L_ool_77:
    s_lshl_b32 s40, s35, 1
    s_add_u32 s40, s40, s39
    s_mov_b32 s8, s90
    s_and_b32 s9, s91, 0xffff
    s_mov_b32 s10, 2621440
    s_mov_b32 s11, 0x20000
    s_lshl3_add_u32 s50, s17, s40
    s_mul_i32 s50, s50, 40960
    s_mul_i32 s51, s34, 160
    s_add_u32 s50, s50, s51
    s_lshl_b32 s51, s38, 4
    v_and_b32 v111, 15, v1
    v_add_u32 v111, s51, v111
    v_mul_u32_u24 v111, 1280, v111
    v_lshrrev_b32 v30, 4, v1
    v_lshl_add_u32 v31, v30, 3, v111
    v_lshl_add_u32 v111, v30, 4, v111
    buffer_load_dwordx4 v[112:115], v111, s[8:11], s50 offen
    buffer_load_dwordx4 v[116:119], v111, s[8:11], s50 offen offset:64
    buffer_load_dwordx2 v[120:121], v31, s[8:11], s50 offen offset:128
    s_mov_b32 s40, s16
    s_branch L_back_78
L_pubslow_81:
    s_waitcnt vmcnt(0)
    buffer_wbl2 sc1
    s_waitcnt vmcnt(0)
    s_mov_b64 exec, 1
    buffer_store_dword v13, v2, s[4:7], s55 offen offset:0 sc1
    s_branch L_pubdone_82
L_ool_85:
    buffer_inv sc1
    s_waitcnt vmcnt(0)
    s_branch L_back_86
L_pubslow_88:
    s_waitcnt vmcnt(0)
    buffer_wbl2 sc1
    s_waitcnt vmcnt(0)
    s_mov_b64 exec, 1
    buffer_store_dword v13, v2, s[4:7], s55 offen offset:1024 sc1
    s_branch L_pubdone_89
L_ool_92:
    buffer_inv sc1
    s_waitcnt vmcnt(0)
    s_branch L_back_93
L_pubslow_94:
    s_waitcnt vmcnt(0)
    buffer_wbl2 sc1
    s_waitcnt vmcnt(0)
    s_mov_b64 exec, 1
    buffer_store_dword v13, v2, s[4:7], s55 offen offset:2048 sc1
    s_branch L_pubdone_95
L_ool_98:
    buffer_inv sc1
    s_waitcnt vmcnt(0)
    s_branch L_back_99
L_pubslow_101:
    s_waitcnt vmcnt(0)
    buffer_wbl2 sc1
    s_waitcnt vmcnt(0)
    s_mov_b64 exec, 1
    buffer_store_dword v13, v2, s[4:7], s55 offen offset:3072 sc1
    s_branch L_pubdone_102
L_ool_105:
    buffer_inv sc1
    s_waitcnt vmcnt(0)
    s_branch L_back_106
L_loader_main:
    s_cmp_lg_u32 s25, 0
    s_cbranch_scc1 L_loader_last
    v_add_u32 v12, s44, v2
    s_barrier
    s_add_u32 s50, s47, 102400
    s_add_u32 s51, s47, 106496
    buffer_load_dwordx4 v[56:59], v2, s[4:7], s50 offen offset:0
    buffer_load_dwordx4 v[60:63], v2, s[4:7], s50 offen offset:1024
    buffer_load_dwordx4 v[64:67], v2, s[4:7], s50 offen offset:2048
    buffer_load_dwordx4 v[68:71], v2, s[4:7], s50 offen offset:3072
    buffer_load_dwordx4 v[72:75], v2, s[4:7], s51 offen offset:0
    s_add_u32 s50, s47, 122880
    s_add_u32 s51, s47, 126976
    buffer_load_dwordx4 v[76:79], v2, s[4:7], s50 offen offset:0
    buffer_load_dwordx4 v[80:83], v2, s[4:7], s50 offen offset:1024
    buffer_load_dwordx4 v[84:87], v2, s[4:7], s50 offen offset:2048
    buffer_load_dwordx4 v[88:91], v2, s[4:7], s50 offen offset:3072
    buffer_load_dwordx4 v[92:95], v2, s[4:7], s51 offen offset:0
    s_add_u32 s50, s46, 81920
    s_add_u32 s51, s46, 86016
    buffer_load_dwordx4 v[16:19], v2, s[4:7], s50 offen offset:0
    buffer_load_dwordx4 v[20:23], v2, s[4:7], s50 offen offset:1024
    buffer_load_dwordx4 v[24:27], v2, s[4:7], s50 offen offset:2048
    buffer_load_dwordx4 v[28:31], v2, s[4:7], s50 offen offset:3072
    buffer_load_dwordx4 v[32:35], v2, s[4:7], s51 offen offset:0
    s_barrier
    s_add_u32 m0, s44, 20480
    s_add_u32 s50, s46, 40960
    buffer_load_dwordx4 v2, s[4:7], s50 offen offset:0 lds
    buffer_load_dwordx4 v2, s[4:7], s50 offen offset:1024 lds
    buffer_load_dwordx4 v2, s[4:7], s50 offen offset:2048 lds
    buffer_load_dwordx4 v2, s[4:7], s50 offen offset:3072 lds
    s_add_u32 m0, s44, 24576
    s_add_u32 s50, s46, 45056
    buffer_load_dwordx4 v2, s[4:7], s50 offen offset:0 lds
    s_add_u32 m0, s44, 40960
    s_add_u32 s50, s46, 61440
    buffer_load_dwordx4 v2, s[4:7], s50 offen offset:0 lds
    buffer_load_dwordx4 v2, s[4:7], s50 offen offset:1024 lds
    buffer_load_dwordx4 v2, s[4:7], s50 offen offset:2048 lds
    buffer_load_dwordx4 v2, s[4:7], s50 offen offset:3072 lds
    s_add_u32 m0, s44, 45056
    s_add_u32 s50, s46, 65536
    buffer_load_dwordx4 v2, s[4:7], s50 offen offset:0 lds
    s_add_u32 s50, s46, 102400
    s_add_u32 s51, s46, 106496
    buffer_load_dwordx4 v[36:39], v2, s[4:7], s50 offen offset:0
    buffer_load_dwordx4 v[40:43], v2, s[4:7], s50 offen offset:1024
    buffer_load_dwordx4 v[44:47], v2, s[4:7], s50 offen offset:2048
    buffer_load_dwordx4 v[48:51], v2, s[4:7], s50 offen offset:3072
    buffer_load_dwordx4 v[52:55], v2, s[4:7], s51 offen offset:0
    s_barrier
    s_waitcnt vmcnt(15)
    v_add_u32 v13, 61440, v12
    ds_write_b128 v13, v[16:19] offset:0
    ds_write_b128 v13, v[20:23] offset:1024
    ds_write_b128 v13, v[24:27] offset:2048
    ds_write_b128 v13, v[28:31] offset:3072
    ds_write_b128 v13, v[32:35] offset:4096
    s_waitcnt vmcnt(5)
    s_barrier
    s_waitcnt vmcnt(0)
    v_add_u32 v13, 81920, v12
    ds_write_b128 v13, v[36:39] offset:0
    ds_write_b128 v13, v[40:43] offset:1024
    ds_write_b128 v13, v[44:47] offset:2048
    ds_write_b128 v13, v[48:51] offset:3072
    ds_write_b128 v13, v[52:55] offset:4096
    s_waitcnt lgkmcnt(0)
    s_barrier
    s_barrier
    s_add_u32 m0, s44, 102400
    s_add_u32 s50, s47, 0
    buffer_load_dwordx4 v2, s[4:7], s50 offen offset:0 lds
    buffer_load_dwordx4 v2, s[4:7], s50 offen offset:1024 lds
    buffer_load_dwordx4 v2, s[4:7], s50 offen offset:2048 lds
    buffer_load_dwordx4 v2, s[4:7], s50 offen offset:3072 lds
    s_add_u32 m0, s44, 106496
    s_add_u32 s50, s47, 4096
    buffer_load_dwordx4 v2, s[4:7], s50 offen offset:0 lds
    s_add_u32 m0, s44, 122880
    s_add_u32 s50, s47, 20480
    buffer_load_dwordx4 v2, s[4:7], s50 offen offset:0 lds
    buffer_load_dwordx4 v2, s[4:7], s50 offen offset:1024 lds
    buffer_load_dwordx4 v2, s[4:7], s50 offen offset:2048 lds
    buffer_load_dwordx4 v2, s[4:7], s50 offen offset:3072 lds
    s_add_u32 m0, s44, 126976
    s_add_u32 s50, s47, 24576
    buffer_load_dwordx4 v2, s[4:7], s50 offen offset:0 lds
    s_add_u32 m0, s44, 0
    s_add_u32 s50, s47, 40960
    buffer_load_dwordx4 v2, s[4:7], s50 offen offset:0 lds
    buffer_load_dwordx4 v2, s[4:7], s50 offen offset:1024 lds
    buffer_load_dwordx4 v2, s[4:7], s50 offen offset:2048 lds
    buffer_load_dwordx4 v2, s[4:7], s50 offen offset:3072 lds
    s_add_u32 m0, s44, 4096
    s_add_u32 s50, s47, 45056
    buffer_load_dwordx4 v2, s[4:7], s50 offen offset:0 lds
    s_add_u32 m0, s44, 20480
    s_add_u32 s50, s47, 61440
    buffer_load_dwordx4 v2, s[4:7], s50 offen offset:0 lds
    buffer_load_dwordx4 v2, s[4:7], s50 offen offset:1024 lds
    buffer_load_dwordx4 v2, s[4:7], s50 offen offset:2048 lds
    buffer_load_dwordx4 v2, s[4:7], s50 offen offset:3072 lds
    s_add_u32 m0, s44, 24576
    s_add_u32 s50, s47, 65536
    buffer_load_dwordx4 v2, s[4:7], s50 offen offset:0 lds
    s_add_u32 m0, s44, 40960
    s_add_u32 s50, s47, 81920
    buffer_load_dwordx4 v2, s[4:7], s50 offen offset:0 lds
    buffer_load_dwordx4 v2, s[4:7], s50 offen offset:1024 lds
    buffer_load_dwordx4 v2, s[4:7], s50 offen offset:2048 lds
    buffer_load_dwordx4 v2, s[4:7], s50 offen offset:3072 lds
    s_add_u32 m0, s44, 45056
    s_add_u32 s50, s47, 86016
    buffer_load_dwordx4 v2, s[4:7], s50 offen offset:0 lds
    s_waitcnt vmcnt(0)
    s_barrier
    v_add_u32 v13, 61440, v12
    ds_write_b128 v13, v[56:59] offset:0
    ds_write_b128 v13, v[60:63] offset:1024
    ds_write_b128 v13, v[64:67] offset:2048
    ds_write_b128 v13, v[68:71] offset:3072
    ds_write_b128 v13, v[72:75] offset:4096
    v_add_u32 v13, 81920, v12
    ds_write_b128 v13, v[76:79] offset:0
    ds_write_b128 v13, v[80:83] offset:1024
    ds_write_b128 v13, v[84:87] offset:2048
    ds_write_b128 v13, v[88:91] offset:3072
    ds_write_b128 v13, v[92:95] offset:4096
    s_barrier
    v_add_u32 v13, 102400, v12
    ds_write_b128 v13, v[112:115] offset:0
    ds_write_b128 v13, v[116:119] offset:1024
    ds_write_b128 v13, v[120:123] offset:2048
    ds_write_b128 v13, v[124:127] offset:3072
    ds_write_b128 v13, v[128:131] offset:4096
    v_add_u32 v13, 122880, v12
    ds_write_b128 v13, v[132:135] offset:0
    ds_write_b128 v13, v[136:139] offset:1024
    ds_write_b128 v13, v[140:143] offset:2048
    ds_write_b128 v13, v[144:147] offset:3072
    ds_write_b128 v13, v[148:151] offset:4096
    s_waitcnt lgkmcnt(10)
    s_barrier
    v_add_u32 v13, 0, v12
    ds_write_b128 v13, v[152:155] offset:0
    ds_write_b128 v13, v[156:159] offset:1024
    ds_write_b128 v13, v[160:163] offset:2048
    ds_write_b128 v13, v[164:167] offset:3072
    ds_write_b128 v13, v[168:171] offset:4096
    v_add_u32 v13, 20480, v12
    ds_write_b128 v13, v[172:175] offset:0
    ds_write_b128 v13, v[176:179] offset:1024
    ds_write_b128 v13, v[180:183] offset:2048
    ds_write_b128 v13, v[184:187] offset:3072
    ds_write_b128 v13, v[188:191] offset:4096
    s_waitcnt lgkmcnt(10)
    s_barrier
    v_add_u32 v13, 40960, v12
    ds_write_b128 v13, v[192:195] offset:0
    ds_write_b128 v13, v[196:199] offset:1024
    ds_write_b128 v13, v[200:203] offset:2048
    ds_write_b128 v13, v[204:207] offset:3072
    ds_write_b128 v13, v[208:211] offset:4096
    s_waitcnt lgkmcnt(0)
    s_barrier
    s_barrier
    s_add_u32 m0, s44, 61440
    s_add_u32 s50, s48, 0
    buffer_load_dwordx4 v2, s[4:7], s50 offen offset:0 lds
    buffer_load_dwordx4 v2, s[4:7], s50 offen offset:1024 lds
    buffer_load_dwordx4 v2, s[4:7], s50 offen offset:2048 lds
    buffer_load_dwordx4 v2, s[4:7], s50 offen offset:3072 lds
    s_add_u32 m0, s44, 65536
    s_add_u32 s50, s48, 4096
    buffer_load_dwordx4 v2, s[4:7], s50 offen offset:0 lds
    s_add_u32 m0, s44, 81920
    s_add_u32 s50, s48, 20480
    buffer_load_dwordx4 v2, s[4:7], s50 offen offset:0 lds
    buffer_load_dwordx4 v2, s[4:7], s50 offen offset:1024 lds
    buffer_load_dwordx4 v2, s[4:7], s50 offen offset:2048 lds
    buffer_load_dwordx4 v2, s[4:7], s50 offen offset:3072 lds
    s_add_u32 m0, s44, 86016
    s_add_u32 s50, s48, 24576
    buffer_load_dwordx4 v2, s[4:7], s50 offen offset:0 lds
    s_add_u32 m0, s44, 102400
    s_add_u32 s50, s48, 40960
    buffer_load_dwordx4 v2, s[4:7], s50 offen offset:0 lds
    buffer_load_dwordx4 v2, s[4:7], s50 offen offset:1024 lds
    buffer_load_dwordx4 v2, s[4:7], s50 offen offset:2048 lds
    buffer_load_dwordx4 v2, s[4:7], s50 offen offset:3072 lds
    s_add_u32 m0, s44, 106496
    s_add_u32 s50, s48, 45056
    buffer_load_dwordx4 v2, s[4:7], s50 offen offset:0 lds
    s_barrier
    v_add_u32 v13, 122880, v12
    ds_write_b128 v13, v[212:215] offset:0
    ds_write_b128 v13, v[216:219] offset:1024
    ds_write_b128 v13, v[220:223] offset:2048
    ds_write_b128 v13, v[224:227] offset:3072
    ds_write_b128 v13, v[228:231] offset:4096
    s_waitcnt vmcnt(0)
    s_waitcnt lgkmcnt(0)
    s_barrier
    v_add_u32 v13, 0, v12
    ds_write_b128 v13, v[232:235] offset:0
    ds_write_b128 v13, v[236:239] offset:1024
    ds_write_b128 v13, v[240:243] offset:2048
    ds_write_b128 v13, v[244:247] offset:3072
    ds_write_b128 v13, v[248:251] offset:4096
    s_barrier
    s_add_u32 m0, s44, 20480
    s_add_u32 s50, s48, 102400
    buffer_load_dwordx4 v2, s[4:7], s50 offen offset:0 lds
    buffer_load_dwordx4 v2, s[4:7], s50 offen offset:1024 lds
    buffer_load_dwordx4 v2, s[4:7], s50 offen offset:2048 lds
    buffer_load_dwordx4 v2, s[4:7], s50 offen offset:3072 lds
    s_add_u32 m0, s44, 24576
    s_add_u32 s50, s48, 106496
    buffer_load_dwordx4 v2, s[4:7], s50 offen offset:0 lds
    s_add_u32 m0, s44, 40960
    s_add_u32 s50, s48, 122880
    buffer_load_dwordx4 v2, s[4:7], s50 offen offset:0 lds
    buffer_load_dwordx4 v2, s[4:7], s50 offen offset:1024 lds
    buffer_load_dwordx4 v2, s[4:7], s50 offen offset:2048 lds
    buffer_load_dwordx4 v2, s[4:7], s50 offen offset:3072 lds
    s_add_u32 m0, s44, 45056
    s_add_u32 s50, s48, 126976
    buffer_load_dwordx4 v2, s[4:7], s50 offen offset:0 lds
    s_add_u32 m0, s44, 61440
    s_add_u32 s50, s48, 143360
    buffer_load_dwordx4 v2, s[4:7], s50 offen offset:0 lds
    buffer_load_dwordx4 v2, s[4:7], s50 offen offset:1024 lds
    buffer_load_dwordx4 v2, s[4:7], s50 offen offset:2048 lds
    buffer_load_dwordx4 v2, s[4:7], s50 offen offset:3072 lds
    s_add_u32 m0, s44, 65536
    s_add_u32 s50, s48, 147456
    buffer_load_dwordx4 v2, s[4:7], s50 offen offset:0 lds
    s_waitcnt lgkmcnt(0)
    s_barrier
    s_waitcnt vmcnt(0)
    s_barrier
    s_branch L_next
L_loader_last:
    v_add_u32 v12, s44, v2
    s_barrier
    s_add_u32 s50, s46, 81920
    s_add_u32 s51, s46, 86016
    buffer_load_dwordx4 v[16:19], v2, s[4:7], s50 offen offset:0
    buffer_load_dwordx4 v[20:23], v2, s[4:7], s50 offen offset:1024
    buffer_load_dwordx4 v[24:27], v2, s[4:7], s50 offen offset:2048
    buffer_load_dwordx4 v[28:31], v2, s[4:7], s50 offen offset:3072
    buffer_load_dwordx4 v[32:35], v2, s[4:7], s51 offen offset:0
    s_barrier
    s_add_u32 m0, s44, 20480
    s_add_u32 s50, s46, 40960
    buffer_load_dwordx4 v2, s[4:7], s50 offen offset:0 lds
    buffer_load_dwordx4 v2, s[4:7], s50 offen offset:1024 lds
    buffer_load_dwordx4 v2, s[4:7], s50 offen offset:2048 lds
    buffer_load_dwordx4 v2, s[4:7], s50 offen offset:3072 lds
    s_add_u32 m0, s44, 24576
    s_add_u32 s50, s46, 45056
    buffer_load_dwordx4 v2, s[4:7], s50 offen offset:0 lds
    s_add_u32 m0, s44, 40960
    s_add_u32 s50, s46, 61440
    buffer_load_dwordx4 v2, s[4:7], s50 offen offset:0 lds
    buffer_load_dwordx4 v2, s[4:7], s50 offen offset:1024 lds
    buffer_load_dwordx4 v2, s[4:7], s50 offen offset:2048 lds
    buffer_load_dwordx4 v2, s[4:7], s50 offen offset:3072 lds
    s_add_u32 m0, s44, 45056
    s_add_u32 s50, s46, 65536
    buffer_load_dwordx4 v2, s[4:7], s50 offen offset:0 lds
    s_add_u32 s50, s46, 102400
    s_add_u32 s51, s46, 106496
    buffer_load_dwordx4 v[36:39], v2, s[4:7], s50 offen offset:0
    buffer_load_dwordx4 v[40:43], v2, s[4:7], s50 offen offset:1024
    buffer_load_dwordx4 v[44:47], v2, s[4:7], s50 offen offset:2048
    buffer_load_dwordx4 v[48:51], v2, s[4:7], s50 offen offset:3072
    buffer_load_dwordx4 v[52:55], v2, s[4:7], s51 offen offset:0
    s_barrier
    s_waitcnt vmcnt(15)
    v_add_u32 v13, 61440, v12
    ds_write_b128 v13, v[16:19] offset:0
    ds_write_b128 v13, v[20:23] offset:1024
    ds_write_b128 v13, v[24:27] offset:2048
    ds_write_b128 v13, v[28:31] offset:3072
    ds_write_b128 v13, v[32:35] offset:4096
    s_waitcnt vmcnt(5)
    s_barrier
    s_waitcnt vmcnt(0)
    v_add_u32 v13, 81920, v12
    ds_write_b128 v13, v[36:39] offset:0
    ds_write_b128 v13, v[40:43] offset:1024
    ds_write_b128 v13, v[44:47] offset:2048
    ds_write_b128 v13, v[48:51] offset:3072
    ds_write_b128 v13, v[52:55] offset:4096
    s_waitcnt lgkmcnt(0)
    s_barrier
    s_barrier
    s_add_u32 m0, s44, 102400
    s_add_u32 s50, s47, 0
    buffer_load_dwordx4 v2, s[4:7], s50 offen offset:0 lds
    buffer_load_dwordx4 v2, s[4:7], s50 offen offset:1024 lds
    buffer_load_dwordx4 v2, s[4:7], s50 offen offset:2048 lds
    buffer_load_dwordx4 v2, s[4:7], s50 offen offset:3072 lds
    s_add_u32 m0, s44, 106496
    s_add_u32 s50, s47, 4096
    buffer_load_dwordx4 v2, s[4:7], s50 offen offset:0 lds
    s_add_u32 m0, s44, 122880
    s_add_u32 s50, s47, 20480
    buffer_load_dwordx4 v2, s[4:7], s50 offen offset:0 lds
    buffer_load_dwordx4 v2, s[4:7], s50 offen offset:1024 lds
    buffer_load_dwordx4 v2, s[4:7], s50 offen offset:2048 lds
    buffer_load_dwordx4 v2, s[4:7], s50 offen offset:3072 lds
    s_add_u32 m0, s44, 126976
    s_add_u32 s50, s47, 24576
    buffer_load_dwordx4 v2, s[4:7], s50 offen offset:0 lds
    s_add_u32 m0, s44, 0
    s_add_u32 s50, s47, 40960
    buffer_load_dwordx4 v2, s[4:7], s50 offen offset:0 lds
    buffer_load_dwordx4 v2, s[4:7], s50 offen offset:1024 lds
    buffer_load_dwordx4 v2, s[4:7], s50 offen offset:2048 lds
    buffer_load_dwordx4 v2, s[4:7], s50 offen offset:3072 lds
    s_add_u32 m0, s44, 4096
    s_add_u32 s50, s47, 45056
    buffer_load_dwordx4 v2, s[4:7], s50 offen offset:0 lds
    s_add_u32 m0, s44, 20480
    s_add_u32 s50, s47, 61440
    buffer_load_dwordx4 v2, s[4:7], s50 offen offset:0 lds
    buffer_load_dwordx4 v2, s[4:7], s50 offen offset:1024 lds
    buffer_load_dwordx4 v2, s[4:7], s50 offen offset:2048 lds
    buffer_load_dwordx4 v2, s[4:7], s50 offen offset:3072 lds
    s_add_u32 m0, s44, 24576
    s_add_u32 s50, s47, 65536
    buffer_load_dwordx4 v2, s[4:7], s50 offen offset:0 lds
    s_add_u32 m0, s44, 40960
    s_add_u32 s50, s47, 81920
    buffer_load_dwordx4 v2, s[4:7], s50 offen offset:0 lds
    buffer_load_dwordx4 v2, s[4:7], s50 offen offset:1024 lds
    buffer_load_dwordx4 v2, s[4:7], s50 offen offset:2048 lds
    buffer_load_dwordx4 v2, s[4:7], s50 offen offset:3072 lds
    s_add_u32 m0, s44, 45056
    s_add_u32 s50, s47, 86016
    buffer_load_dwordx4 v2, s[4:7], s50 offen offset:0 lds
    s_waitcnt vmcnt(0)
    s_barrier
    v_add_u32 v13, 61440, v12
    ds_write_b128 v13, v[112:115] offset:0
    ds_write_b128 v13, v[116:119] offset:1024
    ds_write_b128 v13, v[120:123] offset:2048
    ds_write_b128 v13, v[124:127] offset:3072
    ds_write_b128 v13, v[128:131] offset:4096
    v_add_u32 v13, 81920, v12
    ds_write_b128 v13, v[132:135] offset:0
    ds_write_b128 v13, v[136:139] offset:1024
    ds_write_b128 v13, v[140:143] offset:2048
    ds_write_b128 v13, v[144:147] offset:3072
    ds_write_b128 v13, v[148:151] offset:4096
    s_barrier
    s_cmp_lg_u32 s18, 0
    s_cbranch_scc1 L_wb_107
    s_cmp_lg_u32 s16, 7
    s_cbranch_scc1 L_wb_107
    buffer_wbl2 sc1
L_wb_107:
    v_add_u32 v13, 102400, v12
    ds_write_b128 v13, v[152:155] offset:0
    ds_write_b128 v13, v[156:159] offset:1024
    ds_write_b128 v13, v[160:163] offset:2048
    ds_write_b128 v13, v[164:167] offset:3072
    ds_write_b128 v13, v[168:171] offset:4096
    v_add_u32 v13, 122880, v12
    ds_write_b128 v13, v[172:175] offset:0
    ds_write_b128 v13, v[176:179] offset:1024
    ds_write_b128 v13, v[180:183] offset:2048
    ds_write_b128 v13, v[184:187] offset:3072
    ds_write_b128 v13, v[188:191] offset:4096
    s_waitcnt lgkmcnt(10)
    s_barrier
    v_add_u32 v13, 0, v12
    ds_write_b128 v13, v[192:195] offset:0
    ds_write_b128 v13, v[196:199] offset:1024
    ds_write_b128 v13, v[200:203] offset:2048
    ds_write_b128 v13, v[204:207] offset:3072
    ds_write_b128 v13, v[208:211] offset:4096
    v_add_u32 v13, 20480, v12
    ds_write_b128 v13, v[212:215] offset:0
    ds_write_b128 v13, v[216:219] offset:1024
    ds_write_b128 v13, v[220:223] offset:2048
    ds_write_b128 v13, v[224:227] offset:3072
    ds_write_b128 v13, v[228:231] offset:4096
    s_waitcnt lgkmcnt(10)
    s_barrier
    v_add_u32 v13, 40960, v12
    ds_write_b128 v13, v[232:235] offset:0
    ds_write_b128 v13, v[236:239] offset:1024
    ds_write_b128 v13, v[240:243] offset:2048
    ds_write_b128 v13, v[244:247] offset:3072
    ds_write_b128 v13, v[248:251] offset:4096
    s_waitcnt lgkmcnt(0)
    s_barrier
    s_barrier
    s_barrier
    s_branch L_done
L_code_end:
.section .rodata,"a"
.p2align 6
.amdhsa_kernel interleave_layers__softmax_full_mha__mixer_channel_mlp__prompt_kernel
  .amdhsa_next_free_vgpr 256
  .amdhsa_next_free_sgpr 102
  .amdhsa_accum_offset 256
  .amdhsa_group_segment_fixed_size 0
  .amdhsa_kernarg_size 88
  .amdhsa_user_sgpr_count 2
  .amdhsa_user_sgpr_kernarg_segment_ptr 1
  .amdhsa_system_sgpr_workgroup_id_x 1
  .amdhsa_float_denorm_mode_32 3
.end_amdhsa_kernel
```
